```python
import torch

def _softmax(x, axis=-1):
    return torch.softmax(x, dim=axis)
def _gelu(x):
    return torch.nn.functional.gelu(x, approximate="tanh")
def _silu(x):
    return torch.nn.functional.silu(x)
def _sigmoid(x):
    return torch.sigmoid(x)
def _layernorm(x, axis=-1, eps=1e-5):
    m = x.mean(dim=axis, keepdim=True)
    v = x.var(dim=axis, keepdim=True, unbiased=False)
    return (x - m) / torch.sqrt(v + eps)
def _scatter_add(tgt, idx, src, axis=0):
    return tgt.clone().index_add_(axis, idx, src)
def _segment_sum(src, seg, n):
    out = torch.zeros((n,) + src.shape[1:], dtype=src.dtype)
    return out.index_add_(0, seg, src)
def _pad(x, pw):
    flat = tuple(v for pair in reversed(pw) for v in pair)
    return torch.nn.functional.pad(x, flat)

kernel_name = 'interleave_layers__ssm_conv_h3__glu_gated_bilinear__prompt'

def setup_inputs():

    _w = (lambda a: (lambda t: t.to(torch.bfloat16) if t.is_floating_point() else t)(torch.as_tensor(a)))
    def _A_setup():
        B, S, D = 1, 2048, 448
        ks = 4
        return {
            "q": _w((lambda *s: torch.randn(*s, dtype=torch.bfloat16) * 0.05)(B, S, D)),
            "k": _w((lambda *s: torch.randn(*s, dtype=torch.bfloat16) * 0.4)(B, S, D)),
            "v": _w((lambda *s: torch.randn(*s, dtype=torch.bfloat16) * 0.4)(B, S, D)),
            "shift_k": _w((lambda *s: torch.randn(*s, dtype=torch.bfloat16) * 0.4)(D, ks) * 0.5),
            "ssm_k": _w((lambda *s: torch.randn(*s, dtype=torch.bfloat16) * 0.4)(D, S) * (1.0 / S ** 0.5)),
            "ssm_D": _w((lambda *s: torch.randn(*s, dtype=torch.bfloat16) * 0.4)(D)),
        }
    _A_in = _A_setup()

    def _B_setup():
        B, S, D, F = 1, 2048, 448, 1792
        return {
            "x": _w((lambda *s: torch.randn(*s, dtype=torch.bfloat16) * 0.05)(B, S, D)),
            "w_gate": _w((lambda *s: torch.randn(*s, dtype=torch.bfloat16) * 0.8)(D, F) * (D ** -0.5)),
            "w_up": _w((lambda *s: torch.randn(*s, dtype=torch.bfloat16) * 0.8)(D, F) * (D ** -0.5)),
            "w_down": _w((lambda *s: torch.randn(*s, dtype=torch.bfloat16) * 0.8)(F, D) * (F ** -0.5)),
        }
    _B_in = _B_setup()

    return {
        "A_q": _A_in["q"],
        "A_k": _A_in["k"],
        "A_v": _A_in["v"],
        "A_shift_k": _A_in["shift_k"],
        "A_ssm_k": _A_in["ssm_k"],
        "A_ssm_D": _A_in["ssm_D"],
        "B_x": _B_in["x"],
        "B_w_gate": _B_in["w_gate"],
        "B_w_up": _B_in["w_up"],
        "B_w_down": _B_in["w_down"],
    }

def reference(A_q, A_k, A_v, A_shift_k, A_ssm_k, A_ssm_D, B_x, B_w_gate, B_w_up, B_w_down):
    def _A_ref(q, k, v, shift_k, ssm_k, ssm_D):
        B, S, D = q.shape
        ks = shift_k.shape[-1]
        k_pad = _pad(k, ((0, 0), (ks - 1, 0), (0, 0)))
        k_shift = torch.zeros_like(k)
        for t in range(ks):
            k_shift = k_shift + k_pad[:, t:t + S, :] * shift_k[:, ks - 1 - t][None, None, :]
        kv = k_shift * v
        L = 2 * S
        kv_pad = _pad(kv, ((0, 0), (0, S), (0, 0)))
        kf_pad = _pad(ssm_k, ((0, 0), (0, S)))
        kv_f = (lambda x, axes=(-2,-1): torch.fft.rfft2(x.float(), dim=axes))(kv_pad[:, None, :, :], axes=(1, 2))
        kf_f = (lambda x, axes=(-2,-1): torch.fft.rfft2(x.float(), dim=axes))(kf_pad[:, None, :], axes=(1, 2))
        kf_f = (lambda x, *d: x.permute(*d))(kf_f, 1, 2, 0)
        y_f = kv_f * kf_f[None, :, :, :]
        y = (lambda x, s, axes=(-2,-1): torch.fft.irfft2(x, s=s, dim=axes).to(torch.bfloat16))(y_f, (1, L), axes=(1, 2))[:, 0, :S, :]
        y = y + kv * ssm_D[None, None, :]
        return q * y

    def _B_ref(x, w_gate, w_up, w_down):
        g = torch.einsum("bsd,df->bsf", x, w_gate)
        u = torch.einsum("bsd,df->bsf", x, w_up)
        h = g * u
        return torch.einsum("bsf,fd->bsd", h, w_down)

    x = A_q
    x = x + _A_ref(_layernorm(x, axis=-1), A_k, A_v, A_shift_k, A_ssm_k, A_ssm_D)
    x = x + _B_ref(_layernorm(x, axis=-1), B_w_gate, B_w_up, B_w_down)
    x = x + _A_ref(_layernorm(x, axis=-1), A_k, A_v, A_shift_k, A_ssm_k, A_ssm_D)
    x = x + _B_ref(_layernorm(x, axis=-1), B_w_gate, B_w_up, B_w_down)
    return x
```

```asm
; @launch grid=(256,1,1) block=(256,1,1) lds=163840
.amdgcn_target "amdgcn-amd-amdhsa--gfx950"
.text
.globl interleave_layers__ssm_conv_h3__glu_gated_bilinear__prompt_kernel
.p2align 8
.type interleave_layers__ssm_conv_h3__glu_gated_bilinear__prompt_kernel,@function
interleave_layers__ssm_conv_h3__glu_gated_bilinear__prompt_kernel:
    s_cmp_ge_u32 s2, 256
    s_cbranch_scc1 L_end
    s_load_dwordx16 s[4:19], s[0:1], 0
    s_load_dwordx8 s[20:27], s[0:1], 64
    s_load_dwordx2 s[28:29], s[0:1], 96
    s_getreg_b32 s70, hwreg(HW_REG_XCC_ID)
    v_lshrrev_b32 v2, 6, v0
    v_and_b32 v1, 63, v0
    s_and_b32 s64, s2, 7
    v_readfirstlane_b32 s68, v2
    s_lshr_b32 s65, s2, 3
    s_and_b32 s67, s65, 15
    s_lshr_b32 s72, s65, 4
    s_lshl_b32 s66, s64, 1
    s_add_u32 s66, s66, s72
    s_and_b32 s70, s70, 15
    s_getpc_b64 s[30:31]
L_pc_1:
    s_sub_u32 s30, s30, L_pc_1 - interleave_layers__ssm_conv_h3__glu_gated_bilinear__prompt_kernel
    s_subb_u32 s31, s31, 0
    s_lshl_b32 s73, s65, 2
    s_add_u32 s73, s73, s68
    s_and_b32 s73, s73, 63
    s_lshl_b32 s73, s73, 10
    v_and_b32 v11, 7, v1
    v_lshl_add_u32 v11, v11, 7, s73
    s_mov_b32 s73, L_end - interleave_layers__ssm_conv_h3__glu_gated_bilinear__prompt_kernel
    v_min_u32 v11, s73, v11
    global_load_dword v11, v11, s[30:31]
    s_mul_i32 s72, s72, 14
    s_add_u32 s72, s72, s67
    s_mul_i32 s94, s64, 28
    s_add_u32 s94, s94, s72
    s_cmp_ge_u32 s67, 14
    s_cbranch_scc1 L_row
    s_mul_i32 s92, s94, 9363
    s_lshr_b32 s92, s92, 16
    s_mul_i32 s93, s92, 7
    s_sub_u32 s93, s94, s93
    v_lshrrev_b32 v2, 3, v0
    v_and_b32 v3, 7, v0
    s_mul_i32 s72, s92, 57344
    s_lshl_b32 s73, s93, 7
    s_add_u32 s72, s72, s73
    v_mul_u32_u24 v4, 1792, v2
    v_lshl_add_u32 v4, v3, 4, v4
    v_add_u32 v4, s72, v4
    v_subrev_u32 v5, 2688, v4
    v_subrev_u32 v6, 1792, v4
    s_lshl_b32 s73, s73, 2
    v_lshl_add_u32 v7, v3, 6, s73
    v_xor_b32 v9, 3, v2
    v_lshrrev_b32 v8, 2, v9
    v_xor_b32 v8, v8, v3
    v_lshlrev_b32 v8, 4, v8
    v_and_b32 v9, 3, v9
    v_lshl_add_u32 v8, v9, 2, v8
    v_lshl_add_u32 v8, v3, 10, v8
    s_waitcnt lgkmcnt(0)
    s_mov_b32 s32, s6
    s_and_b32 s33, s7, 0xffff
    s_mov_b32 s34, 1835008
    s_mov_b32 s35, 0x20000
    s_mov_b32 s36, s8
    s_and_b32 s37, s9, 0xffff
    s_mov_b32 s38, 1835008
    s_mov_b32 s39, 0x20000
    s_mov_b32 s44, s10
    s_and_b32 s45, s11, 0xffff
    s_mov_b32 s46, 3584
    s_mov_b32 s47, 0x20000
    s_mov_b32 s40, s28
    s_and_b32 s41, s29, 0xffff
    s_mov_b32 s42, 16777216
    s_mov_b32 s43, 0x20000
    buffer_load_dwordx4 v[12:15], v5, s[32:35], 0 offen
    buffer_load_dwordx4 v[16:19], v6, s[32:35], 0 offen
    buffer_load_dwordx4 v[20:23], v6, s[32:35], 0 offen offset:896
    buffer_load_dwordx4 v[24:27], v4, s[32:35], 0 offen
    buffer_load_dwordx4 v[28:31], v4, s[32:35], 0 offen offset:896
    buffer_load_dwordx4 v[32:35], v4, s[36:39], 0 offen
    buffer_load_dwordx4 v[36:39], v4, s[36:39], 0 offen offset:896
    buffer_load_dwordx4 v[40:43], v7, s[44:47], 0 offen
    buffer_load_dwordx4 v[44:47], v7, s[44:47], 0 offen offset:16
    buffer_load_dwordx4 v[48:51], v7, s[44:47], 0 offen offset:32
    buffer_load_dwordx4 v[52:55], v7, s[44:47], 0 offen offset:48
    buffer_load_dword v10, off, s[40:43], 0 sc1
    v_and_b32 v134, 3, v1
    v_lshlrev_b32 v134, 21, v134
    v_add_u32 v134, 0x2e0000, v134
    buffer_load_dword v134, v134, s[40:43], 0 offen
    s_mov_b32 s52, s18
    s_and_b32 s53, s19, 0xffff
    s_mov_b32 s54, 1605632
    s_mov_b32 s55, 0x20000
    s_mov_b32 s56, s20
    s_and_b32 s57, s21, 0xffff
    s_mov_b32 s58, 1605632
    s_mov_b32 s59, 0x20000
    s_mov_b32 s60, s22
    s_and_b32 s61, s23, 0xffff
    s_mov_b32 s62, 1605632
    s_mov_b32 s63, 0x20000
    s_mov_b32 s48, s12
    s_and_b32 s49, s13, 0xffff
    s_mov_b32 s50, 1835008
    s_mov_b32 s51, 0x20000
    s_lshl_b32 s95, s94, 13
    s_add_u32 s73, s95, 4096
    v_lshlrev_b32 v94, 4, v0
    v_subrev_u32 v95, 8, v94
    v_min_u32 v95, 0x40000000, v95
    s_lshl_b32 s74, s94, 2
    s_load_dword s96, s[14:15], s74
    buffer_load_dwordx4 v[80:83], v94, s[48:51], s95 offen nt
    buffer_load_dwordx2 v[84:85], v95, s[48:51], s95 offen nt
    buffer_load_dwordx4 v[88:91], v94, s[48:51], s73 offen nt
    buffer_load_dwordx2 v[92:93], v95, s[48:51], s73 offen nt
    v_lshrrev_b32 v56, 4, v1
    v_and_b32 v57, 15, v1
    v_lshlrev_b32 v58, 1, v56
    v_xor_b32 v58, v58, v57
    s_and_b32 s72, s68, 1
    s_lshl_b32 s72, s72, 3
    v_xor_b32 v58, s72, v58
    v_mul_u32_u24 v59, 3584, v56
    v_lshl_add_u32 v59, v58, 4, v59
    s_lshl_b32 s73, s67, 8
    v_add_u32 v170, s73, v59
    s_lshl_b32 s90, s68, 11
    s_add_u32 s90, s90, 65536
    s_mul_i32 s78, s68, 14336
    s_add_u32 s78, s78, 0
    s_add_u32 s79, s78, 228352
    s_add_u32 m0, s90, 0
    s_nop 0
    buffer_load_dwordx4 v170, s[52:55], s78 offen lds
    buffer_load_dwordx4 v170, s[52:55], s79 offen offset:1024 lds
    s_add_u32 m0, s90, 8192
    s_nop 0
    buffer_load_dwordx4 v170, s[56:59], s78 offen lds
    buffer_load_dwordx4 v170, s[56:59], s79 offen offset:1024 lds
    s_mul_i32 s78, s68, 14336
    s_add_u32 s78, s78, 57344
    s_add_u32 s79, s78, 228352
    s_add_u32 m0, s90, 16384
    s_nop 0
    buffer_load_dwordx4 v170, s[52:55], s78 offen lds
    buffer_load_dwordx4 v170, s[52:55], s79 offen offset:1024 lds
    s_add_u32 m0, s90, 24576
    s_nop 0
    buffer_load_dwordx4 v170, s[56:59], s78 offen lds
    buffer_load_dwordx4 v170, s[56:59], s79 offen offset:1024 lds
    v_lshrrev_b32 v56, 4, v1
    v_bfe_u32 v57, v1, 2, 2
    v_and_b32 v58, 3, v1
    v_and_b32 v59, 1, v56
    v_lshrrev_b32 v61, 1, v58
    s_lshl_b32 s72, s68, 2
    v_add_u32 v61, s72, v61
    v_lshlrev_b32 v62, 1, v57
    v_xor_b32 v61, v61, v62
    v_lshlrev_b32 v62, 3, v59
    v_xor_b32 v61, v61, v62
    v_lshlrev_b32 v61, 4, v61
    v_and_b32 v62, 1, v58
    v_lshl_add_u32 v61, v62, 3, v61
    v_lshl_add_u32 v62, v56, 3, v57
    v_lshl_add_u32 v61, v62, 8, v61
    v_add_u32 v173, 65536, v61
    v_xor_b32 v174, 32, v173
    v_lshl_add_u32 v62, v56, 2, v57
    v_lshlrev_b32 v62, 7, v62
    v_lshrrev_b32 v61, 1, v57
    v_lshl_add_u32 v61, v59, 1, v61
    v_lshlrev_b32 v61, 1, v61
    v_lshrrev_b32 v63, 1, v58
    s_lshl_b32 s74, s68, 1
    v_add_u32 v63, s74, v63
    v_xor_b32 v63, v63, v61
    v_lshl_add_u32 v62, v63, 4, v62
    v_and_b32 v63, 1, v58
    v_lshl_add_u32 v62, v63, 3, v62
    s_lshl_b32 s74, s68, 12
    s_add_u32 s74, s74, 98304
    v_add_u32 v175, s74, v62
    v_xor_b32 v171, 32, v175
    s_cmp_ge_u32 s67, 7
    s_cselect_b32 s98, 1, 0
    s_mul_i32 s74, s98, 7
    s_sub_u32 s99, s67, s74
    s_lshl_b32 s74, s98, 2
    s_add_u32 s74, s74, s68
    s_mul_i32 s74, s74, 200704
    s_lshl_b32 s72, s99, 7
    s_add_u32 s74, s74, s72
    v_lshrrev_b32 v61, 3, v1
    v_mul_u32_u24 v61, 896, v61
    v_and_b32 v62, 7, v1
    v_lshlrev_b32 v63, 1, v56
    v_xor_b32 v62, v62, v63
    v_lshl_add_u32 v61, v62, 4, v61
    v_add_u32 v172, s74, v61
    v_add_u32 v165, 0x10000, v173
    v_add_u32 v166, 0x10000, v174
    v_xor_b32 v167, 64, v175
    v_xor_b32 v168, 0x60, v175
    s_lshl_b32 s91, s68, 12
    s_add_u32 s91, s91, 65536
    s_mov_b32 s72, 0x05040100
    s_mov_b32 s73, 0x07060302
    s_mov_b32 s74, 0xffff0000
    s_waitcnt vmcnt(13)
    v_readfirstlane_b32 s69, v10
    v_perm_b32 v56, v20, v24, s72
    v_perm_b32 v57, v12, v16, s72
    v_perm_b32 v58, v24, v28, s72
    v_perm_b32 v59, v16, v20, s72
    v_perm_b32 v60, v20, v24, s73
    v_perm_b32 v61, v12, v16, s73
    v_perm_b32 v62, v24, v28, s73
    v_perm_b32 v63, v16, v20, s73
    v_dot2_f32_bf16 v64, v56, v40, 0
    v_dot2_f32_bf16 v65, v58, v40, 0
    v_dot2_f32_bf16 v66, v60, v42, 0
    v_dot2_f32_bf16 v67, v62, v42, 0
    v_dot2_f32_bf16 v64, v57, v41, v64
    v_dot2_f32_bf16 v65, v59, v41, v65
    v_dot2_f32_bf16 v66, v61, v43, v66
    v_dot2_f32_bf16 v67, v63, v43, v67
    v_lshlrev_b32 v68, 16, v32
    v_lshlrev_b32 v69, 16, v36
    v_and_b32 v70, s74, v32
    v_and_b32 v71, s74, v36
    v_mul_f32 v64, v64, v68
    v_mul_f32 v65, v65, v69
    v_mul_f32 v66, v66, v70
    v_mul_f32 v67, v67, v71
    v_cvt_pk_bf16_f32 v72, v65, v64
    v_cvt_pk_bf16_f32 v73, v67, v66
    v_perm_b32 v56, v21, v25, s72
    v_perm_b32 v57, v13, v17, s72
    v_perm_b32 v58, v25, v29, s72
    v_perm_b32 v59, v17, v21, s72
    v_perm_b32 v60, v21, v25, s73
    v_perm_b32 v61, v13, v17, s73
    v_perm_b32 v62, v25, v29, s73
    v_perm_b32 v63, v17, v21, s73
    v_dot2_f32_bf16 v64, v56, v44, 0
    v_dot2_f32_bf16 v65, v58, v44, 0
    v_dot2_f32_bf16 v66, v60, v46, 0
    v_dot2_f32_bf16 v67, v62, v46, 0
    v_dot2_f32_bf16 v64, v57, v45, v64
    v_dot2_f32_bf16 v65, v59, v45, v65
    v_dot2_f32_bf16 v66, v61, v47, v66
    v_dot2_f32_bf16 v67, v63, v47, v67
    v_lshlrev_b32 v68, 16, v33
    v_lshlrev_b32 v69, 16, v37
    v_and_b32 v70, s74, v33
    v_and_b32 v71, s74, v37
    v_mul_f32 v64, v64, v68
    v_mul_f32 v65, v65, v69
    v_mul_f32 v66, v66, v70
    v_mul_f32 v67, v67, v71
    v_cvt_pk_bf16_f32 v74, v65, v64
    v_cvt_pk_bf16_f32 v75, v67, v66
    v_perm_b32 v56, v22, v26, s72
    v_perm_b32 v57, v14, v18, s72
    v_perm_b32 v58, v26, v30, s72
    v_perm_b32 v59, v18, v22, s72
    v_perm_b32 v60, v22, v26, s73
    v_perm_b32 v61, v14, v18, s73
    v_perm_b32 v62, v26, v30, s73
    v_perm_b32 v63, v18, v22, s73
    v_dot2_f32_bf16 v64, v56, v48, 0
    v_dot2_f32_bf16 v65, v58, v48, 0
    v_dot2_f32_bf16 v66, v60, v50, 0
    v_dot2_f32_bf16 v67, v62, v50, 0
    v_dot2_f32_bf16 v64, v57, v49, v64
    v_dot2_f32_bf16 v65, v59, v49, v65
    v_dot2_f32_bf16 v66, v61, v51, v66
    v_dot2_f32_bf16 v67, v63, v51, v67
    v_lshlrev_b32 v68, 16, v34
    v_lshlrev_b32 v69, 16, v38
    v_and_b32 v70, s74, v34
    v_and_b32 v71, s74, v38
    v_mul_f32 v64, v64, v68
    v_mul_f32 v65, v65, v69
    v_mul_f32 v66, v66, v70
    v_mul_f32 v67, v67, v71
    v_cvt_pk_bf16_f32 v76, v65, v64
    v_cvt_pk_bf16_f32 v77, v67, v66
    v_perm_b32 v56, v23, v27, s72
    v_perm_b32 v57, v15, v19, s72
    v_perm_b32 v58, v27, v31, s72
    v_perm_b32 v59, v19, v23, s72
    v_perm_b32 v60, v23, v27, s73
    v_perm_b32 v61, v15, v19, s73
    v_perm_b32 v62, v27, v31, s73
    v_perm_b32 v63, v19, v23, s73
    v_dot2_f32_bf16 v64, v56, v52, 0
    v_dot2_f32_bf16 v65, v58, v52, 0
    v_dot2_f32_bf16 v66, v60, v54, 0
    v_dot2_f32_bf16 v67, v62, v54, 0
    v_dot2_f32_bf16 v64, v57, v53, v64
    v_dot2_f32_bf16 v65, v59, v53, v65
    v_dot2_f32_bf16 v66, v61, v55, v66
    v_dot2_f32_bf16 v67, v63, v55, v67
    v_lshlrev_b32 v68, 16, v35
    v_lshlrev_b32 v69, 16, v39
    v_and_b32 v70, s74, v35
    v_and_b32 v71, s74, v39
    v_mul_f32 v64, v64, v68
    v_mul_f32 v65, v65, v69
    v_mul_f32 v66, v66, v70
    v_mul_f32 v67, v67, v71
    v_cvt_pk_bf16_f32 v78, v65, v64
    v_cvt_pk_bf16_f32 v79, v67, v66
    s_mul_i32 s69, s69, 1664525
    s_add_u32 s69, s69, 1013904223
    ds_write_b32 v8, v72 offset:0
    ds_write_b32 v8, v73 offset:128
    ds_write_b32 v8, v74 offset:256
    ds_write_b32 v8, v75 offset:384
    ds_write_b32 v8, v76 offset:512
    ds_write_b32 v8, v77 offset:640
    ds_write_b32 v8, v78 offset:768
    ds_write_b32 v8, v79 offset:896
    v_lshrrev_b32 v4, 3, v0
    v_and_b32 v5, 7, v0
    v_lshrrev_b32 v6, 6, v0
    v_xor_b32 v6, v6, v5
    v_lshlrev_b32 v6, 4, v6
    v_lshl_add_u32 v2, v4, 7, v6
    v_xor_b32 v7, 64, v2
    v_lshlrev_b32 v3, 12, v4
    v_lshl_add_u32 v3, v5, 4, v3
    s_lshl_b32 s72, s93, 18
    s_lshl_b32 s73, s92, 7
    s_add_u32 s72, s72, s73
    s_add_u32 s72, s72, 1048576
    s_add_u32 s73, s72, 131072
    s_waitcnt lgkmcnt(0)
    s_barrier
    ds_read_b128 v[12:15], v2
    ds_read_b128 v[16:19], v7 offset:4096
    v_mov_b32 v8, s69
    v_mov_b32 v9, s70
    s_lshl_b32 s74, s2, 7
    s_add_u32 s74, s74, 4096
    s_waitcnt lgkmcnt(1)
    buffer_store_dwordx4 v[12:15], v3, s[40:43], s72 offen sc1
    s_waitcnt lgkmcnt(0)
    buffer_store_dwordx4 v[16:19], v3, s[40:43], s73 offen sc1
    s_waitcnt vmcnt(0) lgkmcnt(0)
    s_barrier
    s_cmp_lg_u32 s68, 0
    s_cbranch_scc1 L_af_2
    buffer_store_dwordx2 v[8:9], off, s[40:43], s74 sc1
L_af_2:
    v_min_u32 v11, 55, v1
    s_mul_i32 s72, s94, 7168
    v_lshl_add_u32 v11, v11, 7, s72
    s_cmp_eq_u32 s68, 1
    s_cbranch_scc1 L_t1_3
    s_cmp_eq_u32 s68, 2
    s_cbranch_scc1 L_t2_4
    s_cmp_eq_u32 s68, 3
    s_cbranch_scc1 L_te_6
    buffer_load_dword v11, v11, s[52:55], 0 offen
    s_branch L_te_6
L_t1_3:
    buffer_load_dword v11, v11, s[56:59], 0 offen
    s_branch L_te_6
L_t2_4:
    buffer_load_dword v11, v11, s[60:63], 0 offen
L_t3_5:
L_te_6:
    ds_read_b64_tr_b16 a[0:1], v173 offset:0
    ds_read_b64_tr_b16 a[2:3], v173 offset:1024
    ds_read_b64_tr_b16 a[4:5], v173 offset:8192
    ds_read_b64_tr_b16 a[6:7], v173 offset:9216
    ds_read_b64_tr_b16 a[8:9], v174 offset:0
    ds_read_b64_tr_b16 a[10:11], v174 offset:1024
    ds_read_b64_tr_b16 a[12:13], v174 offset:8192
    ds_read_b64_tr_b16 a[14:15], v174 offset:9216
    ds_read_b64_tr_b16 a[16:17], v173 offset:16384
    ds_read_b64_tr_b16 a[18:19], v173 offset:17408
    ds_read_b64_tr_b16 a[20:21], v173 offset:24576
    ds_read_b64_tr_b16 a[22:23], v173 offset:25600
    ds_read_b64_tr_b16 a[24:25], v174 offset:16384
    ds_read_b64_tr_b16 a[26:27], v174 offset:17408
    ds_read_b64_tr_b16 a[28:29], v174 offset:24576
    ds_read_b64_tr_b16 a[30:31], v174 offset:25600
    s_mul_i32 s78, s68, 14336
    s_add_u32 s78, s78, 114688
    s_add_u32 s79, s78, 228352
    s_add_u32 m0, s90, 32768
    s_nop 0
    buffer_load_dwordx4 v170, s[52:55], s78 offen lds
    buffer_load_dwordx4 v170, s[52:55], s79 offen offset:1024 lds
    s_add_u32 m0, s90, 40960
    s_nop 0
    buffer_load_dwordx4 v170, s[56:59], s78 offen lds
    buffer_load_dwordx4 v170, s[56:59], s79 offen offset:1024 lds
    v_add_u32 v94, 25600, v94
    v_alignbit_b32 v96, v85, v84, 16
    v_alignbit_b32 v97, v80, v85, 16
    v_alignbit_b32 v98, v81, v80, 16
    v_alignbit_b32 v99, v82, v81, 16
    v_mov_b32 v100, v85
    v_mov_b32 v101, v80
    v_mov_b32 v102, v81
    v_mov_b32 v103, v82
    v_alignbit_b32 v104, v80, v85, 16
    v_alignbit_b32 v105, v81, v80, 16
    v_alignbit_b32 v106, v82, v81, 16
    v_alignbit_b32 v107, v83, v82, 16
    ds_write_b128 v94, v[80:83] offset:32
    ds_write_b128 v94, v[96:99] offset:4192
    ds_write_b128 v94, v[100:103] offset:8352
    ds_write_b128 v94, v[104:107] offset:12512
    v_alignbit_b32 v112, v93, v92, 16
    v_alignbit_b32 v113, v88, v93, 16
    v_alignbit_b32 v114, v89, v88, 16
    v_alignbit_b32 v115, v90, v89, 16
    v_mov_b32 v116, v93
    v_mov_b32 v117, v88
    v_mov_b32 v118, v89
    v_mov_b32 v119, v90
    v_alignbit_b32 v120, v88, v93, 16
    v_alignbit_b32 v121, v89, v88, 16
    v_alignbit_b32 v122, v90, v89, 16
    v_alignbit_b32 v123, v91, v90, 16
    ds_write_b128 v94, v[88:91] offset:16672
    ds_write_b128 v94, v[112:115] offset:20832
    ds_write_b128 v94, v[116:119] offset:24992
    ds_write_b128 v94, v[120:123] offset:29152
    v_mov_b32 v128, 0
    v_mov_b32 v129, 0
    v_mov_b32 v130, 0
    v_mov_b32 v131, 0
    v_lshrrev_b32 v95, 5, v1
    v_mul_u32_u24 v95, 4608, v95
    v_and_b32 v132, 31, v1
    v_lshl_add_u32 v95, v132, 4, v95
    v_add_u32 v95, 16384, v95
    v_bfe_u32 v132, v1, 1, 3
    v_mul_u32_u24 v132, 4160, v132
    v_and_b32 v133, 1, v1
    v_lshl_add_u32 v132, v133, 4, v132
    v_add_u32 v132, 25600, v132
    ds_write_b128 v95, v[128:131]
    ds_write_b128 v132, v[128:131]
    v_and_b32 v56, 15, v1
    v_lshrrev_b32 v57, 4, v1
    v_add_u32 v58, 1, v56
    v_and_b32 v58, 3, v58
    v_mul_u32_u24 v58, 4160, v58
    v_add_u32 v59, 12, v56
    v_lshrrev_b32 v59, 2, v59
    v_lshl_add_u32 v59, v59, 3, v58
    v_lshlrev_b32 v60, 4, v57
    v_sub_u32 v59, v59, v60
    s_lshr_b32 s72, s68, 1
    s_and_b32 s73, s68, 1
    s_mul_i32 s74, s72, 16640
    s_lshl_b32 s75, s73, 8
    s_add_u32 s74, s74, s75
    s_add_u32 s74, s74, 25632
    v_add_u32 v160, s74, v59
    s_mul_i32 s74, s72, 4608
    s_sub_u32 s74, s74, s75
    s_add_u32 s74, s74, 16672
    v_lshl_add_u32 v60, v56, 5, v60
    v_add_u32 v164, s74, v60
    s_waitcnt lgkmcnt(0)
    s_lshl_b32 s72, s72, 4
    s_lshr_b32 s96, s96, s72
    s_and_b32 s96, s96, 0xffff
    s_cmp_eq_u32 s73, 0
    s_cselect_b32 s96, s96, 0
    v_lshrrev_b32 v58, 3, v56
    v_add_u32 v58, 2, v58
    v_and_b32 v59, 7, v56
    v_sub_u32 v59, 7, v59
    v_and_b32 v60, 1, v59
    v_lshlrev_b32 v60, 4, v60
    v_lshlrev_b32 v60, v60, s96
    v_lshrrev_b32 v59, 1, v59
    v_cmp_eq_u32 vcc, v58, v57
    v_mov_b32 v61, 0
    v_mov_b32 v62, 0
    v_cndmask_b32 v60, v61, v60, vcc
    v_cmp_eq_u32 vcc, 0, v59
    s_nop 1
    v_cndmask_b32 v176, v61, v60, vcc
    v_cmp_eq_u32 vcc, 1, v59
    s_nop 1
    v_cndmask_b32 v177, v61, v60, vcc
    v_cmp_eq_u32 vcc, 2, v59
    s_nop 1
    v_cndmask_b32 v178, v61, v60, vcc
    v_cmp_eq_u32 vcc, 3, v59
    s_nop 1
    v_cndmask_b32 v179, v61, v60, vcc
    v_lshrrev_b32 v56, 4, v1
    v_lshlrev_b32 v57, 2, v56
    v_xor_b32 v57, v57, v1
    v_lshlrev_b32 v57, 4, v57
    s_lshl_b32 s72, s68, 12
    v_add_u32 v212, s72, v57
    v_and_b32 v56, 3, v1
    v_lshrrev_b32 v58, 2, v1
    v_lshlrev_b32 v59, 2, v56
    v_xor_b32 v59, v58, v59
    v_lshl_add_u32 v59, v56, 4, v59
    v_lshlrev_b32 v59, 4, v59
    s_lshl_b32 s72, s68, 10
    v_add_u32 v213, s72, v59
    s_bfe_u32 s74, s94, 0x40001
    s_lshr_b32 s75, s94, 5
    s_and_b32 s76, s94, 1
    s_lshl1_add_u32 s75, s75, s76
    s_bfe_u32 s76, s74, 0x20001
    v_xor_b32 v56, s76, v56
    v_lshlrev_b32 v56, 4, v56
    v_mul_u32_u24 v58, 14336, v58
    v_add_u32 v214, v58, v56
    s_lshl_b32 s75, s75, 10
    s_lshl_b32 s74, s74, 6
    s_add_u32 s75, s75, s74
    s_mul_i32 s25, s68, 229376
    s_add_u32 s25, s25, s75
    s_add_u32 s25, s25, 3145728
    s_lshl_b32 s28, s94, 7
    s_add_u32 s28, s28, 65536
    v_mov_b32 v215, s69
    v_and_b32 v56, 31, v1
    s_lshr_b32 s72, s94, 5
    v_mad_u32_u24 v57, v56, 7, s72
    v_mul_u32_u24 v58, 2341, v57
    v_lshrrev_b32 v58, 16, v58
    v_mul_u32_u24 v59, 28, v58
    v_sub_u32 v59, v57, v59
    v_cmp_le_u32 vcc, 14, v59
    v_add_u32 v60, 2, v59
    v_mov_b32 v61, s64
    v_cndmask_b32 v59, v59, v60, vcc
    v_cmp_gt_u32 vcc, 32, v1
    s_mov_b32 s72, 4096
    s_nop 0
    v_cndmask_b32 v59, v56, v59, vcc
    v_cndmask_b32 v58, v61, v58, vcc
    v_lshl_add_u32 v56, v59, 3, v58
    v_lshlrev_b32 v56, 7, v56
    v_lshlrev_b32 v57, 4, v1
    s_add_u32 s73, s95, 1048576
    s_lshr_b32 s74, s68, 1
    s_and_b32 s75, s68, 1
    s_lshl_b32 s76, s68, 11
    s_add_u32 s73, s73, s76
    s_mul_i32 s74, s74, 4608
    s_lshl_b32 s75, s75, 11
    s_add_u32 s74, s74, s75
    s_add_u32 m0, s74, 16896
    s_mov_b32 s71, 0
L_poll_7:
    buffer_load_dwordx2 v[58:59], v56, s[40:43], s72 offen sc1
    s_add_u32 s71, s71, 1
    s_waitcnt vmcnt(0)
    v_cmp_ne_u32 vcc, s69, v58
    s_cmp_ge_u32 s71, 131072
    s_cbranch_scc1 L_polld_8
    s_and_b64 exec, exec, vcc
    s_cbranch_scc1 L_poll_7
L_polld_8:
    s_mov_b64 exec, -1
    v_cmp_ne_u32 vcc, s70, v59
    buffer_load_dwordx4 v57, s[40:43], s73 offen sc1 lds
    buffer_load_dwordx4 v57, s[40:43], s73 offen offset:1024 sc1 lds
    s_cmp_eq_u32 vcc_hi, 0
    s_cselect_b32 s101, 1, 0
    s_waitcnt vmcnt(0) lgkmcnt(0)
    s_barrier
    ds_read_b128 v[48:51], v164 offset:192
    ds_read_b128 v[52:55], v164 offset:704
    ds_read_b128 v[56:59], v164 offset:1216
    ds_read_b128 v[60:63], v164 offset:1728
    ds_read_b64 v[32:33], v160 offset:0
    ds_read_b64 v[34:35], v160 offset:8
    ds_read_b64 v[36:37], v160 offset:512
    ds_read_b64 v[38:39], v160 offset:520
    ds_read_b64 v[40:41], v160 offset:1024
    ds_read_b64 v[42:43], v160 offset:1032
    ds_read_b64 v[44:45], v160 offset:1536
    ds_read_b64 v[46:47], v160 offset:1544
    s_waitcnt lgkmcnt(11)
    v_mfma_f32_16x16x32_bf16 v[180:183], v[176:179], v[48:51], 0
    ds_read_b128 v[80:83], v164 offset:128
    ds_read_b128 v[84:87], v164 offset:640
    s_waitcnt lgkmcnt(12)
    v_mfma_f32_16x16x32_bf16 v[184:187], v[176:179], v[52:55], 0
    ds_read_b128 v[88:91], v164 offset:1152
    s_waitcnt lgkmcnt(12)
    v_mfma_f32_16x16x32_bf16 v[188:191], v[176:179], v[56:59], 0
    ds_read_b128 v[92:95], v164 offset:1664
    s_waitcnt lgkmcnt(12)
    v_mfma_f32_16x16x32_bf16 v[192:195], v[176:179], v[60:63], 0
    ds_read_b64 v[64:65], v160 offset:64
    s_waitcnt lgkmcnt(11)
    v_mfma_f32_16x16x32_bf16 v[180:183], v[32:35], v[48:51], v[180:183]
    ds_read_b64 v[66:67], v160 offset:72
    s_waitcnt lgkmcnt(10)
    v_mfma_f32_16x16x32_bf16 v[184:187], v[36:39], v[48:51], v[184:187]
    ds_read_b64 v[68:69], v160 offset:576
    ds_read_b64 v[70:71], v160 offset:584
    s_waitcnt lgkmcnt(10)
    v_mfma_f32_16x16x32_bf16 v[188:191], v[40:43], v[48:51], v[188:191]
    ds_read_b64 v[72:73], v160 offset:1088
    s_waitcnt lgkmcnt(9)
    v_mfma_f32_16x16x32_bf16 v[192:195], v[44:47], v[48:51], v[192:195]
    ds_read_b64 v[74:75], v160 offset:1096
    v_mfma_f32_16x16x32_bf16 v[184:187], v[32:35], v[52:55], v[184:187]
    ds_read_b64 v[76:77], v160 offset:1600
    v_mfma_f32_16x16x32_bf16 v[188:191], v[36:39], v[52:55], v[188:191]
    ds_read_b64 v[78:79], v160 offset:1608
    v_mfma_f32_16x16x32_bf16 v[192:195], v[40:43], v[52:55], v[192:195]
    ds_read_b128 v[112:115], v164 offset:64
    ds_read_b128 v[116:119], v164 offset:576
    v_mfma_f32_16x16x32_bf16 v[188:191], v[32:35], v[56:59], v[188:191]
    ds_read_b128 v[120:123], v164 offset:1088
    v_mfma_f32_16x16x32_bf16 v[192:195], v[36:39], v[56:59], v[192:195]
    ds_read_b128 v[124:127], v164 offset:1600
    v_mfma_f32_16x16x32_bf16 v[192:195], v[32:35], v[60:63], v[192:195]
    ds_read_b64 v[96:97], v160 offset:128
    s_waitcnt lgkmcnt(11)
    v_mfma_f32_16x16x32_bf16 v[180:183], v[64:67], v[80:83], v[180:183]
    ds_read_b64 v[98:99], v160 offset:136
    s_waitcnt lgkmcnt(10)
    v_mfma_f32_16x16x32_bf16 v[184:187], v[68:71], v[80:83], v[184:187]
    ds_read_b64 v[100:101], v160 offset:640
    ds_read_b64 v[102:103], v160 offset:648
    s_waitcnt lgkmcnt(10)
    v_mfma_f32_16x16x32_bf16 v[188:191], v[72:75], v[80:83], v[188:191]
    ds_read_b64 v[104:105], v160 offset:1152
    s_waitcnt lgkmcnt(9)
    v_mfma_f32_16x16x32_bf16 v[192:195], v[76:79], v[80:83], v[192:195]
    ds_read_b64 v[106:107], v160 offset:1160
    v_mfma_f32_16x16x32_bf16 v[184:187], v[64:67], v[84:87], v[184:187]
    ds_read_b64 v[108:109], v160 offset:1664
    v_mfma_f32_16x16x32_bf16 v[188:191], v[68:71], v[84:87], v[188:191]
    ds_read_b64 v[110:111], v160 offset:1672
    v_mfma_f32_16x16x32_bf16 v[192:195], v[72:75], v[84:87], v[192:195]
    ds_read_b128 v[144:147], v164 offset:0
    ds_read_b128 v[148:151], v164 offset:512
    v_mfma_f32_16x16x32_bf16 v[188:191], v[64:67], v[88:91], v[188:191]
    ds_read_b128 v[152:155], v164 offset:1024
    v_mfma_f32_16x16x32_bf16 v[192:195], v[68:71], v[88:91], v[192:195]
    ds_read_b128 v[156:159], v164 offset:1536
    v_mfma_f32_16x16x32_bf16 v[192:195], v[64:67], v[92:95], v[192:195]
    ds_read_b64 v[128:129], v160 offset:192
    s_waitcnt lgkmcnt(11)
    v_mfma_f32_16x16x32_bf16 v[180:183], v[96:99], v[112:115], v[180:183]
    ds_read_b64 v[130:131], v160 offset:200
    s_waitcnt lgkmcnt(10)
    v_mfma_f32_16x16x32_bf16 v[184:187], v[100:103], v[112:115], v[184:187]
    ds_read_b64 v[132:133], v160 offset:704
    ds_read_b64 v[134:135], v160 offset:712
    s_waitcnt lgkmcnt(10)
    v_mfma_f32_16x16x32_bf16 v[188:191], v[104:107], v[112:115], v[188:191]
    ds_read_b64 v[136:137], v160 offset:1216
    s_waitcnt lgkmcnt(9)
    v_mfma_f32_16x16x32_bf16 v[192:195], v[108:111], v[112:115], v[192:195]
    ds_read_b64 v[138:139], v160 offset:1224
    v_mfma_f32_16x16x32_bf16 v[184:187], v[96:99], v[116:119], v[184:187]
    ds_read_b64 v[140:141], v160 offset:1728
    v_mfma_f32_16x16x32_bf16 v[188:191], v[100:103], v[116:119], v[188:191]
    ds_read_b64 v[142:143], v160 offset:1736
    v_mfma_f32_16x16x32_bf16 v[192:195], v[104:107], v[116:119], v[192:195]
    v_mfma_f32_16x16x32_bf16 v[188:191], v[96:99], v[120:123], v[188:191]
    v_mfma_f32_16x16x32_bf16 v[192:195], v[100:103], v[120:123], v[192:195]
    v_mfma_f32_16x16x32_bf16 v[192:195], v[96:99], v[124:127], v[192:195]
    s_waitcnt lgkmcnt(6)
    v_mfma_f32_16x16x32_bf16 v[180:183], v[128:131], v[144:147], v[180:183]
    s_waitcnt lgkmcnt(4)
    v_mfma_f32_16x16x32_bf16 v[184:187], v[132:135], v[144:147], v[184:187]
    s_waitcnt lgkmcnt(2)
    v_mfma_f32_16x16x32_bf16 v[188:191], v[136:139], v[144:147], v[188:191]
    s_waitcnt lgkmcnt(0)
    v_mfma_f32_16x16x32_bf16 v[192:195], v[140:143], v[144:147], v[192:195]
    v_mfma_f32_16x16x32_bf16 v[184:187], v[128:131], v[148:151], v[184:187]
    v_mfma_f32_16x16x32_bf16 v[188:191], v[132:135], v[148:151], v[188:191]
    v_mfma_f32_16x16x32_bf16 v[192:195], v[136:139], v[148:151], v[192:195]
    v_mfma_f32_16x16x32_bf16 v[188:191], v[128:131], v[152:155], v[188:191]
    v_mfma_f32_16x16x32_bf16 v[192:195], v[132:135], v[152:155], v[192:195]
    v_mfma_f32_16x16x32_bf16 v[192:195], v[128:131], v[156:159], v[192:195]
    ds_read_b128 v[64:67], v164 offset:192
    ds_read_b128 v[68:71], v164 offset:704
    ds_read_b128 v[72:75], v164 offset:1216
    ds_read_b128 v[76:79], v164 offset:1728
    s_nop 1
    ds_write_b128 v212, v[180:183] offset:0
    ds_write_b128 v212, v[184:187] offset:1024
    ds_write_b128 v212, v[188:191] offset:2048
    ds_write_b128 v212, v[192:195] offset:3072
    s_mul_i32 s0, s68, 14336
    s_add_u32 s0, s0, 172032
    s_add_u32 s1, s0, 228352
    s_add_u32 s3, s90, 49152
    s_mul_i32 s14, s68, 14336
    s_add_u32 s14, s14, 458752
    s_add_u32 s15, s14, 228352
    s_add_u32 s24, s90, 65536
    ds_read_b64 v[32:33], v160 offset:0
    ds_read_b64 v[34:35], v160 offset:8
    ds_read_b64 v[36:37], v160 offset:512
    ds_read_b64 v[38:39], v160 offset:520
    ds_read_b64 v[40:41], v160 offset:1024
    ds_read_b64 v[42:43], v160 offset:1032
    ds_read_b64 v[44:45], v160 offset:1536
    ds_read_b64 v[46:47], v160 offset:1544
    s_waitcnt lgkmcnt(8)
    s_barrier
    ds_read_b128 v[216:219], v213 offset:0
    ds_read_b128 v[220:223], v213 offset:4096
    ds_read_b128 v[224:227], v213 offset:8192
    ds_read_b128 v[228:231], v213 offset:12288
    ds_read_b128 v[80:83], v164 offset:2240
    ds_read_b128 v[84:87], v164 offset:2752
    ds_read_b128 v[88:91], v164 offset:3264
    ds_read_b128 v[92:95], v164 offset:3776
    ds_read_b64 v[48:49], v160 offset:2048
    ds_read_b64 v[50:51], v160 offset:2056
    ds_read_b64 v[52:53], v160 offset:2560
    ds_read_b64 v[54:55], v160 offset:2568
    ds_read_b64 v[56:57], v160 offset:3072
    ds_read_b64 v[58:59], v160 offset:3080
    ds_read_b64 v[60:61], v160 offset:3584
    ds_read_b64 v[62:63], v160 offset:3592
    s_waitcnt lgkmcnt(14)
    v_add_f32 v216, v216, v220
    v_add_f32 v217, v217, v221
    v_add_f32 v218, v218, v222
    v_add_f32 v219, v219, v223
    s_waitcnt lgkmcnt(12)
    v_add_f32 v224, v224, v228
    v_add_f32 v225, v225, v229
    v_add_f32 v226, v226, v230
    v_add_f32 v227, v227, v231
    v_cvt_pk_bf16_f32 v216, v216, v224
    v_cvt_pk_bf16_f32 v217, v217, v225
    v_cvt_pk_bf16_f32 v218, v218, v226
    v_cvt_pk_bf16_f32 v219, v219, v227
    buffer_store_dwordx4 v[216:219], v214, s[40:43], s25 offen sc1
    s_waitcnt lgkmcnt(11)
    v_mfma_f32_16x16x32_bf16 v[196:199], v[176:179], v[80:83], 0
    s_waitcnt lgkmcnt(10)
    v_mfma_f32_16x16x32_bf16 v[200:203], v[176:179], v[84:87], 0
    s_waitcnt lgkmcnt(9)
    v_mfma_f32_16x16x32_bf16 v[204:207], v[176:179], v[88:91], 0
    s_waitcnt lgkmcnt(8)
    v_mfma_f32_16x16x32_bf16 v[208:211], v[176:179], v[92:95], 0
    ds_read_b64_tr_b16 a[32:33], v173 offset:32768
    ds_read_b64_tr_b16 a[34:35], v173 offset:33792
    ds_read_b64_tr_b16 a[36:37], v173 offset:40960
    ds_read_b64_tr_b16 a[38:39], v173 offset:41984
    ds_read_b64_tr_b16 a[40:41], v174 offset:32768
    ds_read_b64_tr_b16 a[42:43], v174 offset:33792
    ds_read_b64_tr_b16 a[44:45], v174 offset:40960
    ds_read_b64_tr_b16 a[46:47], v174 offset:41984
    s_mov_b32 s77, 0
    s_mov_b64 vcc, -1
    s_add_u32 s25, s25, 917504
L_conv_22:
    s_waitcnt lgkmcnt(0)
    v_mfma_f32_16x16x32_bf16 v[196:199], v[48:51], v[64:67], v[196:199]
    ds_read_b64 v[112:113], v160 offset:2112
    v_mfma_f32_16x16x32_bf16 v[200:203], v[52:55], v[64:67], v[200:203]
    ds_read_b64 v[114:115], v160 offset:2120
    v_mfma_f32_16x16x32_bf16 v[204:207], v[56:59], v[64:67], v[204:207]
    ds_read_b64 v[116:117], v160 offset:2624
    v_mfma_f32_16x16x32_bf16 v[208:211], v[60:63], v[64:67], v[208:211]
    ds_read_b64 v[118:119], v160 offset:2632
    s_mov_b32 m0, s3
    s_nop 0
    buffer_load_dwordx4 v170, s[52:55], s0 offen lds
    v_mfma_f32_16x16x32_bf16 v[196:199], v[44:47], v[68:71], v[196:199]
    ds_read_b64 v[120:121], v160 offset:3136
    v_mfma_f32_16x16x32_bf16 v[200:203], v[48:51], v[68:71], v[200:203]
    ds_read_b64 v[122:123], v160 offset:3144
    v_mfma_f32_16x16x32_bf16 v[204:207], v[52:55], v[68:71], v[204:207]
    ds_read_b64 v[124:125], v160 offset:3648
    v_mfma_f32_16x16x32_bf16 v[208:211], v[56:59], v[68:71], v[208:211]
    ds_read_b64 v[126:127], v160 offset:3656
    v_mfma_f32_16x16x32_bf16 v[196:199], v[40:43], v[72:75], v[196:199]
    ds_read_b128 v[128:131], v164 offset:128
    v_mfma_f32_16x16x32_bf16 v[200:203], v[44:47], v[72:75], v[200:203]
    ds_read_b64 v[96:97], v160 offset:64
    buffer_load_dwordx4 v170, s[52:55], s1 offen offset:1024 lds
    v_mfma_f32_16x16x32_bf16 v[204:207], v[48:51], v[72:75], v[204:207]
    ds_read_b64 v[98:99], v160 offset:72
    v_mfma_f32_16x16x32_bf16 v[208:211], v[52:55], v[72:75], v[208:211]
    ds_read_b64 v[100:101], v160 offset:576
    v_mfma_f32_16x16x32_bf16 v[196:199], v[36:39], v[76:79], v[196:199]
    ds_read_b64 v[102:103], v160 offset:584
    v_mfma_f32_16x16x32_bf16 v[200:203], v[40:43], v[76:79], v[200:203]
    ds_read_b64 v[104:105], v160 offset:1088
    v_mfma_f32_16x16x32_bf16 v[204:207], v[44:47], v[76:79], v[204:207]
    ds_read_b64 v[106:107], v160 offset:1096
    v_mfma_f32_16x16x32_bf16 v[208:211], v[48:51], v[76:79], v[208:211]
    ds_read_b64 v[108:109], v160 offset:1600
    s_add_u32 m0, s3, 8192
    s_nop 0
    buffer_load_dwordx4 v170, s[56:59], s0 offen lds
    v_mfma_f32_16x16x32_bf16 v[196:199], v[32:35], v[80:83], v[196:199]
    ds_read_b64 v[110:111], v160 offset:1608
    v_mfma_f32_16x16x32_bf16 v[200:203], v[36:39], v[80:83], v[200:203]
    ds_read_b128 v[132:135], v164 offset:640
    v_mfma_f32_16x16x32_bf16 v[204:207], v[40:43], v[80:83], v[204:207]
    ds_read_b128 v[136:139], v164 offset:1152
    v_mfma_f32_16x16x32_bf16 v[208:211], v[44:47], v[80:83], v[208:211]
    ds_read_b128 v[140:143], v164 offset:1664
    v_mfma_f32_16x16x32_bf16 v[200:203], v[32:35], v[84:87], v[200:203]
    ds_read_b128 v[144:147], v164 offset:2176
    v_mfma_f32_16x16x32_bf16 v[204:207], v[36:39], v[84:87], v[204:207]
    ds_read_b128 v[148:151], v164 offset:2688
    buffer_load_dwordx4 v170, s[56:59], s1 offen offset:1024 lds
    v_mfma_f32_16x16x32_bf16 v[208:211], v[40:43], v[84:87], v[208:211]
    ds_read_b128 v[152:155], v164 offset:3200
    v_mfma_f32_16x16x32_bf16 v[204:207], v[32:35], v[88:91], v[204:207]
    ds_read_b128 v[156:159], v164 offset:3712
    v_mfma_f32_16x16x32_bf16 v[208:211], v[36:39], v[88:91], v[208:211]
    v_mfma_f32_16x16x32_bf16 v[208:211], v[32:35], v[92:95], v[208:211]
    s_cmp_lg_u32 s77, 0
    s_cbranch_scc1 L_f1_17
    s_waitcnt vmcnt(4)
    s_barrier
    s_cmp_lg_u32 s68, 0
    s_cbranch_scc1 L_f1_17
    buffer_store_dword v215, off, s[40:43], s28 sc1
L_f1_17:
    s_waitcnt lgkmcnt(14)
    v_mfma_f32_16x16x32_bf16 v[196:199], v[112:115], v[128:131], v[196:199]
    ds_read_b64 v[48:49], v160 offset:2176
    v_mfma_f32_16x16x32_bf16 v[200:203], v[116:119], v[128:131], v[200:203]
    ds_read_b64 v[50:51], v160 offset:2184
    v_mfma_f32_16x16x32_bf16 v[204:207], v[120:123], v[128:131], v[204:207]
    ds_read_b64 v[52:53], v160 offset:2688
    s_mov_b32 m0, s24
    s_nop 0
    buffer_load_dwordx4 v170, s[52:55], s14 offen lds
    v_mfma_f32_16x16x32_bf16 v[208:211], v[124:127], v[128:131], v[208:211]
    ds_read_b64 v[54:55], v160 offset:2696
    s_waitcnt lgkmcnt(10)
    v_mfma_f32_16x16x32_bf16 v[196:199], v[108:111], v[132:135], v[196:199]
    ds_read_b64 v[56:57], v160 offset:3200
    v_mfma_f32_16x16x32_bf16 v[200:203], v[112:115], v[132:135], v[200:203]
    ds_read_b64 v[58:59], v160 offset:3208
    v_mfma_f32_16x16x32_bf16 v[204:207], v[116:119], v[132:135], v[204:207]
    ds_read_b64 v[60:61], v160 offset:3712
    v_mfma_f32_16x16x32_bf16 v[208:211], v[120:123], v[132:135], v[208:211]
    ds_read_b64 v[62:63], v160 offset:3720
    s_waitcnt lgkmcnt(13)
    v_mfma_f32_16x16x32_bf16 v[196:199], v[104:107], v[136:139], v[196:199]
    ds_read_b128 v[64:67], v164 offset:64
    buffer_load_dwordx4 v170, s[52:55], s15 offen offset:1024 lds
    v_mfma_f32_16x16x32_bf16 v[200:203], v[108:111], v[136:139], v[200:203]
    ds_read_b64 v[32:33], v160 offset:128
    v_mfma_f32_16x16x32_bf16 v[204:207], v[112:115], v[136:139], v[204:207]
    ds_read_b64 v[34:35], v160 offset:136
    v_mfma_f32_16x16x32_bf16 v[208:211], v[116:119], v[136:139], v[208:211]
    ds_read_b64 v[36:37], v160 offset:640
    s_waitcnt lgkmcnt(14)
    v_mfma_f32_16x16x32_bf16 v[196:199], v[100:103], v[140:143], v[196:199]
    ds_read_b64 v[38:39], v160 offset:648
    v_mfma_f32_16x16x32_bf16 v[200:203], v[104:107], v[140:143], v[200:203]
    ds_read_b64 v[40:41], v160 offset:1152
    v_mfma_f32_16x16x32_bf16 v[204:207], v[108:111], v[140:143], v[204:207]
    ds_read_b64 v[42:43], v160 offset:1160
    s_add_u32 m0, s24, 8192
    s_nop 0
    buffer_load_dwordx4 v170, s[56:59], s14 offen lds
    v_mfma_f32_16x16x32_bf16 v[208:211], v[112:115], v[140:143], v[208:211]
    ds_read_b64 v[44:45], v160 offset:1664
    v_mfma_f32_16x16x32_bf16 v[196:199], v[96:99], v[144:147], v[196:199]
    ds_read_b64 v[46:47], v160 offset:1672
    v_mfma_f32_16x16x32_bf16 v[200:203], v[100:103], v[144:147], v[200:203]
    ds_read_b128 v[68:71], v164 offset:576
    v_mfma_f32_16x16x32_bf16 v[204:207], v[104:107], v[144:147], v[204:207]
    ds_read_b128 v[72:75], v164 offset:1088
    v_mfma_f32_16x16x32_bf16 v[208:211], v[108:111], v[144:147], v[208:211]
    ds_read_b128 v[76:79], v164 offset:1600
    v_mfma_f32_16x16x32_bf16 v[200:203], v[96:99], v[148:151], v[200:203]
    ds_read_b128 v[80:83], v164 offset:2112
    buffer_load_dwordx4 v170, s[56:59], s15 offen offset:1024 lds
    v_mfma_f32_16x16x32_bf16 v[204:207], v[100:103], v[148:151], v[204:207]
    ds_read_b128 v[84:87], v164 offset:2624
    v_mfma_f32_16x16x32_bf16 v[208:211], v[104:107], v[148:151], v[208:211]
    ds_read_b128 v[88:91], v164 offset:3136
    s_waitcnt lgkmcnt(14)
    v_mfma_f32_16x16x32_bf16 v[204:207], v[96:99], v[152:155], v[204:207]
    ds_read_b128 v[92:95], v164 offset:3648
    v_mfma_f32_16x16x32_bf16 v[208:211], v[100:103], v[152:155], v[208:211]
    v_add_u32 v160, 128, v160
    v_mfma_f32_16x16x32_bf16 v[208:211], v[96:99], v[156:159], v[208:211]
    v_subrev_u32 v164, 128, v164
    s_add_u32 s77, s77, 1
    s_cmp_eq_u32 s77, 2
    s_cbranch_scc1 L_convx_23
    s_mov_b64 vcc, 0
    s_mul_i32 s0, s68, 14336
    s_add_u32 s0, s0, 516096
    s_add_u32 s1, s0, 228352
    s_add_u32 s3, s90, 81920
    s_mul_i32 s14, s68, 14336
    s_add_u32 s14, s14, 573440
    s_add_u32 s15, s14, 228352
    s_add_u32 s24, s90, 0
    s_branch L_conv_22
L_convx_23:
    s_nop 4
    ds_write_b128 v212, v[196:199] offset:0
    ds_write_b128 v212, v[200:203] offset:1024
    ds_write_b128 v212, v[204:207] offset:2048
    ds_write_b128 v212, v[208:211] offset:3072
    s_waitcnt vmcnt(8) lgkmcnt(0)
    s_barrier
    ds_read_b128 v[216:219], v213 offset:0
    ds_read_b128 v[220:223], v213 offset:4096
    ds_read_b128 v[224:227], v213 offset:8192
    ds_read_b128 v[228:231], v213 offset:12288
    s_waitcnt lgkmcnt(2)
    v_add_f32 v216, v216, v220
    v_add_f32 v217, v217, v221
    v_add_f32 v218, v218, v222
    v_add_f32 v219, v219, v223
    s_waitcnt lgkmcnt(0)
    v_add_f32 v224, v224, v228
    v_add_f32 v225, v225, v229
    v_add_f32 v226, v226, v230
    v_add_f32 v227, v227, v231
    v_cvt_pk_bf16_f32 v216, v216, v224
    v_cvt_pk_bf16_f32 v217, v217, v225
    v_cvt_pk_bf16_f32 v218, v218, v226
    v_cvt_pk_bf16_f32 v219, v219, v227
    buffer_store_dwordx4 v[216:219], v214, s[40:43], s25 offen sc1
    ds_read_b64_tr_b16 a[48:49], v173 offset:49152
    ds_read_b64_tr_b16 a[50:51], v173 offset:50176
    ds_read_b64_tr_b16 a[52:53], v173 offset:57344
    ds_read_b64_tr_b16 a[54:55], v173 offset:58368
    ds_read_b64_tr_b16 a[56:57], v174 offset:49152
    ds_read_b64_tr_b16 a[58:59], v174 offset:50176
    ds_read_b64_tr_b16 a[60:61], v174 offset:57344
    ds_read_b64_tr_b16 a[62:63], v174 offset:58368
    ds_read_b64_tr_b16 a[64:65], v165 offset:0
    ds_read_b64_tr_b16 a[66:67], v165 offset:1024
    ds_read_b64_tr_b16 a[68:69], v165 offset:8192
    ds_read_b64_tr_b16 a[70:71], v165 offset:9216
    ds_read_b64_tr_b16 a[72:73], v166 offset:0
    ds_read_b64_tr_b16 a[74:75], v166 offset:1024
    ds_read_b64_tr_b16 a[76:77], v166 offset:8192
    ds_read_b64_tr_b16 a[78:79], v166 offset:9216
    s_mul_i32 s78, s68, 14336
    s_add_u32 s78, s78, 630784
    s_add_u32 s79, s78, 228352
    s_add_u32 m0, s90, 16384
    s_nop 0
    buffer_load_dwordx4 v170, s[52:55], s78 offen lds
    buffer_load_dwordx4 v170, s[52:55], s79 offen offset:1024 lds
    s_add_u32 m0, s90, 24576
    s_nop 0
    buffer_load_dwordx4 v170, s[56:59], s78 offen lds
    buffer_load_dwordx4 v170, s[56:59], s79 offen offset:1024 lds
    s_mul_i32 s78, s68, 14336
    s_add_u32 s78, s78, 917504
    s_add_u32 s79, s78, 228352
    s_add_u32 m0, s90, 32768
    s_nop 0
    buffer_load_dwordx4 v170, s[52:55], s78 offen lds
    buffer_load_dwordx4 v170, s[52:55], s79 offen offset:1024 lds
    s_add_u32 m0, s90, 40960
    s_nop 0
    buffer_load_dwordx4 v170, s[56:59], s78 offen lds
    buffer_load_dwordx4 v170, s[56:59], s79 offen offset:1024 lds
    v_lshlrev_b32 v69, 4, v1
    v_bfe_u32 v80, v1, 2, 2
    v_and_b32 v81, 1, v80
    v_lshrrev_b32 v82, 4, v1
    v_lshlrev_b32 v81, 1, v81
    v_xor_b32 v82, v82, v81
    v_mul_u32_u24 v80, 3584, v80
    v_lshl_add_u32 v80, v82, 6, v80
    v_and_b32 v81, 3, v1
    v_lshl_add_u32 v64, v81, 4, v80
    s_lshl_b32 s73, s68, 10
    s_add_u32 s74, s73, 32768
    v_add_u32 v68, s74, v69
    v_xor_b32 v65, 1024, v68
    v_xor_b32 v66, 2048, v68
    v_xor_b32 v67, 3072, v68
    s_mul_i32 s74, s68, 13
    s_add_u32 s74, s74, 3
    s_lshr_b32 s74, s74, 2
    s_lshl_b32 s96, s74, 10
    v_add_u32 v70, s96, v69
    s_mul_i32 s74, s68, 7168
    v_add_u32 v71, s74, v69
    s_lshl_b32 s74, s66, 1
    s_add_u32 s74, s74, s98
    s_mul_i32 s93, s74, 57344
    s_add_u32 s93, s93, 1048576
    s_lshl_b32 s74, s99, 12
    s_add_u32 s74, s74, s73
    s_add_u32 s92, s93, s74
    s_mul_i32 s94, s66, 114688
    s_mul_i32 s74, s98, 14336
    s_add_u32 s94, s94, s74
    s_add_u32 s94, s94, 5242880
    s_mul_i32 s95, s66, 28672
    s_add_u32 s95, s95, 3145728
    s_lshl_b32 s81, s66, 11
    s_add_u32 s81, s81, 131072
    s_lshl_b32 s74, s67, 7
    s_add_u32 s80, s81, s74
    s_lshl_b32 s74, s68, 3
    s_add_u32 s80, s80, s74
    v_and_b32 v80, 7, v1
    v_lshlrev_b32 v80, 2, v80
    v_add_u32 v74, 1792, v80
    v_and_b32 v81, 3, v1
    v_bfe_u32 v82, v1, 2, 3
    v_min_u32 v82, 6, v82
    s_mul_i32 s74, s98, 7
    v_add_u32 v82, s74, v82
    v_lshlrev_b32 v82, 7, v82
    v_lshl_add_u32 v82, v81, 3, v82
    v_cmp_gt_u32 vcc, 32, v1
    v_mov_b32 v83, s69
    v_add_u32 v84, 3, v83
    v_cndmask_b32 v78, v74, v82, vcc
    v_cndmask_b32 v79, v84, v83, vcc
    s_lshl_b32 s74, s68, 7
    s_lshl_b32 s75, s99, 11
    s_add_u32 s74, s74, s75
    v_lshrrev_b32 v82, 4, v1
    v_lshl_add_u32 v82, v82, 5, s74
    v_bfe_u32 v85, v1, 2, 2
    v_lshl_add_u32 v85, v85, 9, v82
    v_lshl_add_u32 v72, v81, 3, v85
    v_mul_u32_u24 v86, 28672, v81
    v_add_u32 v77, v86, v85
    v_bfe_u32 v86, v1, 3, 1
    v_mul_u32_u24 v86, 28672, v86
    v_lshl_add_u32 v86, v80, 5, v86
    v_bfe_u32 v87, v1, 4, 1
    v_mul_u32_u24 v87, 6291456, v87
    v_add_u32 v76, v86, v87
    v_mov_b32 v73, s69
    s_mov_b32 s88, s69
    s_mov_b32 s30, 0
    s_mov_b32 s100, 0
    s_mov_b32 s31, s95
    s_mov_b32 s89, 0
    s_mov_b32 s97, 0
    v_and_b32 v160, 31, v74
    v_add_u32 v160, 1792, v160
    s_waitcnt vmcnt(8) lgkmcnt(0)
    s_barrier
    s_cmp_lg_u32 s68, 0
    s_cbranch_scc1 L_bf_25
    buffer_store_dword v215, off, s[40:43], s28 offset:4 sc1
L_bf_25:
    s_mul_i32 s78, s68, 14336
    s_add_u32 s78, s78, 974848
    s_add_u32 s79, s78, 228352
    s_add_u32 m0, s90, 49152
    s_nop 0
    buffer_load_dwordx4 v170, s[52:55], s78 offen lds
    buffer_load_dwordx4 v170, s[52:55], s79 offen offset:1024 lds
    s_add_u32 m0, s90, 57344
    s_nop 0
    buffer_load_dwordx4 v170, s[56:59], s78 offen lds
    buffer_load_dwordx4 v170, s[56:59], s79 offen offset:1024 lds
    s_mul_i32 s78, s68, 14336
    s_add_u32 s78, s78, 1032192
    s_add_u32 s79, s78, 228352
    s_add_u32 m0, s90, 65536
    s_nop 0
    buffer_load_dwordx4 v170, s[52:55], s78 offen lds
    buffer_load_dwordx4 v170, s[52:55], s79 offen offset:1024 lds
    s_add_u32 m0, s90, 73728
    s_nop 0
    buffer_load_dwordx4 v170, s[56:59], s78 offen lds
    buffer_load_dwordx4 v170, s[56:59], s79 offen offset:1024 lds
    ds_read_b64_tr_b16 a[80:81], v165 offset:16384
    ds_read_b64_tr_b16 a[82:83], v165 offset:17408
    ds_read_b64_tr_b16 a[84:85], v165 offset:24576
    ds_read_b64_tr_b16 a[86:87], v165 offset:25600
    ds_read_b64_tr_b16 a[88:89], v166 offset:16384
    ds_read_b64_tr_b16 a[90:91], v166 offset:17408
    ds_read_b64_tr_b16 a[92:93], v166 offset:24576
    ds_read_b64_tr_b16 a[94:95], v166 offset:25600
    ds_read_b64_tr_b16 a[96:97], v173 offset:0
    ds_read_b64_tr_b16 a[98:99], v173 offset:1024
    ds_read_b64_tr_b16 a[100:101], v173 offset:8192
    ds_read_b64_tr_b16 a[102:103], v173 offset:9216
    ds_read_b64_tr_b16 a[104:105], v174 offset:0
    ds_read_b64_tr_b16 a[106:107], v174 offset:1024
    ds_read_b64_tr_b16 a[108:109], v174 offset:8192
    ds_read_b64_tr_b16 a[110:111], v174 offset:9216
    s_waitcnt vmcnt(12) lgkmcnt(0)
    s_barrier
    s_mul_i32 s78, s68, 14336
    s_add_u32 s78, s78, 1089536
    s_add_u32 s79, s78, 228352
    s_add_u32 m0, s90, 81920
    s_nop 0
    buffer_load_dwordx4 v170, s[52:55], s78 offen lds
    buffer_load_dwordx4 v170, s[52:55], s79 offen offset:1024 lds
    s_add_u32 m0, s90, 90112
    s_nop 0
    buffer_load_dwordx4 v170, s[56:59], s78 offen lds
    buffer_load_dwordx4 v170, s[56:59], s79 offen offset:1024 lds
    s_mul_i32 s78, s68, 28672
    s_add_u32 s78, s78, 1376256
    s_add_u32 s79, s78, 13312
    s_add_u32 m0, s90, 0
    s_nop 0
    buffer_load_dwordx4 v170, s[52:55], s78 offen lds
    buffer_load_dwordx4 v170, s[52:55], s79 offen offset:1024 lds
    s_add_u32 m0, s90, 8192
    s_nop 0
    buffer_load_dwordx4 v170, s[56:59], s78 offen lds
    buffer_load_dwordx4 v170, s[56:59], s79 offen offset:1024 lds
    buffer_load_dword v75, v76, s[40:43], s92 offen sc1
    buffer_load_dword v75, v78, s[40:43], s81 offen sc1
    ds_read_b64_tr_b16 a[112:113], v173 offset:16384
    ds_read_b64_tr_b16 a[114:115], v173 offset:17408
    ds_read_b64_tr_b16 a[116:117], v173 offset:24576
    ds_read_b64_tr_b16 a[118:119], v173 offset:25600
    ds_read_b64_tr_b16 a[120:121], v174 offset:16384
    ds_read_b64_tr_b16 a[122:123], v174 offset:17408
    ds_read_b64_tr_b16 a[124:125], v174 offset:24576
    ds_read_b64_tr_b16 a[126:127], v174 offset:25600
    s_waitcnt vmcnt(18) lgkmcnt(0)
    s_barrier
    s_mul_i32 s78, s68, 28672
    s_add_u32 s78, s78, 1490944
    s_add_u32 s79, s78, 13312
    s_add_u32 m0, s90, 16384
    s_nop 0
    buffer_load_dwordx4 v170, s[52:55], s78 offen lds
    buffer_load_dwordx4 v170, s[52:55], s79 offen offset:1024 lds
    s_add_u32 m0, s90, 24576
    s_nop 0
    buffer_load_dwordx4 v170, s[56:59], s78 offen lds
    buffer_load_dwordx4 v170, s[56:59], s79 offen offset:1024 lds
    ds_read_b64_tr_b16 a[128:129], v173 offset:32768
    ds_read_b64_tr_b16 a[130:131], v173 offset:33792
    ds_read_b64_tr_b16 a[132:133], v173 offset:40960
    ds_read_b64_tr_b16 a[134:135], v173 offset:41984
    ds_read_b64_tr_b16 a[136:137], v174 offset:32768
    ds_read_b64_tr_b16 a[138:139], v174 offset:33792
    ds_read_b64_tr_b16 a[140:141], v174 offset:40960
    ds_read_b64_tr_b16 a[142:143], v174 offset:41984
    s_waitcnt vmcnt(18) lgkmcnt(0)
    s_barrier
    s_add_u32 m0, s91, 32768
    s_mov_b32 s78, 0
    buffer_load_dwordx4 v172, s[60:63], s78 offen offset:0 lds
    s_mov_b32 s78, 6144
    buffer_load_dwordx4 v172, s[60:63], s78 offen offset:1024 lds
    s_mov_b32 s78, 12288
    buffer_load_dwordx4 v172, s[60:63], s78 offen offset:2048 lds
    s_mov_b32 s78, 18432
    buffer_load_dwordx4 v172, s[60:63], s78 offen offset:3072 lds
    ds_read_b64_tr_b16 a[144:145], v173 offset:49152
    ds_read_b64_tr_b16 a[146:147], v173 offset:50176
    ds_read_b64_tr_b16 a[148:149], v173 offset:57344
    ds_read_b64_tr_b16 a[150:151], v173 offset:58368
    ds_read_b64_tr_b16 a[152:153], v174 offset:49152
    ds_read_b64_tr_b16 a[154:155], v174 offset:50176
    ds_read_b64_tr_b16 a[156:157], v174 offset:57344
    ds_read_b64_tr_b16 a[158:159], v174 offset:58368
    s_waitcnt vmcnt(18) lgkmcnt(0)
    s_barrier
    ds_read_b64_tr_b16 a[160:161], v165 offset:0
    ds_read_b64_tr_b16 a[162:163], v165 offset:1024
    ds_read_b64_tr_b16 a[164:165], v165 offset:8192
    ds_read_b64_tr_b16 a[166:167], v165 offset:9216
    ds_read_b64_tr_b16 a[168:169], v166 offset:0
    ds_read_b64_tr_b16 a[170:171], v166 offset:1024
    ds_read_b64_tr_b16 a[172:173], v166 offset:8192
    ds_read_b64_tr_b16 a[174:175], v166 offset:9216
    s_waitcnt vmcnt(14) lgkmcnt(0)
    s_barrier
    ds_read_b64_tr_b16 a[176:177], v165 offset:16384
    ds_read_b64_tr_b16 a[178:179], v165 offset:17408
    ds_read_b64_tr_b16 a[180:181], v165 offset:24576
    ds_read_b64_tr_b16 a[182:183], v165 offset:25600
    ds_read_b64_tr_b16 a[184:185], v166 offset:16384
    ds_read_b64_tr_b16 a[186:187], v166 offset:17408
    ds_read_b64_tr_b16 a[188:189], v166 offset:24576
    ds_read_b64_tr_b16 a[190:191], v166 offset:25600
    s_waitcnt vmcnt(10) lgkmcnt(0)
    s_barrier
    ds_read_b64_tr_b16 a[192:193], v173 offset:0
    ds_read_b64_tr_b16 a[194:195], v173 offset:1024
    ds_read_b64_tr_b16 a[196:197], v173 offset:8192
    ds_read_b64_tr_b16 a[198:199], v173 offset:9216
    ds_read_b64_tr_b16 a[200:201], v174 offset:0
    ds_read_b64_tr_b16 a[202:203], v174 offset:1024
    ds_read_b64_tr_b16 a[204:205], v174 offset:8192
    ds_read_b64_tr_b16 a[206:207], v174 offset:9216
    s_waitcnt vmcnt(4) lgkmcnt(0)
    s_barrier
    ds_read_b64_tr_b16 a[208:209], v173 offset:16384
    ds_read_b64_tr_b16 a[210:211], v173 offset:17408
    ds_read_b64_tr_b16 a[212:213], v173 offset:24576
    ds_read_b64_tr_b16 a[214:215], v173 offset:25600
    ds_read_b64_tr_b16 a[216:217], v174 offset:16384
    ds_read_b64_tr_b16 a[218:219], v174 offset:17408
    ds_read_b64_tr_b16 a[220:221], v174 offset:24576
    ds_read_b64_tr_b16 a[222:223], v174 offset:25600
    s_waitcnt lgkmcnt(0)
    s_cmp_eq_u32 s101, 0
    s_cbranch_scc1 L_slow_26
    s_mov_b32 s72, s92
    s_mov_b32 s71, 0
L_wp_28:
    buffer_load_dword v75, v160, s[40:43], s81 offen sc1
    s_waitcnt vmcnt(0)
    v_subrev_u32 v75, s88, v75
    v_cmp_le_u32 vcc, 64, v75
    s_add_u32 s71, s71, 1
    s_cmp_eq_u64 vcc, 0
    s_cbranch_scc1 L_wpd_29
    s_cmp_lt_u32 s71, 131072
    s_cbranch_scc1 L_wp_28
L_wpd_29:
    s_add_u32 m0, s96, 0
    s_nop 0
    buffer_load_dwordx4 v70, s[40:43], s31 offen offset:0 sc1 lds
    buffer_load_dwordx4 v70, s[40:43], s31 offen offset:1024 sc1 lds
    buffer_load_dwordx4 v70, s[40:43], s31 offen offset:2048 sc1 lds
    buffer_load_dwordx4 v70, s[40:43], s31 offen offset:3072 sc1 lds
    s_add_u32 m0, s96, 14336
    s_add_u32 s79, s31, 14336
    buffer_load_dwordx4 v70, s[40:43], s79 offen offset:0 sc1 lds
    buffer_load_dwordx4 v70, s[40:43], s79 offen offset:1024 sc1 lds
    buffer_load_dwordx4 v70, s[40:43], s79 offen offset:2048 sc1 lds
    buffer_load_dwordx4 v70, s[40:43], s79 offen offset:3072 sc1 lds
L_got_27:
    s_waitcnt vmcnt(4)
    s_barrier
    ds_read_b128 v[48:51], v64 offset:0
    ds_read_b128 v[52:55], v64 offset:256
    ds_read_b128 v[56:59], v64 offset:512
    v_lshrrev_b32 v81, 4, v69
    s_waitcnt lgkmcnt(2)
    v_mfma_f32_16x16x32_bf16 v[0:3], a[0:3], v[48:51], 0
    v_add_u32 v80, 65536, v64
    s_add_u32 m0, s91, 49152
    s_mov_b32 s78, 28672
    buffer_load_dwordx4 v172, s[60:63], s78 offen offset:0 lds
    v_mfma_f32_16x16x32_bf16 v[4:7], a[4:7], v[48:51], 0
    v_cmp_gt_u32 vcc, 32, v81
    s_add_u32 s31, s95, 458752
    v_mfma_f32_16x16x32_bf16 v[8:11], a[8:11], v[48:51], 0
    s_add_u32 s88, s69, 1
    v_mfma_f32_16x16x32_bf16 v[12:15], a[12:15], v[48:51], 0
    ds_read_b128 v[60:63], v64 offset:768
    s_add_u32 m0, s91, 49152
    s_mov_b32 s78, 34816
    buffer_load_dwordx4 v172, s[60:63], s78 offen offset:1024 lds
    s_waitcnt lgkmcnt(2)
    v_mfma_f32_16x16x32_bf16 v[0:3], a[16:19], v[52:55], v[0:3]
    v_cndmask_b32 v81, 0, 1, vcc
    v_mfma_f32_16x16x32_bf16 v[4:7], a[20:23], v[52:55], v[4:7]
    v_mfma_f32_16x16x32_bf16 v[8:11], a[24:27], v[52:55], v[8:11]
    s_add_u32 m0, s91, 49152
    s_mov_b32 s78, 40960
    buffer_load_dwordx4 v172, s[60:63], s78 offen offset:2048 lds
    v_mfma_f32_16x16x32_bf16 v[12:15], a[28:31], v[52:55], v[12:15]
    ds_read_b128 v[48:51], v64 offset:1024
    s_waitcnt lgkmcnt(2)
    v_mfma_f32_16x16x32_bf16 v[0:3], a[32:35], v[56:59], v[0:3]
    v_mfma_f32_16x16x32_bf16 v[4:7], a[36:39], v[56:59], v[4:7]
    s_add_u32 m0, s91, 49152
    s_mov_b32 s78, 47104
    buffer_load_dwordx4 v172, s[60:63], s78 offen offset:3072 lds
    v_mfma_f32_16x16x32_bf16 v[8:11], a[40:43], v[56:59], v[8:11]
    v_mfma_f32_16x16x32_bf16 v[12:15], a[44:47], v[56:59], v[12:15]
    ds_read_b128 v[52:55], v64 offset:1280
    s_waitcnt lgkmcnt(2)
    v_mfma_f32_16x16x32_bf16 v[0:3], a[48:51], v[60:63], v[0:3]
    s_add_u32 m0, s91, 65536
    s_mov_b32 s78, 57344
    buffer_load_dwordx4 v172, s[60:63], s78 offen offset:0 lds
    v_mfma_f32_16x16x32_bf16 v[4:7], a[52:55], v[60:63], v[4:7]
    v_mfma_f32_16x16x32_bf16 v[8:11], a[56:59], v[60:63], v[8:11]
    v_mfma_f32_16x16x32_bf16 v[12:15], a[60:63], v[60:63], v[12:15]
    ds_read_b128 v[56:59], v64 offset:1536
    s_add_u32 m0, s91, 65536
    s_mov_b32 s78, 63488
    buffer_load_dwordx4 v172, s[60:63], s78 offen offset:1024 lds
    s_waitcnt lgkmcnt(2)
    v_mfma_f32_16x16x32_bf16 v[0:3], a[64:67], v[48:51], v[0:3]
    v_mfma_f32_16x16x32_bf16 v[4:7], a[68:71], v[48:51], v[4:7]
    v_mfma_f32_16x16x32_bf16 v[8:11], a[72:75], v[48:51], v[8:11]
    s_add_u32 m0, s91, 65536
    s_mov_b32 s78, 69632
    buffer_load_dwordx4 v172, s[60:63], s78 offen offset:2048 lds
    v_mfma_f32_16x16x32_bf16 v[12:15], a[76:79], v[48:51], v[12:15]
    ds_read_b128 v[60:63], v64 offset:1792
    s_waitcnt lgkmcnt(2)
    v_mfma_f32_16x16x32_bf16 v[0:3], a[80:83], v[52:55], v[0:3]
    v_mfma_f32_16x16x32_bf16 v[4:7], a[84:87], v[52:55], v[4:7]
    s_add_u32 m0, s91, 65536
    s_mov_b32 s78, 75776
    buffer_load_dwordx4 v172, s[60:63], s78 offen offset:3072 lds
    v_mfma_f32_16x16x32_bf16 v[8:11], a[88:91], v[52:55], v[8:11]
    v_mfma_f32_16x16x32_bf16 v[12:15], a[92:95], v[52:55], v[12:15]
    ds_read_b128 v[48:51], v64 offset:2048
    s_waitcnt lgkmcnt(2)
    v_mfma_f32_16x16x32_bf16 v[0:3], a[96:99], v[56:59], v[0:3]
    s_add_u32 m0, s91, 81920
    s_mov_b32 s78, 86016
    buffer_load_dwordx4 v172, s[60:63], s78 offen offset:0 lds
    v_mfma_f32_16x16x32_bf16 v[4:7], a[100:103], v[56:59], v[4:7]
    v_mfma_f32_16x16x32_bf16 v[8:11], a[104:107], v[56:59], v[8:11]
    v_mfma_f32_16x16x32_bf16 v[12:15], a[108:111], v[56:59], v[12:15]
    ds_read_b128 v[52:55], v64 offset:2304
    s_add_u32 m0, s91, 81920
    s_mov_b32 s78, 92160
    buffer_load_dwordx4 v172, s[60:63], s78 offen offset:1024 lds
    s_waitcnt lgkmcnt(2)
    v_mfma_f32_16x16x32_bf16 v[0:3], a[112:115], v[60:63], v[0:3]
    buffer_load_dword v75, v74, s[40:43], s81 offen sc1
    v_mfma_f32_16x16x32_bf16 v[4:7], a[116:119], v[60:63], v[4:7]
    v_mfma_f32_16x16x32_bf16 v[8:11], a[120:123], v[60:63], v[8:11]
    s_add_u32 m0, s91, 81920
    s_mov_b32 s78, 98304
    buffer_load_dwordx4 v172, s[60:63], s78 offen offset:2048 lds
    v_mfma_f32_16x16x32_bf16 v[12:15], a[124:127], v[60:63], v[12:15]
    ds_read_b128 v[56:59], v64 offset:2560
    s_waitcnt lgkmcnt(2)
    v_mfma_f32_16x16x32_bf16 v[0:3], a[128:131], v[48:51], v[0:3]
    v_mfma_f32_16x16x32_bf16 v[4:7], a[132:135], v[48:51], v[4:7]
    s_add_u32 m0, s91, 81920
    s_mov_b32 s78, 104448
    buffer_load_dwordx4 v172, s[60:63], s78 offen offset:3072 lds
    v_mfma_f32_16x16x32_bf16 v[8:11], a[136:139], v[48:51], v[8:11]
    v_mfma_f32_16x16x32_bf16 v[12:15], a[140:143], v[48:51], v[12:15]
    ds_read_b128 v[60:63], v64 offset:2816
    s_waitcnt lgkmcnt(2)
    v_mfma_f32_16x16x32_bf16 v[0:3], a[144:147], v[52:55], v[0:3]
    v_mfma_f32_16x16x32_bf16 v[4:7], a[148:151], v[52:55], v[4:7]
    v_mfma_f32_16x16x32_bf16 v[8:11], a[152:155], v[52:55], v[8:11]
    v_mfma_f32_16x16x32_bf16 v[12:15], a[156:159], v[52:55], v[12:15]
    ds_read_b128 v[48:51], v64 offset:3072
    s_waitcnt lgkmcnt(2)
    v_mfma_f32_16x16x32_bf16 v[0:3], a[160:163], v[56:59], v[0:3]
    v_mfma_f32_16x16x32_bf16 v[4:7], a[164:167], v[56:59], v[4:7]
    v_mfma_f32_16x16x32_bf16 v[8:11], a[168:171], v[56:59], v[8:11]
    v_mfma_f32_16x16x32_bf16 v[12:15], a[172:175], v[56:59], v[12:15]
    ds_read_b128 v[52:55], v64 offset:3328
    s_waitcnt lgkmcnt(2)
    v_mfma_f32_16x16x32_bf16 v[0:3], a[176:179], v[60:63], v[0:3]
    v_mfma_f32_16x16x32_bf16 v[4:7], a[180:183], v[60:63], v[4:7]
    s_waitcnt vmcnt(13)
    s_barrier
    v_mfma_f32_16x16x32_bf16 v[8:11], a[184:187], v[60:63], v[8:11]
    v_mfma_f32_16x16x32_bf16 v[12:15], a[188:191], v[60:63], v[12:15]
    ds_read_b128 v[56:59], v64 offset:14336
    s_waitcnt lgkmcnt(2)
    v_mfma_f32_16x16x32_bf16 v[0:3], a[192:195], v[48:51], v[0:3]
    v_mfma_f32_16x16x32_bf16 v[4:7], a[196:199], v[48:51], v[4:7]
    v_mfma_f32_16x16x32_bf16 v[8:11], a[200:203], v[48:51], v[8:11]
    v_mfma_f32_16x16x32_bf16 v[12:15], a[204:207], v[48:51], v[12:15]
    ds_read_b128 v[60:63], v64 offset:14592
    s_waitcnt lgkmcnt(2)
    v_mfma_f32_16x16x32_bf16 v[0:3], a[208:211], v[52:55], v[0:3]
    v_mfma_f32_16x16x32_bf16 v[4:7], a[212:215], v[52:55], v[4:7]
    v_mfma_f32_16x16x32_bf16 v[8:11], a[216:219], v[52:55], v[8:11]
    v_mfma_f32_16x16x32_bf16 v[12:15], a[220:223], v[52:55], v[12:15]
    ds_read_b128 v[48:51], v64 offset:14848
    s_waitcnt lgkmcnt(2)
    v_mfma_f32_16x16x32_bf16 v[88:91], a[0:3], v[56:59], 0
    s_waitcnt vmcnt(2)
    v_subrev_u32 v75, s88, v75
    v_mfma_f32_16x16x32_bf16 v[92:95], a[4:7], v[56:59], 0
    v_cmp_le_u32 vcc, 64, v75
    v_mfma_f32_16x16x32_bf16 v[96:99], a[8:11], v[56:59], 0
    s_cbranch_vccz L_bk_31
    s_mov_b32 s71, 0
L_wp_32:
    buffer_load_dword v75, v74, s[40:43], s81 offen sc1
    s_waitcnt vmcnt(0)
    v_subrev_u32 v75, s88, v75
    v_cmp_le_u32 vcc, 64, v75
    s_add_u32 s71, s71, 1
    s_cmp_eq_u64 vcc, 0
    s_cbranch_scc1 L_wpd_33
    s_cmp_lt_u32 s71, 131072
    s_cbranch_scc1 L_wp_32
L_wpd_33:
L_bk_31:
    s_add_u32 m0, s96, 65536
    v_mfma_f32_16x16x32_bf16 v[100:103], a[12:15], v[56:59], 0
    ds_read_b128 v[52:55], v64 offset:15104
    s_waitcnt lgkmcnt(2)
    v_mfma_f32_16x16x32_bf16 v[88:91], a[16:19], v[60:63], v[88:91]
    v_mul_f32 v0, v0, v4
    v_mul_f32 v1, v1, v5
    s_waitcnt vmcnt(0)
    ds_read_b64_tr_b16 a[224:225], v175 offset:0
    ds_read_b64_tr_b16 a[226:227], v175 offset:2048
    v_mfma_f32_16x16x32_bf16 v[92:95], a[20:23], v[60:63], v[92:95]
    buffer_load_dwordx4 v70, s[40:43], s31 offen offset:0 sc1 lds
    ds_read_b64_tr_b16 a[228:229], v171 offset:0
    ds_read_b64_tr_b16 a[230:231], v171 offset:2048
    v_mfma_f32_16x16x32_bf16 v[96:99], a[24:27], v[60:63], v[96:99]
    v_mul_f32 v2, v2, v6
    v_mul_f32 v3, v3, v7
    ds_read_b64_tr_b16 a[232:233], v167 offset:0
    ds_read_b64_tr_b16 a[234:235], v167 offset:2048
    v_mfma_f32_16x16x32_bf16 v[100:103], a[28:31], v[60:63], v[100:103]
    ds_read_b128 v[56:59], v64 offset:15360
    s_waitcnt lgkmcnt(8)
    v_mfma_f32_16x16x32_bf16 v[88:91], a[32:35], v[48:51], v[88:91]
    v_mul_f32 v8, v8, v12
    v_mul_f32 v9, v9, v13
    ds_read_b64_tr_b16 a[236:237], v168 offset:0
    ds_read_b64_tr_b16 a[238:239], v168 offset:2048
    v_mfma_f32_16x16x32_bf16 v[92:95], a[36:39], v[48:51], v[92:95]
    buffer_load_dwordx4 v70, s[40:43], s31 offen offset:1024 sc1 lds
    ds_read_b64_tr_b16 a[240:241], v175 offset:16384
    ds_read_b64_tr_b16 a[242:243], v175 offset:18432
    v_mfma_f32_16x16x32_bf16 v[96:99], a[40:43], v[48:51], v[96:99]
    v_mul_f32 v10, v10, v14
    v_mul_f32 v11, v11, v15
    ds_read_b64_tr_b16 a[244:245], v171 offset:16384
    ds_read_b64_tr_b16 a[246:247], v171 offset:18432
    v_mfma_f32_16x16x32_bf16 v[100:103], a[44:47], v[48:51], v[100:103]
    ds_read_b128 v[60:63], v64 offset:15616
    s_waitcnt lgkmcnt(14)
    v_mfma_f32_16x16x32_bf16 v[88:91], a[48:51], v[52:55], v[88:91]
    v_cvt_pk_bf16_f32 v44, v0, v1
    v_cvt_pk_bf16_f32 v45, v2, v3
    ds_read_b64_tr_b16 a[248:249], v167 offset:16384
    ds_read_b64_tr_b16 a[250:251], v167 offset:18432
    v_mfma_f32_16x16x32_bf16 v[92:95], a[52:55], v[52:55], v[92:95]
    buffer_load_dwordx4 v70, s[40:43], s31 offen offset:2048 sc1 lds
    ds_read_b64_tr_b16 a[252:253], v168 offset:16384
    ds_read_b64_tr_b16 a[254:255], v168 offset:18432
    v_mfma_f32_16x16x32_bf16 v[96:99], a[56:59], v[52:55], v[96:99]
    v_cvt_pk_bf16_f32 v46, v8, v9
    v_cvt_pk_bf16_f32 v47, v10, v11
    ds_read_b64_tr_b16 v[176:177], v175 offset:32768
    ds_read_b64_tr_b16 v[178:179], v175 offset:34816
    v_mfma_f32_16x16x32_bf16 v[100:103], a[60:63], v[52:55], v[100:103]
    ds_read_b128 v[48:51], v64 offset:15872
    s_waitcnt lgkmcnt(14)
    v_mfma_f32_16x16x32_bf16 v[88:91], a[64:67], v[56:59], v[88:91]
    ds_read_b64_tr_b16 v[180:181], v171 offset:32768
    ds_read_b64_tr_b16 v[182:183], v171 offset:34816
    v_mfma_f32_16x16x32_bf16 v[92:95], a[68:71], v[56:59], v[92:95]
    buffer_load_dwordx4 v70, s[40:43], s31 offen offset:3072 sc1 lds
    ds_read_b64_tr_b16 v[184:185], v167 offset:32768
    ds_read_b64_tr_b16 v[186:187], v167 offset:34816
    v_mfma_f32_16x16x32_bf16 v[96:99], a[72:75], v[56:59], v[96:99]
    buffer_store_dwordx4 v[44:47], v69, s[40:43], s72 offen
    ds_read_b64_tr_b16 v[188:189], v168 offset:32768
    ds_read_b64_tr_b16 v[190:191], v168 offset:34816
    v_mfma_f32_16x16x32_bf16 v[100:103], a[76:79], v[56:59], v[100:103]
    ds_read_b128 v[52:55], v64 offset:16128
    s_waitcnt lgkmcnt(14)
    v_mfma_f32_16x16x32_bf16 v[88:91], a[80:83], v[60:63], v[88:91]
    s_add_u32 s31, s31, 14336
    s_add_u32 s88, s88, 1
    ds_read_b64_tr_b16 v[192:193], v175 offset:49152
    ds_read_b64_tr_b16 v[194:195], v175 offset:51200
    v_mfma_f32_16x16x32_bf16 v[92:95], a[84:87], v[60:63], v[92:95]
    ds_read_b64_tr_b16 v[196:197], v171 offset:49152
    ds_read_b64_tr_b16 v[198:199], v171 offset:51200
    v_mfma_f32_16x16x32_bf16 v[96:99], a[88:91], v[60:63], v[96:99]
    ds_read_b64_tr_b16 v[200:201], v167 offset:49152
    ds_read_b64_tr_b16 v[202:203], v167 offset:51200
    v_mfma_f32_16x16x32_bf16 v[100:103], a[92:95], v[60:63], v[100:103]
    ds_read_b128 v[56:59], v64 offset:16384
    s_waitcnt lgkmcnt(14)
    v_mfma_f32_16x16x32_bf16 v[88:91], a[96:99], v[48:51], v[88:91]
    ds_read_b64_tr_b16 v[204:205], v168 offset:49152
    ds_read_b64_tr_b16 v[206:207], v168 offset:51200
    v_mfma_f32_16x16x32_bf16 v[92:95], a[100:103], v[48:51], v[92:95]
    v_mfma_f32_16x16x32_bf16 v[96:99], a[104:107], v[48:51], v[96:99]
    v_mfma_f32_16x16x32_bf16 v[100:103], a[108:111], v[48:51], v[100:103]
    ds_read_b128 v[60:63], v64 offset:16640
    s_waitcnt lgkmcnt(10)
    v_mfma_f32_16x16x32_bf16 v[88:91], a[112:115], v[52:55], v[88:91]
    buffer_load_dword v75, v74, s[40:43], s81 offen sc1
    s_waitcnt lgkmcnt(1)
    v_mfma_f32_16x16x32_bf16 v[92:95], a[116:119], v[52:55], v[92:95]
    s_add_u32 m0, s91, 32768
    s_mov_b32 s78, 114688
    buffer_load_dwordx4 v172, s[60:63], s78 offen offset:0 lds
    v_mfma_f32_16x16x32_bf16 v[96:99], a[120:123], v[52:55], v[96:99]
    v_mfma_f32_16x16x32_bf16 v[100:103], a[124:127], v[52:55], v[100:103]
    ds_read_b128 v[48:51], v64 offset:16896
    v_mfma_f32_16x16x32_bf16 v[88:91], a[128:131], v[56:59], v[88:91]
    s_add_u32 m0, s91, 32768
    s_mov_b32 s78, 120832
    buffer_load_dwordx4 v172, s[60:63], s78 offen offset:1024 lds
    v_mfma_f32_16x16x32_bf16 v[92:95], a[132:135], v[56:59], v[92:95]
    v_mfma_f32_16x16x32_bf16 v[96:99], a[136:139], v[56:59], v[96:99]
    v_mfma_f32_16x16x32_bf16 v[100:103], a[140:143], v[56:59], v[100:103]
    ds_read_b128 v[52:55], v64 offset:17152
    s_add_u32 m0, s91, 32768
    s_mov_b32 s78, 126976
    buffer_load_dwordx4 v172, s[60:63], s78 offen offset:2048 lds
    s_waitcnt lgkmcnt(2)
    v_mfma_f32_16x16x32_bf16 v[88:91], a[144:147], v[60:63], v[88:91]
    v_mfma_f32_16x16x32_bf16 v[92:95], a[148:151], v[60:63], v[92:95]
    v_mfma_f32_16x16x32_bf16 v[96:99], a[152:155], v[60:63], v[96:99]
    s_add_u32 m0, s91, 32768
    s_mov_b32 s78, 133120
    buffer_load_dwordx4 v172, s[60:63], s78 offen offset:3072 lds
    v_mfma_f32_16x16x32_bf16 v[100:103], a[156:159], v[60:63], v[100:103]
    ds_read_b128 v[56:59], v64 offset:17408
    s_waitcnt lgkmcnt(2)
    v_mfma_f32_16x16x32_bf16 v[88:91], a[160:163], v[48:51], v[88:91]
    v_mfma_f32_16x16x32_bf16 v[92:95], a[164:167], v[48:51], v[92:95]
    s_waitcnt vmcnt(5)
    buffer_store_dword v73, off, s[40:43], s80
    s_add_u32 m0, s91, 49152
    s_mov_b32 s78, 143360
    buffer_load_dwordx4 v172, s[60:63], s78 offen offset:0 lds
    v_mfma_f32_16x16x32_bf16 v[96:99], a[168:171], v[48:51], v[96:99]
    v_add_u32 v73, 1, v73
    s_add_u32 s72, s92, 28672
    v_mfma_f32_16x16x32_bf16 v[100:103], a[172:175], v[48:51], v[100:103]
    ds_read_b128 v[60:63], v64 offset:17664
    s_waitcnt lgkmcnt(2)
    v_mfma_f32_16x16x32_bf16 v[88:91], a[176:179], v[52:55], v[88:91]
    s_add_u32 m0, s91, 49152
    s_mov_b32 s78, 149504
    buffer_load_dwordx4 v172, s[60:63], s78 offen offset:1024 lds
    v_mfma_f32_16x16x32_bf16 v[92:95], a[180:183], v[52:55], v[92:95]
    s_barrier
    v_mfma_f32_16x16x32_bf16 v[96:99], a[184:187], v[52:55], v[96:99]
    v_mfma_f32_16x16x32_bf16 v[100:103], a[188:191], v[52:55], v[100:103]
    ds_read_b128 v[48:51], v80 offset:0
    s_add_u32 m0, s91, 49152
    s_mov_b32 s78, 155648
    buffer_load_dwordx4 v172, s[60:63], s78 offen offset:2048 lds
    s_waitcnt lgkmcnt(2)
    v_mfma_f32_16x16x32_bf16 v[88:91], a[192:195], v[56:59], v[88:91]
    v_mfma_f32_16x16x32_bf16 v[92:95], a[196:199], v[56:59], v[92:95]
    v_mfma_f32_16x16x32_bf16 v[96:99], a[200:203], v[56:59], v[96:99]
    s_add_u32 m0, s91, 49152
    s_mov_b32 s78, 161792
    buffer_load_dwordx4 v172, s[60:63], s78 offen offset:3072 lds
    v_mfma_f32_16x16x32_bf16 v[100:103], a[204:207], v[56:59], v[100:103]
    ds_read_b128 v[52:55], v80 offset:256
    s_waitcnt lgkmcnt(2)
    v_mfma_f32_16x16x32_bf16 v[88:91], a[208:211], v[60:63], v[88:91]
    v_mfma_f32_16x16x32_bf16 v[92:95], a[212:215], v[60:63], v[92:95]
    s_add_u32 m0, s91, 65536
    s_mov_b32 s78, 172032
    buffer_load_dwordx4 v172, s[60:63], s78 offen offset:0 lds
    v_mfma_f32_16x16x32_bf16 v[96:99], a[216:219], v[60:63], v[96:99]
    v_mfma_f32_16x16x32_bf16 v[100:103], a[220:223], v[60:63], v[100:103]
    ds_read_b128 v[56:59], v80 offset:512
    s_waitcnt lgkmcnt(2)
    v_mfma_f32_16x16x32_bf16 v[0:3], a[0:3], v[48:51], 0
    s_waitcnt vmcnt(10)
    v_subrev_u32 v75, s88, v75
    v_mfma_f32_16x16x32_bf16 v[4:7], a[4:7], v[48:51], 0
    v_cmp_le_u32 vcc, 64, v75
    v_mfma_f32_16x16x32_bf16 v[8:11], a[8:11], v[48:51], 0
    s_cbranch_vccz L_bk_35
    s_mov_b32 s71, 0
L_wp_36:
    buffer_load_dword v75, v74, s[40:43], s81 offen sc1
    s_waitcnt vmcnt(0)
    v_subrev_u32 v75, s88, v75
    v_cmp_le_u32 vcc, 64, v75
    s_add_u32 s71, s71, 1
    s_cmp_eq_u64 vcc, 0
    s_cbranch_scc1 L_wpd_37
    s_cmp_lt_u32 s71, 131072
    s_cbranch_scc1 L_wp_36
L_wpd_37:
L_bk_35:
    s_add_u32 m0, s96, 81920
    v_mfma_f32_16x16x32_bf16 v[12:15], a[12:15], v[48:51], 0
    ds_read_b128 v[60:63], v80 offset:768
    s_waitcnt lgkmcnt(2)
    v_mfma_f32_16x16x32_bf16 v[0:3], a[16:19], v[52:55], v[0:3]
    v_mul_f32 v88, v88, v92
    v_mul_f32 v89, v89, v93
    v_mfma_f32_16x16x32_bf16 v[4:7], a[20:23], v[52:55], v[4:7]
    buffer_load_dwordx4 v70, s[40:43], s31 offen offset:0 sc1 lds
    v_mfma_f32_16x16x32_bf16 v[8:11], a[24:27], v[52:55], v[8:11]
    v_mul_f32 v90, v90, v94
    v_mul_f32 v91, v91, v95
    v_mfma_f32_16x16x32_bf16 v[12:15], a[28:31], v[52:55], v[12:15]
    ds_read_b128 v[48:51], v80 offset:1024
    s_waitcnt lgkmcnt(2)
    v_mfma_f32_16x16x32_bf16 v[0:3], a[32:35], v[56:59], v[0:3]
    v_mul_f32 v96, v96, v100
    v_mul_f32 v97, v97, v101
    v_mfma_f32_16x16x32_bf16 v[4:7], a[36:39], v[56:59], v[4:7]
    buffer_load_dwordx4 v70, s[40:43], s31 offen offset:1024 sc1 lds
    v_mfma_f32_16x16x32_bf16 v[8:11], a[40:43], v[56:59], v[8:11]
    v_mul_f32 v98, v98, v102
    v_mul_f32 v99, v99, v103
    v_mfma_f32_16x16x32_bf16 v[12:15], a[44:47], v[56:59], v[12:15]
    ds_read_b128 v[52:55], v80 offset:1280
    s_waitcnt lgkmcnt(2)
    v_mfma_f32_16x16x32_bf16 v[0:3], a[48:51], v[60:63], v[0:3]
    v_cvt_pk_bf16_f32 v44, v88, v89
    v_cvt_pk_bf16_f32 v45, v90, v91
    v_mfma_f32_16x16x32_bf16 v[4:7], a[52:55], v[60:63], v[4:7]
    buffer_load_dwordx4 v70, s[40:43], s31 offen offset:2048 sc1 lds
    v_mfma_f32_16x16x32_bf16 v[8:11], a[56:59], v[60:63], v[8:11]
    v_cvt_pk_bf16_f32 v46, v96, v97
    v_cvt_pk_bf16_f32 v47, v98, v99
    v_mfma_f32_16x16x32_bf16 v[12:15], a[60:63], v[60:63], v[12:15]
    ds_read_b128 v[56:59], v80 offset:1536
    s_waitcnt lgkmcnt(2)
    v_mfma_f32_16x16x32_bf16 v[0:3], a[64:67], v[48:51], v[0:3]
    v_mfma_f32_16x16x32_bf16 v[4:7], a[68:71], v[48:51], v[4:7]
    buffer_load_dwordx4 v70, s[40:43], s31 offen offset:3072 sc1 lds
    v_mfma_f32_16x16x32_bf16 v[8:11], a[72:75], v[48:51], v[8:11]
    buffer_store_dwordx4 v[44:47], v69, s[40:43], s72 offen
    v_mfma_f32_16x16x32_bf16 v[12:15], a[76:79], v[48:51], v[12:15]
    ds_read_b128 v[60:63], v80 offset:1792
    s_waitcnt lgkmcnt(2)
    v_mfma_f32_16x16x32_bf16 v[0:3], a[80:83], v[52:55], v[0:3]
    s_add_u32 s31, s95, 917504
    s_add_u32 s88, s88, 1
    v_mfma_f32_16x16x32_bf16 v[4:7], a[84:87], v[52:55], v[4:7]
    v_mfma_f32_16x16x32_bf16 v[8:11], a[88:91], v[52:55], v[8:11]
    v_mfma_f32_16x16x32_bf16 v[12:15], a[92:95], v[52:55], v[12:15]
    ds_read_b128 v[48:51], v80 offset:2048
    s_waitcnt lgkmcnt(2)
    v_mfma_f32_16x16x32_bf16 v[0:3], a[96:99], v[56:59], v[0:3]
    v_mfma_f32_16x16x32_bf16 v[4:7], a[100:103], v[56:59], v[4:7]
    v_mfma_f32_16x16x32_bf16 v[8:11], a[104:107], v[56:59], v[8:11]
    v_mfma_f32_16x16x32_bf16 v[12:15], a[108:111], v[56:59], v[12:15]
    ds_read_b128 v[52:55], v80 offset:2304
    s_waitcnt lgkmcnt(2)
    v_mfma_f32_16x16x32_bf16 v[0:3], a[112:115], v[60:63], v[0:3]
    buffer_load_dword v75, v78, s[40:43], s81 offen sc1
    v_mfma_f32_16x16x32_bf16 v[4:7], a[116:119], v[60:63], v[4:7]
    s_add_u32 m0, s91, 65536
    s_mov_b32 s78, 178176
    buffer_load_dwordx4 v172, s[60:63], s78 offen offset:1024 lds
    v_mfma_f32_16x16x32_bf16 v[8:11], a[120:123], v[60:63], v[8:11]
    v_mfma_f32_16x16x32_bf16 v[12:15], a[124:127], v[60:63], v[12:15]
    ds_read_b128 v[56:59], v80 offset:2560
    s_waitcnt lgkmcnt(2)
    v_mfma_f32_16x16x32_bf16 v[0:3], a[128:131], v[48:51], v[0:3]
    s_add_u32 m0, s91, 65536
    s_mov_b32 s78, 184320
    buffer_load_dwordx4 v172, s[60:63], s78 offen offset:2048 lds
    v_mfma_f32_16x16x32_bf16 v[4:7], a[132:135], v[48:51], v[4:7]
    v_mfma_f32_16x16x32_bf16 v[8:11], a[136:139], v[48:51], v[8:11]
    v_mfma_f32_16x16x32_bf16 v[12:15], a[140:143], v[48:51], v[12:15]
    ds_read_b128 v[60:63], v80 offset:2816
    s_add_u32 m0, s91, 65536
    s_mov_b32 s78, 190464
    buffer_load_dwordx4 v172, s[60:63], s78 offen offset:3072 lds
    s_waitcnt lgkmcnt(2)
    v_mfma_f32_16x16x32_bf16 v[0:3], a[144:147], v[52:55], v[0:3]
    v_mfma_f32_16x16x32_bf16 v[4:7], a[148:151], v[52:55], v[4:7]
    v_mfma_f32_16x16x32_bf16 v[8:11], a[152:155], v[52:55], v[8:11]
    v_mfma_f32_16x16x32_bf16 v[12:15], a[156:159], v[52:55], v[12:15]
    ds_read_b128 v[48:51], v80 offset:3072
    s_waitcnt lgkmcnt(2)
    v_mfma_f32_16x16x32_bf16 v[0:3], a[160:163], v[56:59], v[0:3]
    v_mfma_f32_16x16x32_bf16 v[4:7], a[164:167], v[56:59], v[4:7]
    s_waitcnt vmcnt(4)
    buffer_store_dword v73, off, s[40:43], s80
    v_mfma_f32_16x16x32_bf16 v[8:11], a[168:171], v[56:59], v[8:11]
    v_add_u32 v73, 1, v73
    s_add_u32 s72, s92, 6291456
    v_mfma_f32_16x16x32_bf16 v[12:15], a[172:175], v[56:59], v[12:15]
    ds_read_b128 v[52:55], v80 offset:3328
    s_waitcnt lgkmcnt(2)
    v_mfma_f32_16x16x32_bf16 v[0:3], a[176:179], v[60:63], v[0:3]
    v_mfma_f32_16x16x32_bf16 v[4:7], a[180:183], v[60:63], v[4:7]
    s_barrier
    v_mfma_f32_16x16x32_bf16 v[8:11], a[184:187], v[60:63], v[8:11]
    v_mfma_f32_16x16x32_bf16 v[12:15], a[188:191], v[60:63], v[12:15]
    ds_read_b128 v[56:59], v80 offset:16384
    s_waitcnt lgkmcnt(2)
    v_mfma_f32_16x16x32_bf16 v[0:3], a[192:195], v[48:51], v[0:3]
    v_mfma_f32_16x16x32_bf16 v[4:7], a[196:199], v[48:51], v[4:7]
    v_mfma_f32_16x16x32_bf16 v[8:11], a[200:203], v[48:51], v[8:11]
    v_mfma_f32_16x16x32_bf16 v[12:15], a[204:207], v[48:51], v[12:15]
    ds_read_b128 v[60:63], v80 offset:16640
    s_waitcnt lgkmcnt(2)
    v_mfma_f32_16x16x32_bf16 v[0:3], a[208:211], v[52:55], v[0:3]
    v_mfma_f32_16x16x32_bf16 v[4:7], a[212:215], v[52:55], v[4:7]
    s_add_u32 s75, s93, 32768
    v_mfma_f32_16x16x32_bf16 v[8:11], a[216:219], v[52:55], v[8:11]
    s_add_u32 s77, s93, 4096
    s_add_u32 s73, s93, 28672
    v_mfma_f32_16x16x32_bf16 v[12:15], a[220:223], v[52:55], v[12:15]
    ds_read_b128 v[48:51], v80 offset:16896
    s_waitcnt lgkmcnt(2)
    v_mfma_f32_16x16x32_bf16 v[88:91], a[0:3], v[56:59], 0
    s_waitcnt vmcnt(4)
    v_subrev_u32 v75, v79, v75
    v_mfma_f32_16x16x32_bf16 v[92:95], a[4:7], v[56:59], 0
    v_cmp_le_u32 vcc, 64, v75
    v_mfma_f32_16x16x32_bf16 v[96:99], a[8:11], v[56:59], 0
    s_cbranch_vccz L_bk_39
    s_mov_b32 s71, 0
L_wp_40:
    buffer_load_dword v75, v78, s[40:43], s81 offen sc1
    s_waitcnt vmcnt(0)
    v_subrev_u32 v75, v79, v75
    v_cmp_le_u32 vcc, 64, v75
    s_add_u32 s71, s71, 1
    s_cmp_eq_u64 vcc, 0
    s_cbranch_scc1 L_wpd_41
    s_cmp_lt_u32 s71, 131072
    s_cbranch_scc1 L_wp_40
L_wpd_41:
L_bk_39:
    s_add_u32 m0, s96, 0
    v_mfma_f32_16x16x32_bf16 v[100:103], a[12:15], v[56:59], 0
    ds_read_b128 v[52:55], v80 offset:17152
    s_waitcnt lgkmcnt(2)
    v_mfma_f32_16x16x32_bf16 v[88:91], a[16:19], v[60:63], v[88:91]
    v_mul_f32 v0, v0, v4
    v_mul_f32 v1, v1, v5
    v_mfma_f32_16x16x32_bf16 v[92:95], a[20:23], v[60:63], v[92:95]
    buffer_load_dwordx4 v70, s[40:43], s31 offen offset:0 sc1 lds
    v_mfma_f32_16x16x32_bf16 v[96:99], a[24:27], v[60:63], v[96:99]
    v_mul_f32 v2, v2, v6
    v_mul_f32 v3, v3, v7
    v_mfma_f32_16x16x32_bf16 v[100:103], a[28:31], v[60:63], v[100:103]
    ds_read_b128 v[56:59], v80 offset:17408
    s_waitcnt lgkmcnt(2)
    v_mfma_f32_16x16x32_bf16 v[88:91], a[32:35], v[48:51], v[88:91]
    v_mul_f32 v8, v8, v12
    v_mul_f32 v9, v9, v13
    v_mfma_f32_16x16x32_bf16 v[92:95], a[36:39], v[48:51], v[92:95]
    buffer_load_dwordx4 v70, s[40:43], s31 offen offset:1024 sc1 lds
    v_mfma_f32_16x16x32_bf16 v[96:99], a[40:43], v[48:51], v[96:99]
    v_mul_f32 v10, v10, v14
    v_mul_f32 v11, v11, v15
    v_mfma_f32_16x16x32_bf16 v[100:103], a[44:47], v[48:51], v[100:103]
    ds_read_b128 v[60:63], v80 offset:17664
    s_waitcnt lgkmcnt(2)
    v_mfma_f32_16x16x32_bf16 v[88:91], a[48:51], v[52:55], v[88:91]
    v_cvt_pk_bf16_f32 v44, v0, v1
    v_cvt_pk_bf16_f32 v45, v2, v3
    v_mfma_f32_16x16x32_bf16 v[92:95], a[52:55], v[52:55], v[92:95]
    buffer_load_dwordx4 v70, s[40:43], s31 offen offset:2048 sc1 lds
    v_mfma_f32_16x16x32_bf16 v[96:99], a[56:59], v[52:55], v[96:99]
    v_cvt_pk_bf16_f32 v46, v8, v9
    v_cvt_pk_bf16_f32 v47, v10, v11
    v_mfma_f32_16x16x32_bf16 v[100:103], a[60:63], v[52:55], v[100:103]
    ds_read_b128 v[48:51], v80 offset:17920
    s_waitcnt lgkmcnt(2)
    v_mfma_f32_16x16x32_bf16 v[88:91], a[64:67], v[56:59], v[88:91]
    v_mfma_f32_16x16x32_bf16 v[92:95], a[68:71], v[56:59], v[92:95]
    buffer_load_dwordx4 v70, s[40:43], s31 offen offset:3072 sc1 lds
    v_mfma_f32_16x16x32_bf16 v[96:99], a[72:75], v[56:59], v[96:99]
    buffer_store_dwordx4 v[44:47], v69, s[40:43], s72 offen
    v_mfma_f32_16x16x32_bf16 v[100:103], a[76:79], v[56:59], v[100:103]
    ds_read_b128 v[52:55], v80 offset:18176
    s_waitcnt lgkmcnt(2)
    v_mfma_f32_16x16x32_bf16 v[88:91], a[80:83], v[60:63], v[88:91]
    s_add_u32 s31, s31, 14336
    s_add_u32 s88, s88, 1
    v_mfma_f32_16x16x32_bf16 v[92:95], a[84:87], v[60:63], v[92:95]
    buffer_load_dword v75, v78, s[40:43], s81 offen sc1
    v_add_u32 v79, v81, v79
    v_mfma_f32_16x16x32_bf16 v[96:99], a[88:91], v[60:63], v[96:99]
    buffer_load_dwordx4 v[104:107], v71, s[40:43], s93 offen offset:0 sc1
    s_waitcnt vmcnt(8)
    ds_read_b64_tr_b16 v[208:209], v175 offset:0
    ds_read_b64_tr_b16 v[210:211], v175 offset:2048
    v_mfma_f32_16x16x32_bf16 v[100:103], a[92:95], v[60:63], v[100:103]
    ds_read_b128 v[56:59], v80 offset:18432
    s_waitcnt lgkmcnt(4)
    v_mfma_f32_16x16x32_bf16 v[88:91], a[96:99], v[48:51], v[88:91]
    ds_read_b64_tr_b16 v[212:213], v171 offset:0
    ds_read_b64_tr_b16 v[214:215], v171 offset:2048
    v_mfma_f32_16x16x32_bf16 v[92:95], a[100:103], v[48:51], v[92:95]
    buffer_load_dwordx4 v[108:111], v71, s[40:43], s93 offen offset:1024 sc1
    ds_read_b64_tr_b16 v[216:217], v167 offset:0
    ds_read_b64_tr_b16 v[218:219], v167 offset:2048
    v_mfma_f32_16x16x32_bf16 v[96:99], a[104:107], v[48:51], v[96:99]
    ds_read_b64_tr_b16 v[220:221], v168 offset:0
    ds_read_b64_tr_b16 v[222:223], v168 offset:2048
    v_mfma_f32_16x16x32_bf16 v[100:103], a[108:111], v[48:51], v[100:103]
    ds_read_b128 v[60:63], v80 offset:18688
    s_waitcnt lgkmcnt(10)
    v_mfma_f32_16x16x32_bf16 v[88:91], a[112:115], v[52:55], v[88:91]
    buffer_load_dwordx4 v[112:115], v71, s[40:43], s93 offen offset:2048 sc1
    ds_read_b64_tr_b16 v[224:225], v175 offset:16384
    ds_read_b64_tr_b16 v[226:227], v175 offset:18432
    v_mfma_f32_16x16x32_bf16 v[92:95], a[116:119], v[52:55], v[92:95]
    ds_read_b64_tr_b16 v[228:229], v171 offset:16384
    ds_read_b64_tr_b16 v[230:231], v171 offset:18432
    v_mfma_f32_16x16x32_bf16 v[96:99], a[120:123], v[52:55], v[96:99]
    ds_read_b64_tr_b16 v[232:233], v167 offset:16384
    ds_read_b64_tr_b16 v[234:235], v167 offset:18432
    v_mfma_f32_16x16x32_bf16 v[100:103], a[124:127], v[52:55], v[100:103]
    ds_read_b128 v[48:51], v80 offset:18944
    buffer_load_dwordx4 v[116:119], v71, s[40:43], s93 offen offset:3072 sc1
    s_waitcnt lgkmcnt(14)
    v_mfma_f32_16x16x32_bf16 v[88:91], a[128:131], v[56:59], v[88:91]
    ds_read_b64_tr_b16 v[236:237], v168 offset:16384
    ds_read_b64_tr_b16 v[238:239], v168 offset:18432
    v_mfma_f32_16x16x32_bf16 v[92:95], a[132:135], v[56:59], v[92:95]
    ds_read_b64_tr_b16 v[240:241], v175 offset:32768
    ds_read_b64_tr_b16 v[242:243], v175 offset:34816
    v_mfma_f32_16x16x32_bf16 v[96:99], a[136:139], v[56:59], v[96:99]
    buffer_load_dwordx4 v[120:123], v71, s[40:43], s77 offen offset:0 sc1
    ds_read_b64_tr_b16 v[244:245], v171 offset:32768
    ds_read_b64_tr_b16 v[246:247], v171 offset:34816
    v_mfma_f32_16x16x32_bf16 v[100:103], a[140:143], v[56:59], v[100:103]
    ds_read_b128 v[52:55], v80 offset:19200
    s_waitcnt lgkmcnt(14)
    v_mfma_f32_16x16x32_bf16 v[88:91], a[144:147], v[60:63], v[88:91]
    ds_read_b64_tr_b16 v[248:249], v167 offset:32768
    ds_read_b64_tr_b16 v[250:251], v167 offset:34816
    v_mfma_f32_16x16x32_bf16 v[92:95], a[148:151], v[60:63], v[92:95]
    buffer_load_dwordx4 v[124:127], v71, s[40:43], s77 offen offset:1024 sc1
    ds_read_b64_tr_b16 v[252:253], v168 offset:32768
    ds_read_b64_tr_b16 v[254:255], v168 offset:34816
    v_mfma_f32_16x16x32_bf16 v[96:99], a[152:155], v[60:63], v[96:99]
    v_mfma_f32_16x16x32_bf16 v[100:103], a[156:159], v[60:63], v[100:103]
    ds_read_b128 v[56:59], v80 offset:19456
    s_waitcnt lgkmcnt(12)
    v_mfma_f32_16x16x32_bf16 v[88:91], a[160:163], v[48:51], v[88:91]
    buffer_load_dwordx4 v[128:131], v71, s[40:43], s77 offen offset:2048 sc1
    v_mfma_f32_16x16x32_bf16 v[92:95], a[164:167], v[48:51], v[92:95]
    s_waitcnt vmcnt(8)
    buffer_store_dword v73, off, s[40:43], s80
    v_mfma_f32_16x16x32_bf16 v[96:99], a[168:171], v[48:51], v[96:99]
    v_add_u32 v73, 1, v73
    s_add_u32 s72, s92, 6320128
    v_mfma_f32_16x16x32_bf16 v[100:103], a[172:175], v[48:51], v[100:103]
    ds_read_b128 v[60:63], v80 offset:19712
    s_waitcnt lgkmcnt(6)
    v_mfma_f32_16x16x32_bf16 v[88:91], a[176:179], v[52:55], v[88:91]
    s_waitcnt vmcnt(8)
    v_subrev_u32 v75, v79, v75
    v_mfma_f32_16x16x32_bf16 v[92:95], a[180:183], v[52:55], v[92:95]
    v_cmp_le_u32 vcc, 64, v75
    v_mfma_f32_16x16x32_bf16 v[96:99], a[184:187], v[52:55], v[96:99]
    s_cbranch_vccz L_bk_43
    s_mov_b32 s71, 0
L_wp_44:
    buffer_load_dword v75, v78, s[40:43], s81 offen sc1
    s_waitcnt vmcnt(0)
    v_subrev_u32 v75, v79, v75
    v_cmp_le_u32 vcc, 64, v75
    s_add_u32 s71, s71, 1
    s_cmp_eq_u64 vcc, 0
    s_cbranch_scc1 L_wpd_45
    s_cmp_lt_u32 s71, 131072
    s_cbranch_scc1 L_wp_44
L_wpd_45:
L_bk_43:
    v_add_u32 v79, 1, v79
    v_mfma_f32_16x16x32_bf16 v[100:103], a[188:191], v[52:55], v[100:103]
    s_waitcnt lgkmcnt(1)
    v_mfma_f32_16x16x32_bf16 v[88:91], a[192:195], v[56:59], v[88:91]
    buffer_load_dwordx4 v[132:135], v71, s[40:43], s73 offen offset:0 sc1
    v_mfma_f32_16x16x32_bf16 v[92:95], a[196:199], v[56:59], v[92:95]
    v_mfma_f32_16x16x32_bf16 v[96:99], a[200:203], v[56:59], v[96:99]
    v_mfma_f32_16x16x32_bf16 v[100:103], a[204:207], v[56:59], v[100:103]
    buffer_load_dwordx4 v[136:139], v71, s[40:43], s73 offen offset:1024 sc1
    s_waitcnt lgkmcnt(0)
    v_mfma_f32_16x16x32_bf16 v[88:91], a[208:211], v[60:63], v[88:91]
    v_mfma_f32_16x16x32_bf16 v[92:95], a[212:215], v[60:63], v[92:95]
    v_mfma_f32_16x16x32_bf16 v[96:99], a[216:219], v[60:63], v[96:99]
    buffer_load_dwordx4 v[140:143], v71, s[40:43], s73 offen offset:2048 sc1
    v_mfma_f32_16x16x32_bf16 v[100:103], a[220:223], v[60:63], v[100:103]
    s_waitcnt vmcnt(10)
    v_mfma_f32_16x16x32_bf16 v[16:19], a[224:227], v[104:107], 0
    v_mfma_f32_16x16x32_bf16 v[20:23], a[228:231], v[104:107], 0
    buffer_load_dwordx4 v[144:147], v71, s[40:43], s73 offen offset:3072 sc1
    v_mfma_f32_16x16x32_bf16 v[24:27], a[232:235], v[104:107], 0
    v_mfma_f32_16x16x32_bf16 v[28:31], a[236:239], v[104:107], 0
    s_waitcnt vmcnt(10)
    v_mfma_f32_16x16x32_bf16 v[16:19], a[240:243], v[108:111], v[16:19]
    buffer_load_dwordx4 v[148:151], v71, s[40:43], s75 offen offset:0 sc1
    v_mul_f32 v88, v88, v92
    v_mul_f32 v89, v89, v93
    v_mfma_f32_16x16x32_bf16 v[20:23], a[244:247], v[108:111], v[20:23]
    v_mul_f32 v90, v90, v94
    v_mul_f32 v91, v91, v95
    v_mfma_f32_16x16x32_bf16 v[24:27], a[248:251], v[108:111], v[24:27]
    v_mul_f32 v96, v96, v100
    v_mul_f32 v97, v97, v101
    v_mfma_f32_16x16x32_bf16 v[28:31], a[252:255], v[108:111], v[28:31]
    buffer_load_dwordx4 v[152:155], v71, s[40:43], s75 offen offset:1024 sc1
    v_mul_f32 v98, v98, v102
    v_mul_f32 v99, v99, v103
    s_waitcnt vmcnt(11)
    v_mfma_f32_16x16x32_bf16 v[16:19], v[176:179], v[112:115], v[16:19]
    v_cvt_pk_bf16_f32 v44, v88, v89
    v_cvt_pk_bf16_f32 v45, v90, v91
    v_mfma_f32_16x16x32_bf16 v[20:23], v[180:183], v[112:115], v[20:23]
    v_cvt_pk_bf16_f32 v46, v96, v97
    v_cvt_pk_bf16_f32 v47, v98, v99
    v_mfma_f32_16x16x32_bf16 v[24:27], v[184:187], v[112:115], v[24:27]
    buffer_load_dwordx4 v[156:159], v71, s[40:43], s75 offen offset:2048 sc1
    buffer_store_dwordx4 v[44:47], v69, s[40:43], s72 offen
    v_mfma_f32_16x16x32_bf16 v[28:31], v[188:191], v[112:115], v[28:31]
    s_mov_b32 s72, s92
    s_mov_b32 s74, s94
    s_waitcnt vmcnt(12)
    v_mfma_f32_16x16x32_bf16 v[16:19], v[192:195], v[116:119], v[16:19]
    v_mfma_f32_16x16x32_bf16 v[20:23], v[196:199], v[116:119], v[20:23]
    s_mov_b32 s100, 2
    v_mfma_f32_16x16x32_bf16 v[24:27], v[200:203], v[116:119], v[24:27]
    s_add_u32 s73, s93, 6291456
    s_add_u32 s77, s73, 4096
    v_mfma_f32_16x16x32_bf16 v[28:31], v[204:207], v[116:119], v[28:31]
    s_waitcnt vmcnt(11)
    v_mfma_f32_16x16x32_bf16 v[16:19], v[208:211], v[120:123], v[16:19]
    v_mfma_f32_16x16x32_bf16 v[20:23], v[212:215], v[120:123], v[20:23]
    v_mfma_f32_16x16x32_bf16 v[24:27], v[216:219], v[120:123], v[24:27]
    v_mfma_f32_16x16x32_bf16 v[28:31], v[220:223], v[120:123], v[28:31]
    s_waitcnt vmcnt(10)
    v_mfma_f32_16x16x32_bf16 v[16:19], v[224:227], v[124:127], v[16:19]
    v_mfma_f32_16x16x32_bf16 v[20:23], v[228:231], v[124:127], v[20:23]
    v_mfma_f32_16x16x32_bf16 v[24:27], v[232:235], v[124:127], v[24:27]
    v_mfma_f32_16x16x32_bf16 v[28:31], v[236:239], v[124:127], v[28:31]
    s_waitcnt vmcnt(9)
    v_mfma_f32_16x16x32_bf16 v[16:19], v[240:243], v[128:131], v[16:19]
    v_mfma_f32_16x16x32_bf16 v[20:23], v[244:247], v[128:131], v[20:23]
    v_mfma_f32_16x16x32_bf16 v[24:27], v[248:251], v[128:131], v[24:27]
    v_mfma_f32_16x16x32_bf16 v[28:31], v[252:255], v[128:131], v[28:31]
    s_waitcnt vmcnt(7)
    v_mfma_f32_16x16x32_bf16 v[88:91], a[224:227], v[132:135], 0
    v_mfma_f32_16x16x32_bf16 v[92:95], a[228:231], v[132:135], 0
    v_mfma_f32_16x16x32_bf16 v[96:99], a[232:235], v[132:135], 0
    v_mfma_f32_16x16x32_bf16 v[100:103], a[236:239], v[132:135], 0
    s_waitcnt vmcnt(6)
    v_mfma_f32_16x16x32_bf16 v[88:91], a[240:243], v[136:139], v[88:91]
    ds_write_b128 v65, v[20:23] offset:12288
    v_mfma_f32_16x16x32_bf16 v[92:95], a[244:247], v[136:139], v[92:95]
    v_mfma_f32_16x16x32_bf16 v[96:99], a[248:251], v[136:139], v[96:99]
    ds_write_b128 v66, v[24:27] offset:16384
    v_mfma_f32_16x16x32_bf16 v[100:103], a[252:255], v[136:139], v[100:103]
    s_waitcnt vmcnt(5)
    v_mfma_f32_16x16x32_bf16 v[88:91], v[176:179], v[140:143], v[88:91]
    ds_write_b128 v67, v[28:31] offset:20480
    v_mfma_f32_16x16x32_bf16 v[92:95], v[180:183], v[140:143], v[92:95]
    v_mfma_f32_16x16x32_bf16 v[96:99], v[184:187], v[140:143], v[96:99]
    v_mfma_f32_16x16x32_bf16 v[100:103], v[188:191], v[140:143], v[100:103]
    s_waitcnt lgkmcnt(0)
    s_barrier
    s_waitcnt vmcnt(4)
    v_mfma_f32_16x16x32_bf16 v[88:91], v[192:195], v[144:147], v[88:91]
    buffer_load_dword v75, v78, s[40:43], s81 offen sc1
    v_mfma_f32_16x16x32_bf16 v[92:95], v[196:199], v[144:147], v[92:95]
    ds_read_b128 v[32:35], v68 offset:12288
    ds_read_b128 v[36:39], v68 offset:16384
    v_mfma_f32_16x16x32_bf16 v[96:99], v[200:203], v[144:147], v[96:99]
    ds_read_b128 v[40:43], v68 offset:20480
    v_mfma_f32_16x16x32_bf16 v[100:103], v[204:207], v[144:147], v[100:103]
    s_waitcnt vmcnt(4)
    v_mfma_f32_16x16x32_bf16 v[88:91], v[208:211], v[148:151], v[88:91]
    v_mfma_f32_16x16x32_bf16 v[92:95], v[212:215], v[148:151], v[92:95]
    s_waitcnt lgkmcnt(2)
    v_add_f32 v32, v32, v16
    v_add_f32 v33, v33, v17
    v_mfma_f32_16x16x32_bf16 v[96:99], v[216:219], v[148:151], v[96:99]
    v_add_f32 v34, v34, v18
    v_add_f32 v35, v35, v19
    v_mfma_f32_16x16x32_bf16 v[100:103], v[220:223], v[148:151], v[100:103]
    ds_read_b128 v[48:51], v64 offset:0
    s_waitcnt lgkmcnt(1)
    v_add_f32 v36, v36, v40
    v_add_f32 v37, v37, v41
    s_waitcnt vmcnt(3)
    v_mfma_f32_16x16x32_bf16 v[88:91], v[224:227], v[152:155], v[88:91]
    v_add_f32 v38, v38, v42
    v_add_f32 v39, v39, v43
    v_mfma_f32_16x16x32_bf16 v[92:95], v[228:231], v[152:155], v[92:95]
    v_add_f32 v32, v32, v36
    v_add_f32 v33, v33, v37
    v_mfma_f32_16x16x32_bf16 v[96:99], v[232:235], v[152:155], v[96:99]
    v_add_f32 v34, v34, v38
    v_add_f32 v35, v35, v39
    v_mfma_f32_16x16x32_bf16 v[100:103], v[236:239], v[152:155], v[100:103]
    ds_read_b128 v[52:55], v64 offset:256
    v_cvt_pk_bf16_f32 v32, v32, v33
    v_cvt_pk_bf16_f32 v33, v34, v35
    s_waitcnt vmcnt(2)
    v_mfma_f32_16x16x32_bf16 v[88:91], v[240:243], v[156:159], v[88:91]
    v_mfma_f32_16x16x32_bf16 v[92:95], v[244:247], v[156:159], v[92:95]
    buffer_store_dwordx2 v[32:33], v72, s[40:43], s74 offen
    s_add_u32 s74, s74, 28672
    v_mfma_f32_16x16x32_bf16 v[96:99], v[248:251], v[156:159], v[96:99]
    v_mfma_f32_16x16x32_bf16 v[100:103], v[252:255], v[156:159], v[100:103]
    ds_read_b128 v[56:59], v64 offset:512
.p2align 6
L_blk_78:
    s_waitcnt lgkmcnt(2)
    v_mfma_f32_16x16x32_bf16 v[0:3], a[0:3], v[48:51], 0
    v_mfma_f32_16x16x32_bf16 v[4:7], a[4:7], v[48:51], 0
    v_mfma_f32_16x16x32_bf16 v[8:11], a[8:11], v[48:51], 0
    v_mfma_f32_16x16x32_bf16 v[12:15], a[12:15], v[48:51], 0
    ds_read_b128 v[60:63], v64 offset:768
    s_waitcnt lgkmcnt(2)
    v_mfma_f32_16x16x32_bf16 v[0:3], a[16:19], v[52:55], v[0:3]
    ds_write_b128 v65, v[92:95] offset:0
    v_mfma_f32_16x16x32_bf16 v[4:7], a[20:23], v[52:55], v[4:7]
    v_mfma_f32_16x16x32_bf16 v[8:11], a[24:27], v[52:55], v[8:11]
    v_mfma_f32_16x16x32_bf16 v[12:15], a[28:31], v[52:55], v[12:15]
    ds_read_b128 v[48:51], v64 offset:1024
    s_waitcnt lgkmcnt(3)
    v_mfma_f32_16x16x32_bf16 v[0:3], a[32:35], v[56:59], v[0:3]
    ds_write_b128 v66, v[96:99] offset:4096
    v_mfma_f32_16x16x32_bf16 v[4:7], a[36:39], v[56:59], v[4:7]
    s_waitcnt vmcnt(1)
    v_subrev_u32 v75, v79, v75
    v_mfma_f32_16x16x32_bf16 v[8:11], a[40:43], v[56:59], v[8:11]
    v_cmp_le_u32 vcc, 64, v75
    v_mfma_f32_16x16x32_bf16 v[12:15], a[44:47], v[56:59], v[12:15]
    ds_read_b128 v[52:55], v64 offset:1280
    s_cbranch_vccnz L_sl_46
L_bk_47:
    s_add_u32 m0, s96, 14336
    s_waitcnt lgkmcnt(4)
    v_mfma_f32_16x16x32_bf16 v[0:3], a[48:51], v[60:63], v[0:3]
    buffer_load_dwordx4 v70, s[40:43], s31 offen offset:0 sc1 lds
    v_mfma_f32_16x16x32_bf16 v[4:7], a[52:55], v[60:63], v[4:7]
    v_mfma_f32_16x16x32_bf16 v[8:11], a[56:59], v[60:63], v[8:11]
    v_mfma_f32_16x16x32_bf16 v[12:15], a[60:63], v[60:63], v[12:15]
    ds_read_b128 v[56:59], v64 offset:1536
    s_waitcnt lgkmcnt(3)
    v_mfma_f32_16x16x32_bf16 v[0:3], a[64:67], v[48:51], v[0:3]
    ds_write_b128 v67, v[100:103] offset:8192
    v_mfma_f32_16x16x32_bf16 v[4:7], a[68:71], v[48:51], v[4:7]
    buffer_load_dwordx4 v70, s[40:43], s31 offen offset:1024 sc1 lds
    v_mfma_f32_16x16x32_bf16 v[8:11], a[72:75], v[48:51], v[8:11]
    v_mfma_f32_16x16x32_bf16 v[12:15], a[76:79], v[48:51], v[12:15]
    ds_read_b128 v[60:63], v64 offset:1792
    s_waitcnt lgkmcnt(3)
    v_mfma_f32_16x16x32_bf16 v[0:3], a[80:83], v[52:55], v[0:3]
    s_waitcnt vmcnt(2)
    s_waitcnt vmcnt(2)
    buffer_store_dword v73, off, s[40:43], s80
    v_mfma_f32_16x16x32_bf16 v[4:7], a[84:87], v[52:55], v[4:7]
    v_add_u32 v73, 1, v73
    v_mfma_f32_16x16x32_bf16 v[8:11], a[88:91], v[52:55], v[8:11]
    buffer_load_dwordx4 v70, s[40:43], s31 offen offset:2048 sc1 lds
    v_mfma_f32_16x16x32_bf16 v[12:15], a[92:95], v[52:55], v[12:15]
    ds_read_b128 v[48:51], v64 offset:2048
    s_waitcnt lgkmcnt(3)
    v_mfma_f32_16x16x32_bf16 v[0:3], a[96:99], v[56:59], v[0:3]
    buffer_load_dwordx4 v70, s[40:43], s31 offen offset:3072 sc1 lds
    v_mfma_f32_16x16x32_bf16 v[4:7], a[100:103], v[56:59], v[4:7]
    v_mfma_f32_16x16x32_bf16 v[8:11], a[104:107], v[56:59], v[8:11]
    buffer_load_dwordx4 v[104:107], v71, s[40:43], s73 offen offset:0 sc1
    v_mfma_f32_16x16x32_bf16 v[12:15], a[108:111], v[56:59], v[12:15]
    ds_read_b128 v[52:55], v64 offset:2304
    s_waitcnt lgkmcnt(2)
    v_mfma_f32_16x16x32_bf16 v[0:3], a[112:115], v[60:63], v[0:3]
    v_mfma_f32_16x16x32_bf16 v[4:7], a[116:119], v[60:63], v[4:7]
    v_mfma_f32_16x16x32_bf16 v[8:11], a[120:123], v[60:63], v[8:11]
    buffer_load_dwordx4 v[108:111], v71, s[40:43], s73 offen offset:1024 sc1
    v_mfma_f32_16x16x32_bf16 v[12:15], a[124:127], v[60:63], v[12:15]
    ds_read_b128 v[56:59], v64 offset:2560
    s_waitcnt lgkmcnt(2)
    v_mfma_f32_16x16x32_bf16 v[0:3], a[128:131], v[48:51], v[0:3]
    v_mfma_f32_16x16x32_bf16 v[4:7], a[132:135], v[48:51], v[4:7]
    buffer_load_dwordx4 v[112:115], v71, s[40:43], s73 offen offset:2048 sc1
    v_mfma_f32_16x16x32_bf16 v[8:11], a[136:139], v[48:51], v[8:11]
    v_mfma_f32_16x16x32_bf16 v[12:15], a[140:143], v[48:51], v[12:15]
    ds_read_b128 v[60:63], v64 offset:2816
    s_waitcnt lgkmcnt(2)
    v_mfma_f32_16x16x32_bf16 v[0:3], a[144:147], v[52:55], v[0:3]
    v_mfma_f32_16x16x32_bf16 v[4:7], a[148:151], v[52:55], v[4:7]
    buffer_load_dwordx4 v[116:119], v71, s[40:43], s73 offen offset:3072 sc1
    v_mfma_f32_16x16x32_bf16 v[8:11], a[152:155], v[52:55], v[8:11]
    v_mfma_f32_16x16x32_bf16 v[12:15], a[156:159], v[52:55], v[12:15]
    ds_read_b128 v[48:51], v64 offset:3072
    s_waitcnt lgkmcnt(2)
    v_mfma_f32_16x16x32_bf16 v[0:3], a[160:163], v[56:59], v[0:3]
    buffer_load_dwordx4 v[120:123], v71, s[40:43], s77 offen offset:0 sc1
    v_mfma_f32_16x16x32_bf16 v[4:7], a[164:167], v[56:59], v[4:7]
    v_mfma_f32_16x16x32_bf16 v[8:11], a[168:171], v[56:59], v[8:11]
    v_mfma_f32_16x16x32_bf16 v[12:15], a[172:175], v[56:59], v[12:15]
    ds_read_b128 v[52:55], v64 offset:3328
    s_waitcnt lgkmcnt(2)
    v_mfma_f32_16x16x32_bf16 v[0:3], a[176:179], v[60:63], v[0:3]
    buffer_load_dwordx4 v[124:127], v71, s[40:43], s77 offen offset:1024 sc1
    v_mfma_f32_16x16x32_bf16 v[4:7], a[180:183], v[60:63], v[4:7]
    v_mfma_f32_16x16x32_bf16 v[8:11], a[184:187], v[60:63], v[8:11]
    v_mfma_f32_16x16x32_bf16 v[12:15], a[188:191], v[60:63], v[12:15]
    s_waitcnt lgkmcnt(1)
    v_mfma_f32_16x16x32_bf16 v[0:3], a[192:195], v[48:51], v[0:3]
    buffer_load_dwordx4 v[128:131], v71, s[40:43], s77 offen offset:2048 sc1
    v_mfma_f32_16x16x32_bf16 v[4:7], a[196:199], v[48:51], v[4:7]
    v_mfma_f32_16x16x32_bf16 v[8:11], a[200:203], v[48:51], v[8:11]
    v_mfma_f32_16x16x32_bf16 v[12:15], a[204:207], v[48:51], v[12:15]
    s_waitcnt lgkmcnt(0)
    v_mfma_f32_16x16x32_bf16 v[0:3], a[208:211], v[52:55], v[0:3]
    s_waitcnt vmcnt(7)
    s_barrier
    v_mfma_f32_16x16x32_bf16 v[4:7], a[212:215], v[52:55], v[4:7]
    ds_read_b128 v[32:35], v68 offset:0
    v_mfma_f32_16x16x32_bf16 v[8:11], a[216:219], v[52:55], v[8:11]
    ds_read_b128 v[36:39], v68 offset:4096
    v_mfma_f32_16x16x32_bf16 v[12:15], a[220:223], v[52:55], v[12:15]
    ds_read_b128 v[40:43], v68 offset:8192
    s_waitcnt vmcnt(6)
    v_mfma_f32_16x16x32_bf16 v[16:19], a[224:227], v[104:107], 0
    v_mfma_f32_16x16x32_bf16 v[20:23], a[228:231], v[104:107], 0
    s_add_u32 s73, s73, 28672
    s_add_u32 s77, s73, 4096
    v_mfma_f32_16x16x32_bf16 v[24:27], a[232:235], v[104:107], 0
    s_add_u32 s100, s100, 1
    s_and_b32 s75, s100, 3
    v_mfma_f32_16x16x32_bf16 v[28:31], a[236:239], v[104:107], 0
    s_waitcnt vmcnt(5)
    s_mul_i32 s75, s75, 458752
    s_add_u32 s31, s95, s75
    v_mfma_f32_16x16x32_bf16 v[16:19], a[240:243], v[108:111], v[16:19]
    s_waitcnt lgkmcnt(2)
    v_add_f32 v32, v32, v88
    v_add_f32 v33, v33, v89
    v_mfma_f32_16x16x32_bf16 v[20:23], a[244:247], v[108:111], v[20:23]
    v_add_f32 v34, v34, v90
    v_add_f32 v35, v35, v91
    v_mfma_f32_16x16x32_bf16 v[24:27], a[248:251], v[108:111], v[24:27]
    s_waitcnt lgkmcnt(0)
    v_add_f32 v36, v36, v40
    v_add_f32 v37, v37, v41
    v_mfma_f32_16x16x32_bf16 v[28:31], a[252:255], v[108:111], v[28:31]
    v_add_f32 v38, v38, v42
    v_add_f32 v39, v39, v43
    s_waitcnt vmcnt(4)
    v_mfma_f32_16x16x32_bf16 v[16:19], v[176:179], v[112:115], v[16:19]
    v_add_f32 v32, v32, v36
    v_add_f32 v33, v33, v37
    v_mfma_f32_16x16x32_bf16 v[20:23], v[180:183], v[112:115], v[20:23]
    v_add_f32 v34, v34, v38
    v_add_f32 v35, v35, v39
    v_mfma_f32_16x16x32_bf16 v[24:27], v[184:187], v[112:115], v[24:27]
    v_cvt_pk_bf16_f32 v32, v32, v33
    v_cvt_pk_bf16_f32 v33, v34, v35
    v_mfma_f32_16x16x32_bf16 v[28:31], v[188:191], v[112:115], v[28:31]
    buffer_store_dwordx2 v[32:33], v72, s[40:43], s74 offen
    s_waitcnt vmcnt(4)
    v_mfma_f32_16x16x32_bf16 v[16:19], v[192:195], v[116:119], v[16:19]
    v_mul_f32 v0, v0, v4
    v_mul_f32 v1, v1, v5
    buffer_load_dword v75, v78, s[40:43], s81 offen sc1
    v_mfma_f32_16x16x32_bf16 v[20:23], v[196:199], v[116:119], v[20:23]
    v_mul_f32 v2, v2, v6
    v_mul_f32 v3, v3, v7
    v_add_u32 v79, 1, v79
    v_mfma_f32_16x16x32_bf16 v[24:27], v[200:203], v[116:119], v[24:27]
    v_mul_f32 v8, v8, v12
    v_mul_f32 v9, v9, v13
    v_mfma_f32_16x16x32_bf16 v[28:31], v[204:207], v[116:119], v[28:31]
    s_waitcnt vmcnt(4)
    v_mul_f32 v10, v10, v14
    v_mul_f32 v11, v11, v15
    v_mfma_f32_16x16x32_bf16 v[16:19], v[208:211], v[120:123], v[16:19]
    v_cvt_pk_bf16_f32 v44, v0, v1
    v_cvt_pk_bf16_f32 v45, v2, v3
    v_mfma_f32_16x16x32_bf16 v[20:23], v[212:215], v[120:123], v[20:23]
    v_cvt_pk_bf16_f32 v46, v8, v9
    v_cvt_pk_bf16_f32 v47, v10, v11
    v_mfma_f32_16x16x32_bf16 v[24:27], v[216:219], v[120:123], v[24:27]
    buffer_store_dwordx4 v[44:47], v69, s[40:43], s72 offen
    v_mfma_f32_16x16x32_bf16 v[28:31], v[220:223], v[120:123], v[28:31]
    ds_read_b128 v[56:59], v64 offset:14336
    s_waitcnt vmcnt(4)
    v_mfma_f32_16x16x32_bf16 v[16:19], v[224:227], v[124:127], v[16:19]
    v_mfma_f32_16x16x32_bf16 v[20:23], v[228:231], v[124:127], v[20:23]
    v_mfma_f32_16x16x32_bf16 v[24:27], v[232:235], v[124:127], v[24:27]
    s_xor_b32 s30, s30, 57344
    s_add_u32 s74, s30, s94
    v_mfma_f32_16x16x32_bf16 v[28:31], v[236:239], v[124:127], v[28:31]
    ds_read_b128 v[60:63], v64 offset:14592
    s_waitcnt vmcnt(3)
    v_mfma_f32_16x16x32_bf16 v[16:19], v[240:243], v[128:131], v[16:19]
    s_add_u32 s72, s72, 28672
    v_mfma_f32_16x16x32_bf16 v[20:23], v[244:247], v[128:131], v[20:23]
    v_mfma_f32_16x16x32_bf16 v[24:27], v[248:251], v[128:131], v[24:27]
    v_mfma_f32_16x16x32_bf16 v[28:31], v[252:255], v[128:131], v[28:31]
    ds_read_b128 v[48:51], v64 offset:14848
    s_waitcnt lgkmcnt(2)
    v_mfma_f32_16x16x32_bf16 v[0:3], a[0:3], v[56:59], 0
    v_mfma_f32_16x16x32_bf16 v[4:7], a[4:7], v[56:59], 0
    v_mfma_f32_16x16x32_bf16 v[8:11], a[8:11], v[56:59], 0
    v_mfma_f32_16x16x32_bf16 v[12:15], a[12:15], v[56:59], 0
    ds_read_b128 v[52:55], v64 offset:15104
    s_waitcnt lgkmcnt(2)
    v_mfma_f32_16x16x32_bf16 v[0:3], a[16:19], v[60:63], v[0:3]
    ds_write_b128 v65, v[20:23] offset:12288
    v_mfma_f32_16x16x32_bf16 v[4:7], a[20:23], v[60:63], v[4:7]
    v_mfma_f32_16x16x32_bf16 v[8:11], a[24:27], v[60:63], v[8:11]
    v_mfma_f32_16x16x32_bf16 v[12:15], a[28:31], v[60:63], v[12:15]
    ds_read_b128 v[56:59], v64 offset:15360
    s_waitcnt lgkmcnt(3)
    v_mfma_f32_16x16x32_bf16 v[0:3], a[32:35], v[48:51], v[0:3]
    ds_write_b128 v66, v[24:27] offset:16384
    v_mfma_f32_16x16x32_bf16 v[4:7], a[36:39], v[48:51], v[4:7]
    s_waitcnt vmcnt(1)
    v_subrev_u32 v75, v79, v75
    v_mfma_f32_16x16x32_bf16 v[8:11], a[40:43], v[48:51], v[8:11]
    v_cmp_le_u32 vcc, 64, v75
    v_mfma_f32_16x16x32_bf16 v[12:15], a[44:47], v[48:51], v[12:15]
    ds_read_b128 v[60:63], v64 offset:15616
    s_cbranch_vccnz L_sl_50
L_bk_51:
    s_add_u32 m0, s96, 0
    s_waitcnt lgkmcnt(4)
    v_mfma_f32_16x16x32_bf16 v[0:3], a[48:51], v[52:55], v[0:3]
    buffer_load_dwordx4 v70, s[40:43], s31 offen offset:0 sc1 lds
    v_mfma_f32_16x16x32_bf16 v[4:7], a[52:55], v[52:55], v[4:7]
    v_mfma_f32_16x16x32_bf16 v[8:11], a[56:59], v[52:55], v[8:11]
    v_mfma_f32_16x16x32_bf16 v[12:15], a[60:63], v[52:55], v[12:15]
    ds_read_b128 v[48:51], v64 offset:15872
    s_waitcnt lgkmcnt(3)
    v_mfma_f32_16x16x32_bf16 v[0:3], a[64:67], v[56:59], v[0:3]
    ds_write_b128 v67, v[28:31] offset:20480
    v_mfma_f32_16x16x32_bf16 v[4:7], a[68:71], v[56:59], v[4:7]
    buffer_load_dwordx4 v70, s[40:43], s31 offen offset:1024 sc1 lds
    v_mfma_f32_16x16x32_bf16 v[8:11], a[72:75], v[56:59], v[8:11]
    v_mfma_f32_16x16x32_bf16 v[12:15], a[76:79], v[56:59], v[12:15]
    ds_read_b128 v[52:55], v64 offset:16128
    s_waitcnt lgkmcnt(3)
    v_mfma_f32_16x16x32_bf16 v[0:3], a[80:83], v[60:63], v[0:3]
    s_waitcnt vmcnt(2)
    buffer_store_dword v73, off, s[40:43], s80
    v_mfma_f32_16x16x32_bf16 v[4:7], a[84:87], v[60:63], v[4:7]
    v_add_u32 v73, 1, v73
    v_mfma_f32_16x16x32_bf16 v[8:11], a[88:91], v[60:63], v[8:11]
    buffer_load_dwordx4 v70, s[40:43], s31 offen offset:2048 sc1 lds
    v_mfma_f32_16x16x32_bf16 v[12:15], a[92:95], v[60:63], v[12:15]
    ds_read_b128 v[56:59], v64 offset:16384
    s_waitcnt lgkmcnt(3)
    v_mfma_f32_16x16x32_bf16 v[0:3], a[96:99], v[48:51], v[0:3]
    buffer_load_dwordx4 v70, s[40:43], s31 offen offset:3072 sc1 lds
    v_mfma_f32_16x16x32_bf16 v[4:7], a[100:103], v[48:51], v[4:7]
    v_mfma_f32_16x16x32_bf16 v[8:11], a[104:107], v[48:51], v[8:11]
    buffer_load_dwordx4 v[104:107], v71, s[40:43], s73 offen offset:0 sc1
    v_mfma_f32_16x16x32_bf16 v[12:15], a[108:111], v[48:51], v[12:15]
    ds_read_b128 v[60:63], v64 offset:16640
    s_waitcnt lgkmcnt(2)
    v_mfma_f32_16x16x32_bf16 v[0:3], a[112:115], v[52:55], v[0:3]
    v_mfma_f32_16x16x32_bf16 v[4:7], a[116:119], v[52:55], v[4:7]
    v_mfma_f32_16x16x32_bf16 v[8:11], a[120:123], v[52:55], v[8:11]
    buffer_load_dwordx4 v[108:111], v71, s[40:43], s73 offen offset:1024 sc1
    v_mfma_f32_16x16x32_bf16 v[12:15], a[124:127], v[52:55], v[12:15]
    ds_read_b128 v[48:51], v64 offset:16896
    s_waitcnt lgkmcnt(2)
    v_mfma_f32_16x16x32_bf16 v[0:3], a[128:131], v[56:59], v[0:3]
    v_mfma_f32_16x16x32_bf16 v[4:7], a[132:135], v[56:59], v[4:7]
    buffer_load_dwordx4 v[112:115], v71, s[40:43], s73 offen offset:2048 sc1
    v_mfma_f32_16x16x32_bf16 v[8:11], a[136:139], v[56:59], v[8:11]
    v_mfma_f32_16x16x32_bf16 v[12:15], a[140:143], v[56:59], v[12:15]
    ds_read_b128 v[52:55], v64 offset:17152
    s_waitcnt lgkmcnt(2)
    v_mfma_f32_16x16x32_bf16 v[0:3], a[144:147], v[60:63], v[0:3]
    v_mfma_f32_16x16x32_bf16 v[4:7], a[148:151], v[60:63], v[4:7]
    buffer_load_dwordx4 v[116:119], v71, s[40:43], s73 offen offset:3072 sc1
    v_mfma_f32_16x16x32_bf16 v[8:11], a[152:155], v[60:63], v[8:11]
    v_mfma_f32_16x16x32_bf16 v[12:15], a[156:159], v[60:63], v[12:15]
    ds_read_b128 v[56:59], v64 offset:17408
    s_waitcnt lgkmcnt(2)
    v_mfma_f32_16x16x32_bf16 v[0:3], a[160:163], v[48:51], v[0:3]
    buffer_load_dwordx4 v[120:123], v71, s[40:43], s77 offen offset:0 sc1
    v_mfma_f32_16x16x32_bf16 v[4:7], a[164:167], v[48:51], v[4:7]
    v_mfma_f32_16x16x32_bf16 v[8:11], a[168:171], v[48:51], v[8:11]
    v_mfma_f32_16x16x32_bf16 v[12:15], a[172:175], v[48:51], v[12:15]
    ds_read_b128 v[60:63], v64 offset:17664
    s_waitcnt lgkmcnt(2)
    v_mfma_f32_16x16x32_bf16 v[0:3], a[176:179], v[52:55], v[0:3]
    buffer_load_dwordx4 v[124:127], v71, s[40:43], s77 offen offset:1024 sc1
    v_mfma_f32_16x16x32_bf16 v[4:7], a[180:183], v[52:55], v[4:7]
    v_mfma_f32_16x16x32_bf16 v[8:11], a[184:187], v[52:55], v[8:11]
    v_mfma_f32_16x16x32_bf16 v[12:15], a[188:191], v[52:55], v[12:15]
    s_waitcnt lgkmcnt(1)
    v_mfma_f32_16x16x32_bf16 v[0:3], a[192:195], v[56:59], v[0:3]
    buffer_load_dwordx4 v[128:131], v71, s[40:43], s77 offen offset:2048 sc1
    v_mfma_f32_16x16x32_bf16 v[4:7], a[196:199], v[56:59], v[4:7]
    v_mfma_f32_16x16x32_bf16 v[8:11], a[200:203], v[56:59], v[8:11]
    v_mfma_f32_16x16x32_bf16 v[12:15], a[204:207], v[56:59], v[12:15]
    s_waitcnt lgkmcnt(0)
    v_mfma_f32_16x16x32_bf16 v[0:3], a[208:211], v[60:63], v[0:3]
    s_waitcnt vmcnt(7)
    s_barrier
    v_mfma_f32_16x16x32_bf16 v[4:7], a[212:215], v[60:63], v[4:7]
    ds_read_b128 v[32:35], v68 offset:12288
    v_mfma_f32_16x16x32_bf16 v[8:11], a[216:219], v[60:63], v[8:11]
    ds_read_b128 v[36:39], v68 offset:16384
    v_mfma_f32_16x16x32_bf16 v[12:15], a[220:223], v[60:63], v[12:15]
    ds_read_b128 v[40:43], v68 offset:20480
    s_waitcnt vmcnt(6)
    v_mfma_f32_16x16x32_bf16 v[88:91], a[224:227], v[104:107], 0
    v_mfma_f32_16x16x32_bf16 v[92:95], a[228:231], v[104:107], 0
    s_add_u32 s73, s93, s89
    s_add_u32 s77, s73, 4096
    v_mfma_f32_16x16x32_bf16 v[96:99], a[232:235], v[104:107], 0
    s_xor_b32 s89, s89, 6291456
    s_add_u32 s31, s31, 14336
    v_mfma_f32_16x16x32_bf16 v[100:103], a[236:239], v[104:107], 0
    s_waitcnt vmcnt(5)
    v_mfma_f32_16x16x32_bf16 v[88:91], a[240:243], v[108:111], v[88:91]
    s_waitcnt lgkmcnt(2)
    v_add_f32 v32, v32, v16
    v_add_f32 v33, v33, v17
    v_mfma_f32_16x16x32_bf16 v[92:95], a[244:247], v[108:111], v[92:95]
    v_add_f32 v34, v34, v18
    v_add_f32 v35, v35, v19
    v_mfma_f32_16x16x32_bf16 v[96:99], a[248:251], v[108:111], v[96:99]
    s_waitcnt lgkmcnt(0)
    v_add_f32 v36, v36, v40
    v_add_f32 v37, v37, v41
    v_mfma_f32_16x16x32_bf16 v[100:103], a[252:255], v[108:111], v[100:103]
    v_add_f32 v38, v38, v42
    v_add_f32 v39, v39, v43
    s_waitcnt vmcnt(4)
    v_mfma_f32_16x16x32_bf16 v[88:91], v[176:179], v[112:115], v[88:91]
    v_add_f32 v32, v32, v36
    v_add_f32 v33, v33, v37
    v_mfma_f32_16x16x32_bf16 v[92:95], v[180:183], v[112:115], v[92:95]
    v_add_f32 v34, v34, v38
    v_add_f32 v35, v35, v39
    v_mfma_f32_16x16x32_bf16 v[96:99], v[184:187], v[112:115], v[96:99]
    v_cvt_pk_bf16_f32 v32, v32, v33
    v_cvt_pk_bf16_f32 v33, v34, v35
    v_mfma_f32_16x16x32_bf16 v[100:103], v[188:191], v[112:115], v[100:103]
    buffer_store_dwordx2 v[32:33], v72, s[40:43], s74 offen
    s_waitcnt vmcnt(4)
    v_mfma_f32_16x16x32_bf16 v[88:91], v[192:195], v[116:119], v[88:91]
    v_mul_f32 v0, v0, v4
    v_mul_f32 v1, v1, v5
    buffer_load_dword v75, v78, s[40:43], s81 offen sc1
    v_mfma_f32_16x16x32_bf16 v[92:95], v[196:199], v[116:119], v[92:95]
    v_mul_f32 v2, v2, v6
    v_mul_f32 v3, v3, v7
    v_add_u32 v79, 1, v79
    v_mfma_f32_16x16x32_bf16 v[96:99], v[200:203], v[116:119], v[96:99]
    v_mul_f32 v8, v8, v12
    v_mul_f32 v9, v9, v13
    v_mfma_f32_16x16x32_bf16 v[100:103], v[204:207], v[116:119], v[100:103]
    s_waitcnt vmcnt(4)
    v_mul_f32 v10, v10, v14
    v_mul_f32 v11, v11, v15
    v_mfma_f32_16x16x32_bf16 v[88:91], v[208:211], v[120:123], v[88:91]
    v_cvt_pk_bf16_f32 v44, v0, v1
    v_cvt_pk_bf16_f32 v45, v2, v3
    v_mfma_f32_16x16x32_bf16 v[92:95], v[212:215], v[120:123], v[92:95]
    v_cvt_pk_bf16_f32 v46, v8, v9
    v_cvt_pk_bf16_f32 v47, v10, v11
    v_mfma_f32_16x16x32_bf16 v[96:99], v[216:219], v[120:123], v[96:99]
    buffer_store_dwordx4 v[44:47], v69, s[40:43], s72 offen
    v_mfma_f32_16x16x32_bf16 v[100:103], v[220:223], v[120:123], v[100:103]
    ds_read_b128 v[48:51], v64 offset:0
    s_waitcnt vmcnt(4)
    v_mfma_f32_16x16x32_bf16 v[88:91], v[224:227], v[124:127], v[88:91]
    v_mfma_f32_16x16x32_bf16 v[92:95], v[228:231], v[124:127], v[92:95]
    v_mfma_f32_16x16x32_bf16 v[96:99], v[232:235], v[124:127], v[96:99]
    s_add_u32 s74, s74, 28672
    s_add_u32 s72, s92, s89
    v_mfma_f32_16x16x32_bf16 v[100:103], v[236:239], v[124:127], v[100:103]
    ds_read_b128 v[52:55], v64 offset:256
    s_waitcnt vmcnt(3)
    v_mfma_f32_16x16x32_bf16 v[88:91], v[240:243], v[128:131], v[88:91]
    v_mfma_f32_16x16x32_bf16 v[92:95], v[244:247], v[128:131], v[92:95]
    v_mfma_f32_16x16x32_bf16 v[96:99], v[248:251], v[128:131], v[96:99]
    v_mfma_f32_16x16x32_bf16 v[100:103], v[252:255], v[128:131], v[100:103]
    ds_read_b128 v[56:59], v64 offset:512
    s_cmp_lt_u32 s100, 7
    s_cbranch_scc1 L_blk_78
    s_waitcnt lgkmcnt(2)
    v_mfma_f32_16x16x32_bf16 v[0:3], a[0:3], v[48:51], 0
    v_mfma_f32_16x16x32_bf16 v[4:7], a[4:7], v[48:51], 0
    v_mfma_f32_16x16x32_bf16 v[8:11], a[8:11], v[48:51], 0
    v_mfma_f32_16x16x32_bf16 v[12:15], a[12:15], v[48:51], 0
    ds_read_b128 v[60:63], v64 offset:768
    s_waitcnt lgkmcnt(2)
    v_mfma_f32_16x16x32_bf16 v[0:3], a[16:19], v[52:55], v[0:3]
    ds_write_b128 v65, v[92:95] offset:0
    v_mfma_f32_16x16x32_bf16 v[4:7], a[20:23], v[52:55], v[4:7]
    v_mfma_f32_16x16x32_bf16 v[8:11], a[24:27], v[52:55], v[8:11]
    ds_write_b128 v66, v[96:99] offset:4096
    v_mfma_f32_16x16x32_bf16 v[12:15], a[28:31], v[52:55], v[12:15]
    ds_read_b128 v[48:51], v64 offset:1024
    s_waitcnt lgkmcnt(4)
    v_mfma_f32_16x16x32_bf16 v[0:3], a[32:35], v[56:59], v[0:3]
    ds_write_b128 v67, v[100:103] offset:8192
    v_mfma_f32_16x16x32_bf16 v[4:7], a[36:39], v[56:59], v[4:7]
    s_waitcnt vmcnt(1)
    v_subrev_u32 v75, v79, v75
    v_mfma_f32_16x16x32_bf16 v[8:11], a[40:43], v[56:59], v[8:11]
    v_cmp_le_u32 vcc, 64, v75
    v_mfma_f32_16x16x32_bf16 v[12:15], a[44:47], v[56:59], v[12:15]
    ds_read_b128 v[52:55], v64 offset:1280
    s_cbranch_vccz L_bk_55
    s_mov_b32 s71, 0
L_wp_56:
    buffer_load_dword v75, v78, s[40:43], s81 offen sc1
    s_waitcnt vmcnt(0)
    v_subrev_u32 v75, v79, v75
    v_cmp_le_u32 vcc, 64, v75
    s_add_u32 s71, s71, 1
    s_cmp_eq_u64 vcc, 0
    s_cbranch_scc1 L_wpd_57
    s_cmp_lt_u32 s71, 131072
    s_cbranch_scc1 L_wp_56
L_wpd_57:
L_bk_55:
    s_add_u32 m0, s96, 14336
    s_waitcnt lgkmcnt(5)
    v_mfma_f32_16x16x32_bf16 v[0:3], a[48:51], v[60:63], v[0:3]
    buffer_load_dwordx4 v70, s[40:43], s31 offen offset:0 sc1 lds
    v_mfma_f32_16x16x32_bf16 v[4:7], a[52:55], v[60:63], v[4:7]
    v_mfma_f32_16x16x32_bf16 v[8:11], a[56:59], v[60:63], v[8:11]
    v_mfma_f32_16x16x32_bf16 v[12:15], a[60:63], v[60:63], v[12:15]
    ds_read_b128 v[56:59], v64 offset:1536
    s_waitcnt lgkmcnt(3)
    v_mfma_f32_16x16x32_bf16 v[0:3], a[64:67], v[48:51], v[0:3]
    buffer_load_dwordx4 v70, s[40:43], s31 offen offset:1024 sc1 lds
    v_mfma_f32_16x16x32_bf16 v[4:7], a[68:71], v[48:51], v[4:7]
    v_mfma_f32_16x16x32_bf16 v[8:11], a[72:75], v[48:51], v[8:11]
    v_mfma_f32_16x16x32_bf16 v[12:15], a[76:79], v[48:51], v[12:15]
    ds_read_b128 v[60:63], v64 offset:1792
    s_waitcnt lgkmcnt(2)
    v_mfma_f32_16x16x32_bf16 v[0:3], a[80:83], v[52:55], v[0:3]
    buffer_load_dwordx4 v70, s[40:43], s31 offen offset:2048 sc1 lds
    v_mfma_f32_16x16x32_bf16 v[4:7], a[84:87], v[52:55], v[4:7]
    s_waitcnt vmcnt(3)
    buffer_store_dword v73, off, s[40:43], s80
    v_mfma_f32_16x16x32_bf16 v[8:11], a[88:91], v[52:55], v[8:11]
    v_add_u32 v73, 1, v73
    v_add_u32 v79, 1, v79
    v_mfma_f32_16x16x32_bf16 v[12:15], a[92:95], v[52:55], v[12:15]
    ds_read_b128 v[48:51], v64 offset:2048
    s_waitcnt lgkmcnt(2)
    v_mfma_f32_16x16x32_bf16 v[0:3], a[96:99], v[56:59], v[0:3]
    buffer_load_dwordx4 v70, s[40:43], s31 offen offset:3072 sc1 lds
    v_mfma_f32_16x16x32_bf16 v[4:7], a[100:103], v[56:59], v[4:7]
    v_mfma_f32_16x16x32_bf16 v[8:11], a[104:107], v[56:59], v[8:11]
    buffer_load_dwordx4 v[104:107], v71, s[40:43], s73 offen offset:0 sc1
    v_mfma_f32_16x16x32_bf16 v[12:15], a[108:111], v[56:59], v[12:15]
    ds_read_b128 v[52:55], v64 offset:2304
    s_waitcnt lgkmcnt(2)
    v_mfma_f32_16x16x32_bf16 v[0:3], a[112:115], v[60:63], v[0:3]
    v_mfma_f32_16x16x32_bf16 v[4:7], a[116:119], v[60:63], v[4:7]
    v_mfma_f32_16x16x32_bf16 v[8:11], a[120:123], v[60:63], v[8:11]
    buffer_load_dwordx4 v[108:111], v71, s[40:43], s73 offen offset:1024 sc1
    v_mfma_f32_16x16x32_bf16 v[12:15], a[124:127], v[60:63], v[12:15]
    ds_read_b128 v[56:59], v64 offset:2560
    s_waitcnt lgkmcnt(2)
    v_mfma_f32_16x16x32_bf16 v[0:3], a[128:131], v[48:51], v[0:3]
    v_mfma_f32_16x16x32_bf16 v[4:7], a[132:135], v[48:51], v[4:7]
    v_mfma_f32_16x16x32_bf16 v[8:11], a[136:139], v[48:51], v[8:11]
    buffer_load_dwordx4 v[112:115], v71, s[40:43], s73 offen offset:2048 sc1
    v_mfma_f32_16x16x32_bf16 v[12:15], a[140:143], v[48:51], v[12:15]
    ds_read_b128 v[60:63], v64 offset:2816
    s_waitcnt lgkmcnt(2)
    v_mfma_f32_16x16x32_bf16 v[0:3], a[144:147], v[52:55], v[0:3]
    v_mfma_f32_16x16x32_bf16 v[4:7], a[148:151], v[52:55], v[4:7]
    v_mfma_f32_16x16x32_bf16 v[8:11], a[152:155], v[52:55], v[8:11]
    buffer_load_dwordx4 v[116:119], v71, s[40:43], s73 offen offset:3072 sc1
    v_mfma_f32_16x16x32_bf16 v[12:15], a[156:159], v[52:55], v[12:15]
    ds_read_b128 v[48:51], v64 offset:3072
    s_waitcnt lgkmcnt(2)
    v_mfma_f32_16x16x32_bf16 v[0:3], a[160:163], v[56:59], v[0:3]
    v_mfma_f32_16x16x32_bf16 v[4:7], a[164:167], v[56:59], v[4:7]
    buffer_load_dword v75, v78, s[40:43], s81 offen sc1
    v_mfma_f32_16x16x32_bf16 v[8:11], a[168:171], v[56:59], v[8:11]
    buffer_load_dwordx4 v[120:123], v71, s[40:43], s77 offen offset:0 sc1
    v_mfma_f32_16x16x32_bf16 v[12:15], a[172:175], v[56:59], v[12:15]
    ds_read_b128 v[52:55], v64 offset:3328
    s_waitcnt lgkmcnt(2)
    v_mfma_f32_16x16x32_bf16 v[0:3], a[176:179], v[60:63], v[0:3]
    v_mfma_f32_16x16x32_bf16 v[4:7], a[180:183], v[60:63], v[4:7]
    s_waitcnt vmcnt(6)
    s_barrier
    v_mfma_f32_16x16x32_bf16 v[8:11], a[184:187], v[60:63], v[8:11]
    buffer_load_dwordx4 v[124:127], v71, s[40:43], s77 offen offset:1024 sc1
    v_mfma_f32_16x16x32_bf16 v[12:15], a[188:191], v[60:63], v[12:15]
    ds_read_b128 v[56:59], v64 offset:14336
    s_waitcnt lgkmcnt(2)
    v_mfma_f32_16x16x32_bf16 v[0:3], a[192:195], v[48:51], v[0:3]
    v_mfma_f32_16x16x32_bf16 v[4:7], a[196:199], v[48:51], v[4:7]
    v_mfma_f32_16x16x32_bf16 v[8:11], a[200:203], v[48:51], v[8:11]
    buffer_load_dwordx4 v[128:131], v71, s[40:43], s77 offen offset:2048 sc1
    v_mfma_f32_16x16x32_bf16 v[12:15], a[204:207], v[48:51], v[12:15]
    ds_read_b128 v[60:63], v64 offset:14592
    s_waitcnt lgkmcnt(2)
    v_mfma_f32_16x16x32_bf16 v[0:3], a[208:211], v[52:55], v[0:3]
    ds_read_b128 v[32:35], v68 offset:0
    v_mfma_f32_16x16x32_bf16 v[4:7], a[212:215], v[52:55], v[4:7]
    ds_read_b128 v[36:39], v68 offset:4096
    s_add_u32 s73, s93, 28672
    s_add_u32 s77, s73, 4096
    v_mfma_f32_16x16x32_bf16 v[8:11], a[216:219], v[52:55], v[8:11]
    ds_read_b128 v[40:43], v68 offset:8192
    v_mfma_f32_16x16x32_bf16 v[12:15], a[220:223], v[52:55], v[12:15]
    ds_read_b128 v[48:51], v64 offset:14848
    s_waitcnt lgkmcnt(5)
    v_mfma_f32_16x16x32_bf16 v[160:163], a[0:3], v[56:59], 0
    v_mfma_f32_16x16x32_bf16 v[164:167], a[4:7], v[56:59], 0
    v_mfma_f32_16x16x32_bf16 v[168:171], a[8:11], v[56:59], 0
    v_mfma_f32_16x16x32_bf16 v[172:175], a[12:15], v[56:59], 0
    ds_read_b128 v[52:55], v64 offset:15104
    s_waitcnt lgkmcnt(5)
    v_mfma_f32_16x16x32_bf16 v[160:163], a[16:19], v[60:63], v[160:163]
    v_mul_f32 v0, v0, v4
    v_mul_f32 v1, v1, v5
    v_mfma_f32_16x16x32_bf16 v[164:167], a[20:23], v[60:63], v[164:167]
    v_mul_f32 v2, v2, v6
    v_mul_f32 v3, v3, v7
    v_mfma_f32_16x16x32_bf16 v[168:171], a[24:27], v[60:63], v[168:171]
    v_mul_f32 v8, v8, v12
    v_mul_f32 v9, v9, v13
    v_mfma_f32_16x16x32_bf16 v[172:175], a[28:31], v[60:63], v[172:175]
    ds_read_b128 v[56:59], v64 offset:15360
    v_mul_f32 v10, v10, v14
    v_mul_f32 v11, v11, v15
    s_waitcnt lgkmcnt(2)
    v_mfma_f32_16x16x32_bf16 v[160:163], a[32:35], v[48:51], v[160:163]
    v_cvt_pk_bf16_f32 v44, v0, v1
    v_cvt_pk_bf16_f32 v45, v2, v3
    v_mfma_f32_16x16x32_bf16 v[164:167], a[36:39], v[48:51], v[164:167]
    v_cvt_pk_bf16_f32 v46, v8, v9
    v_cvt_pk_bf16_f32 v47, v10, v11
    v_mfma_f32_16x16x32_bf16 v[168:171], a[40:43], v[48:51], v[168:171]
    buffer_store_dwordx4 v[44:47], v69, s[40:43], s72 offen
    v_mfma_f32_16x16x32_bf16 v[172:175], a[44:47], v[48:51], v[172:175]
    ds_read_b128 v[60:63], v64 offset:15616
    s_waitcnt lgkmcnt(2)
    v_mfma_f32_16x16x32_bf16 v[160:163], a[48:51], v[52:55], v[160:163]
    s_waitcnt vmcnt(4)
    v_subrev_u32 v75, v79, v75
    v_mfma_f32_16x16x32_bf16 v[164:167], a[52:55], v[52:55], v[164:167]
    v_cmp_le_u32 vcc, 64, v75
    v_mfma_f32_16x16x32_bf16 v[168:171], a[56:59], v[52:55], v[168:171]
    s_cbranch_vccz L_bk_59
    s_mov_b32 s71, 0
L_wp_60:
    buffer_load_dword v75, v78, s[40:43], s81 offen sc1
    s_waitcnt vmcnt(0)
    v_subrev_u32 v75, v79, v75
    v_cmp_le_u32 vcc, 64, v75
    s_add_u32 s71, s71, 1
    s_cmp_eq_u64 vcc, 0
    s_cbranch_scc1 L_wpd_61
    s_cmp_lt_u32 s71, 131072
    s_cbranch_scc1 L_wp_60
L_wpd_61:
L_bk_59:
    v_mfma_f32_16x16x32_bf16 v[172:175], a[60:63], v[52:55], v[172:175]
    ds_read_b128 v[48:51], v64 offset:15872
    s_waitcnt lgkmcnt(2)
    v_mfma_f32_16x16x32_bf16 v[160:163], a[64:67], v[56:59], v[160:163]
    v_add_f32 v32, v32, v88
    v_add_f32 v33, v33, v89
    v_mfma_f32_16x16x32_bf16 v[164:167], a[68:71], v[56:59], v[164:167]
    v_add_f32 v34, v34, v90
    v_add_f32 v35, v35, v91
    v_mfma_f32_16x16x32_bf16 v[168:171], a[72:75], v[56:59], v[168:171]
    v_add_f32 v36, v36, v40
    v_add_f32 v37, v37, v41
    v_mfma_f32_16x16x32_bf16 v[172:175], a[76:79], v[56:59], v[172:175]
    ds_read_b128 v[52:55], v64 offset:16128
    v_add_f32 v38, v38, v42
    v_add_f32 v39, v39, v43
    s_waitcnt lgkmcnt(2)
    v_mfma_f32_16x16x32_bf16 v[160:163], a[80:83], v[60:63], v[160:163]
    v_add_f32 v32, v32, v36
    v_add_f32 v33, v33, v37
    v_mfma_f32_16x16x32_bf16 v[164:167], a[84:87], v[60:63], v[164:167]
    v_add_f32 v34, v34, v38
    v_add_f32 v35, v35, v39
    v_mfma_f32_16x16x32_bf16 v[168:171], a[88:91], v[60:63], v[168:171]
    v_cvt_pk_bf16_f32 v32, v32, v33
    v_cvt_pk_bf16_f32 v33, v34, v35
    v_mfma_f32_16x16x32_bf16 v[172:175], a[92:95], v[60:63], v[172:175]
    ds_read_b128 v[56:59], v64 offset:16384
    s_waitcnt lgkmcnt(2)
    v_mfma_f32_16x16x32_bf16 v[160:163], a[96:99], v[48:51], v[160:163]
    buffer_store_dwordx2 v[32:33], v72, s[40:43], s74 offen
    v_add_u32 v79, 1, v79
    v_mfma_f32_16x16x32_bf16 v[164:167], a[100:103], v[48:51], v[164:167]
    buffer_load_dwordx4 v[132:135], v71, s[40:43], s73 offen offset:0 sc1
    v_mfma_f32_16x16x32_bf16 v[168:171], a[104:107], v[48:51], v[168:171]
    s_add_u32 s72, s72, 28672
    s_mov_b32 s74, s94
    v_mfma_f32_16x16x32_bf16 v[172:175], a[108:111], v[48:51], v[172:175]
    ds_read_b128 v[60:63], v64 offset:16640
    s_waitcnt lgkmcnt(2)
    v_mfma_f32_16x16x32_bf16 v[160:163], a[112:115], v[52:55], v[160:163]
    v_mfma_f32_16x16x32_bf16 v[164:167], a[116:119], v[52:55], v[164:167]
    buffer_load_dwordx4 v[136:139], v71, s[40:43], s73 offen offset:1024 sc1
    v_mfma_f32_16x16x32_bf16 v[168:171], a[120:123], v[52:55], v[168:171]
    v_mfma_f32_16x16x32_bf16 v[172:175], a[124:127], v[52:55], v[172:175]
    ds_read_b128 v[48:51], v64 offset:16896
    s_waitcnt lgkmcnt(2)
    v_mfma_f32_16x16x32_bf16 v[160:163], a[128:131], v[56:59], v[160:163]
    v_mfma_f32_16x16x32_bf16 v[164:167], a[132:135], v[56:59], v[164:167]
    buffer_load_dwordx4 v[140:143], v71, s[40:43], s73 offen offset:2048 sc1
    v_mfma_f32_16x16x32_bf16 v[168:171], a[136:139], v[56:59], v[168:171]
    v_mfma_f32_16x16x32_bf16 v[172:175], a[140:143], v[56:59], v[172:175]
    ds_read_b128 v[52:55], v64 offset:17152
    s_waitcnt lgkmcnt(2)
    v_mfma_f32_16x16x32_bf16 v[160:163], a[144:147], v[60:63], v[160:163]
    v_mfma_f32_16x16x32_bf16 v[164:167], a[148:151], v[60:63], v[164:167]
    buffer_load_dwordx4 v[144:147], v71, s[40:43], s73 offen offset:3072 sc1
    v_mfma_f32_16x16x32_bf16 v[168:171], a[152:155], v[60:63], v[168:171]
    v_mfma_f32_16x16x32_bf16 v[172:175], a[156:159], v[60:63], v[172:175]
    ds_read_b128 v[56:59], v64 offset:17408
    s_waitcnt lgkmcnt(2)
    v_mfma_f32_16x16x32_bf16 v[160:163], a[160:163], v[48:51], v[160:163]
    v_mfma_f32_16x16x32_bf16 v[164:167], a[164:167], v[48:51], v[164:167]
    buffer_load_dwordx4 v[148:151], v71, s[40:43], s77 offen offset:0 sc1
    v_mfma_f32_16x16x32_bf16 v[168:171], a[168:171], v[48:51], v[168:171]
    v_mfma_f32_16x16x32_bf16 v[172:175], a[172:175], v[48:51], v[172:175]
    ds_read_b128 v[60:63], v64 offset:17664
    s_waitcnt lgkmcnt(2)
    v_mfma_f32_16x16x32_bf16 v[160:163], a[176:179], v[52:55], v[160:163]
    v_mfma_f32_16x16x32_bf16 v[164:167], a[180:183], v[52:55], v[164:167]
    buffer_load_dwordx4 v[152:155], v71, s[40:43], s77 offen offset:1024 sc1
    v_mfma_f32_16x16x32_bf16 v[168:171], a[184:187], v[52:55], v[168:171]
    s_waitcnt vmcnt(7)
    s_waitcnt vmcnt(6)
    buffer_store_dword v73, off, s[40:43], s80
    v_mfma_f32_16x16x32_bf16 v[172:175], a[188:191], v[52:55], v[172:175]
    v_add_u32 v73, 1, v73
    s_waitcnt lgkmcnt(1)
    v_mfma_f32_16x16x32_bf16 v[160:163], a[192:195], v[56:59], v[160:163]
    v_mfma_f32_16x16x32_bf16 v[164:167], a[196:199], v[56:59], v[164:167]
    buffer_load_dwordx4 v[156:159], v71, s[40:43], s77 offen offset:2048 sc1
    v_mfma_f32_16x16x32_bf16 v[168:171], a[200:203], v[56:59], v[168:171]
    v_mfma_f32_16x16x32_bf16 v[172:175], a[204:207], v[56:59], v[172:175]
    s_waitcnt lgkmcnt(0)
    v_mfma_f32_16x16x32_bf16 v[160:163], a[208:211], v[60:63], v[160:163]
    s_add_u32 s73, s93, 6291456
    s_add_u32 s77, s73, 4096
    v_mfma_f32_16x16x32_bf16 v[164:167], a[212:215], v[60:63], v[164:167]
    v_mfma_f32_16x16x32_bf16 v[168:171], a[216:219], v[60:63], v[168:171]
    v_mfma_f32_16x16x32_bf16 v[172:175], a[220:223], v[60:63], v[172:175]
    v_mfma_f32_16x16x32_bf16 v[16:19], a[224:227], v[104:107], 0
    s_nop 1
    v_mfma_f32_16x16x32_bf16 v[20:23], a[228:231], v[104:107], 0
    s_nop 1
    v_mfma_f32_16x16x32_bf16 v[24:27], a[232:235], v[104:107], 0
    v_mul_f32 v160, v160, v164
    v_mul_f32 v161, v161, v165
    v_mfma_f32_16x16x32_bf16 v[28:31], a[236:239], v[104:107], 0
    v_mul_f32 v162, v162, v166
    v_mul_f32 v163, v163, v167
    v_mfma_f32_16x16x32_bf16 v[16:19], a[240:243], v[108:111], v[16:19]
    v_mul_f32 v168, v168, v172
    v_mul_f32 v169, v169, v173
    v_mfma_f32_16x16x32_bf16 v[20:23], a[244:247], v[108:111], v[20:23]
    v_mul_f32 v170, v170, v174
    v_mul_f32 v171, v171, v175
    buffer_load_dword v75, v78, s[40:43], s81 offen sc1
    v_mfma_f32_16x16x32_bf16 v[24:27], a[248:251], v[108:111], v[24:27]
    v_cvt_pk_bf16_f32 v44, v160, v161
    v_cvt_pk_bf16_f32 v45, v162, v163
    v_mfma_f32_16x16x32_bf16 v[28:31], a[252:255], v[108:111], v[28:31]
    v_cvt_pk_bf16_f32 v46, v168, v169
    v_cvt_pk_bf16_f32 v47, v170, v171
    v_mfma_f32_16x16x32_bf16 v[16:19], v[176:179], v[112:115], v[16:19]
    buffer_store_dwordx4 v[44:47], v69, s[40:43], s72 offen
    v_mfma_f32_16x16x32_bf16 v[20:23], v[180:183], v[112:115], v[20:23]
    v_mfma_f32_16x16x32_bf16 v[24:27], v[184:187], v[112:115], v[24:27]
    v_mfma_f32_16x16x32_bf16 v[28:31], v[188:191], v[112:115], v[28:31]
    v_mfma_f32_16x16x32_bf16 v[16:19], v[192:195], v[116:119], v[16:19]
    v_mfma_f32_16x16x32_bf16 v[20:23], v[196:199], v[116:119], v[20:23]
    v_mfma_f32_16x16x32_bf16 v[24:27], v[200:203], v[116:119], v[24:27]
    v_mfma_f32_16x16x32_bf16 v[28:31], v[204:207], v[116:119], v[28:31]
    v_mfma_f32_16x16x32_bf16 v[16:19], v[208:211], v[120:123], v[16:19]
    v_mfma_f32_16x16x32_bf16 v[20:23], v[212:215], v[120:123], v[20:23]
    v_mfma_f32_16x16x32_bf16 v[24:27], v[216:219], v[120:123], v[24:27]
    v_mfma_f32_16x16x32_bf16 v[28:31], v[220:223], v[120:123], v[28:31]
    v_mfma_f32_16x16x32_bf16 v[16:19], v[224:227], v[124:127], v[16:19]
    v_mfma_f32_16x16x32_bf16 v[20:23], v[228:231], v[124:127], v[20:23]
    v_mfma_f32_16x16x32_bf16 v[24:27], v[232:235], v[124:127], v[24:27]
    v_mfma_f32_16x16x32_bf16 v[28:31], v[236:239], v[124:127], v[28:31]
    v_mfma_f32_16x16x32_bf16 v[16:19], v[240:243], v[128:131], v[16:19]
    v_mfma_f32_16x16x32_bf16 v[20:23], v[244:247], v[128:131], v[20:23]
    s_waitcnt vmcnt(1)
    v_subrev_u32 v75, v79, v75
    v_mfma_f32_16x16x32_bf16 v[24:27], v[248:251], v[128:131], v[24:27]
    v_cmp_le_u32 vcc, 64, v75
    v_mfma_f32_16x16x32_bf16 v[28:31], v[252:255], v[128:131], v[28:31]
    s_cbranch_vccz L_bk_63
    s_mov_b32 s71, 0
L_wp_64:
    buffer_load_dword v75, v78, s[40:43], s81 offen sc1
    s_waitcnt vmcnt(0)
    v_subrev_u32 v75, v79, v75
    v_cmp_le_u32 vcc, 64, v75
    s_add_u32 s71, s71, 1
    s_cmp_eq_u64 vcc, 0
    s_cbranch_scc1 L_wpd_65
    s_cmp_lt_u32 s71, 131072
    s_cbranch_scc1 L_wp_64
L_wpd_65:
L_bk_63:
    v_mfma_f32_16x16x32_bf16 v[88:91], a[224:227], v[132:135], 0
    buffer_load_dwordx4 v[104:107], v71, s[40:43], s73 offen offset:0 sc1
    v_mfma_f32_16x16x32_bf16 v[92:95], a[228:231], v[132:135], 0
    v_mfma_f32_16x16x32_bf16 v[96:99], a[232:235], v[132:135], 0
    buffer_load_dwordx4 v[108:111], v71, s[40:43], s73 offen offset:1024 sc1
    s_waitcnt vmcnt(2)
    buffer_store_dword v73, off, s[40:43], s80
    v_mfma_f32_16x16x32_bf16 v[100:103], a[236:239], v[132:135], 0
    v_add_u32 v73, 1, v73
    v_add_u32 v79, 1, v79
    v_mfma_f32_16x16x32_bf16 v[88:91], a[240:243], v[136:139], v[88:91]
    buffer_load_dwordx4 v[112:115], v71, s[40:43], s73 offen offset:2048 sc1
    v_mfma_f32_16x16x32_bf16 v[92:95], a[244:247], v[136:139], v[92:95]
    ds_write_b128 v65, v[20:23] offset:12288
    v_mfma_f32_16x16x32_bf16 v[96:99], a[248:251], v[136:139], v[96:99]
    buffer_load_dwordx4 v[116:119], v71, s[40:43], s73 offen offset:3072 sc1
    v_mfma_f32_16x16x32_bf16 v[100:103], a[252:255], v[136:139], v[100:103]
    ds_write_b128 v66, v[24:27] offset:16384
    v_mfma_f32_16x16x32_bf16 v[88:91], v[176:179], v[140:143], v[88:91]
    buffer_load_dwordx4 v[120:123], v71, s[40:43], s77 offen offset:0 sc1
    v_mfma_f32_16x16x32_bf16 v[92:95], v[180:183], v[140:143], v[92:95]
    ds_write_b128 v67, v[28:31] offset:20480
    v_mfma_f32_16x16x32_bf16 v[96:99], v[184:187], v[140:143], v[96:99]
    buffer_load_dwordx4 v[124:127], v71, s[40:43], s77 offen offset:1024 sc1
    v_mfma_f32_16x16x32_bf16 v[100:103], v[188:191], v[140:143], v[100:103]
    v_mfma_f32_16x16x32_bf16 v[88:91], v[192:195], v[144:147], v[88:91]
    buffer_load_dwordx4 v[128:131], v71, s[40:43], s77 offen offset:2048 sc1
    buffer_load_dword v75, v78, s[40:43], s81 offen sc1
    v_mfma_f32_16x16x32_bf16 v[92:95], v[196:199], v[144:147], v[92:95]
    s_waitcnt lgkmcnt(0)
    s_barrier
    v_mfma_f32_16x16x32_bf16 v[96:99], v[200:203], v[144:147], v[96:99]
    ds_read_b128 v[32:35], v68 offset:12288
    ds_read_b128 v[36:39], v68 offset:16384
    v_mfma_f32_16x16x32_bf16 v[100:103], v[204:207], v[144:147], v[100:103]
    ds_read_b128 v[40:43], v68 offset:20480
    v_mfma_f32_16x16x32_bf16 v[88:91], v[208:211], v[148:151], v[88:91]
    v_mfma_f32_16x16x32_bf16 v[92:95], v[212:215], v[148:151], v[92:95]
    v_mfma_f32_16x16x32_bf16 v[96:99], v[216:219], v[148:151], v[96:99]
    v_mfma_f32_16x16x32_bf16 v[100:103], v[220:223], v[148:151], v[100:103]
    s_waitcnt lgkmcnt(2)
    v_add_f32 v32, v32, v16
    v_add_f32 v33, v33, v17
    v_mfma_f32_16x16x32_bf16 v[88:91], v[224:227], v[152:155], v[88:91]
    v_add_f32 v34, v34, v18
    v_add_f32 v35, v35, v19
    v_mfma_f32_16x16x32_bf16 v[92:95], v[228:231], v[152:155], v[92:95]
    s_waitcnt lgkmcnt(0)
    v_add_f32 v36, v36, v40
    v_add_f32 v37, v37, v41
    v_mfma_f32_16x16x32_bf16 v[96:99], v[232:235], v[152:155], v[96:99]
    v_add_f32 v38, v38, v42
    v_add_f32 v39, v39, v43
    v_mfma_f32_16x16x32_bf16 v[100:103], v[236:239], v[152:155], v[100:103]
    v_add_f32 v32, v32, v36
    v_add_f32 v33, v33, v37
    v_mfma_f32_16x16x32_bf16 v[88:91], v[240:243], v[156:159], v[88:91]
    v_add_f32 v34, v34, v38
    v_add_f32 v35, v35, v39
    v_mfma_f32_16x16x32_bf16 v[92:95], v[244:247], v[156:159], v[92:95]
    v_cvt_pk_bf16_f32 v32, v32, v33
    v_cvt_pk_bf16_f32 v33, v34, v35
    v_mfma_f32_16x16x32_bf16 v[96:99], v[248:251], v[156:159], v[96:99]
    buffer_store_dwordx2 v[32:33], v72, s[40:43], s74 offen
    s_add_u32 s74, s74, 28672
    v_mfma_f32_16x16x32_bf16 v[100:103], v[252:255], v[156:159], v[100:103]
    s_add_u32 s73, s73, 28672
    s_add_u32 s77, s73, 4096
    s_waitcnt vmcnt(9)
    v_mfma_f32_16x16x32_bf16 v[16:19], a[224:227], v[104:107], 0
    v_mfma_f32_16x16x32_bf16 v[20:23], a[228:231], v[104:107], 0
    v_mfma_f32_16x16x32_bf16 v[24:27], a[232:235], v[104:107], 0
    v_mfma_f32_16x16x32_bf16 v[28:31], a[236:239], v[104:107], 0
    s_waitcnt vmcnt(1)
    v_subrev_u32 v75, v79, v75
    v_mfma_f32_16x16x32_bf16 v[16:19], a[240:243], v[108:111], v[16:19]
    v_cmp_le_u32 vcc, 64, v75
    v_mfma_f32_16x16x32_bf16 v[20:23], a[244:247], v[108:111], v[20:23]
    s_cbranch_vccz L_bk_67
    s_mov_b32 s71, 0
L_wp_68:
    buffer_load_dword v75, v78, s[40:43], s81 offen sc1
    s_waitcnt vmcnt(0)
    v_subrev_u32 v75, v79, v75
    v_cmp_le_u32 vcc, 64, v75
    s_add_u32 s71, s71, 1
    s_cmp_eq_u64 vcc, 0
    s_cbranch_scc1 L_wpd_69
    s_cmp_lt_u32 s71, 131072
    s_cbranch_scc1 L_wp_68
L_wpd_69:
L_bk_67:
    buffer_load_dwordx4 v[132:135], v71, s[40:43], s73 offen offset:0 sc1
    ds_write_b128 v65, v[92:95] offset:0
    v_mfma_f32_16x16x32_bf16 v[24:27], a[248:251], v[108:111], v[24:27]
    buffer_load_dwordx4 v[136:139], v71, s[40:43], s73 offen offset:1024 sc1
    v_mfma_f32_16x16x32_bf16 v[28:31], a[252:255], v[108:111], v[28:31]
    buffer_load_dwordx4 v[140:143], v71, s[40:43], s73 offen offset:2048 sc1
    ds_write_b128 v66, v[96:99] offset:4096
    v_mfma_f32_16x16x32_bf16 v[16:19], v[176:179], v[112:115], v[16:19]
    buffer_load_dwordx4 v[144:147], v71, s[40:43], s73 offen offset:3072 sc1
    v_mfma_f32_16x16x32_bf16 v[20:23], v[180:183], v[112:115], v[20:23]
    buffer_load_dwordx4 v[148:151], v71, s[40:43], s77 offen offset:0 sc1
    ds_write_b128 v67, v[100:103] offset:8192
    v_mfma_f32_16x16x32_bf16 v[24:27], v[184:187], v[112:115], v[24:27]
    buffer_load_dwordx4 v[152:155], v71, s[40:43], s77 offen offset:1024 sc1
    v_mfma_f32_16x16x32_bf16 v[28:31], v[188:191], v[112:115], v[28:31]
    buffer_load_dwordx4 v[156:159], v71, s[40:43], s77 offen offset:2048 sc1
    v_mfma_f32_16x16x32_bf16 v[16:19], v[192:195], v[116:119], v[16:19]
    v_mfma_f32_16x16x32_bf16 v[20:23], v[196:199], v[116:119], v[20:23]
    s_waitcnt lgkmcnt(0)
    s_barrier
    v_mfma_f32_16x16x32_bf16 v[24:27], v[200:203], v[116:119], v[24:27]
    ds_read_b128 v[32:35], v68 offset:0
    ds_read_b128 v[36:39], v68 offset:4096
    v_mfma_f32_16x16x32_bf16 v[28:31], v[204:207], v[116:119], v[28:31]
    ds_read_b128 v[40:43], v68 offset:8192
    v_mfma_f32_16x16x32_bf16 v[16:19], v[208:211], v[120:123], v[16:19]
    v_mfma_f32_16x16x32_bf16 v[20:23], v[212:215], v[120:123], v[20:23]
    s_add_u32 s88, s69, 17
    buffer_load_dword v75, v74, s[40:43], s81 offen sc1
    v_mfma_f32_16x16x32_bf16 v[24:27], v[216:219], v[120:123], v[24:27]
    s_waitcnt vmcnt(8)
    buffer_store_dword v73, off, s[40:43], s80
    v_mfma_f32_16x16x32_bf16 v[28:31], v[220:223], v[120:123], v[28:31]
    s_waitcnt lgkmcnt(2)
    v_add_f32 v32, v32, v88
    v_add_f32 v33, v33, v89
    v_mfma_f32_16x16x32_bf16 v[16:19], v[224:227], v[124:127], v[16:19]
    v_add_f32 v34, v34, v90
    v_add_f32 v35, v35, v91
    v_mfma_f32_16x16x32_bf16 v[20:23], v[228:231], v[124:127], v[20:23]
    s_waitcnt lgkmcnt(0)
    v_add_f32 v36, v36, v40
    v_add_f32 v37, v37, v41
    v_mfma_f32_16x16x32_bf16 v[24:27], v[232:235], v[124:127], v[24:27]
    v_add_f32 v38, v38, v42
    v_add_f32 v39, v39, v43
    v_mfma_f32_16x16x32_bf16 v[28:31], v[236:239], v[124:127], v[28:31]
    v_add_f32 v32, v32, v36
    v_add_f32 v33, v33, v37
    v_mfma_f32_16x16x32_bf16 v[16:19], v[240:243], v[128:131], v[16:19]
    v_add_f32 v34, v34, v38
    v_add_f32 v35, v35, v39
    v_mfma_f32_16x16x32_bf16 v[20:23], v[244:247], v[128:131], v[20:23]
    v_cvt_pk_bf16_f32 v32, v32, v33
    v_cvt_pk_bf16_f32 v33, v34, v35
    v_mfma_f32_16x16x32_bf16 v[24:27], v[248:251], v[128:131], v[24:27]
    buffer_store_dwordx2 v[32:33], v72, s[40:43], s74 offen
    s_add_u32 s74, s74, 28672
    v_mfma_f32_16x16x32_bf16 v[28:31], v[252:255], v[128:131], v[28:31]
    v_add_u32 v73, 1, v73
    s_waitcnt vmcnt(9)
    v_mfma_f32_16x16x32_bf16 v[92:95], a[228:231], v[132:135], 0
    v_mfma_f32_16x16x32_bf16 v[96:99], a[232:235], v[132:135], 0
    v_mfma_f32_16x16x32_bf16 v[100:103], a[236:239], v[132:135], 0
    s_waitcnt vmcnt(8)
    v_mfma_f32_16x16x32_bf16 v[92:95], a[244:247], v[136:139], v[92:95]
    ds_write_b128 v65, v[20:23] offset:12288
    v_mfma_f32_16x16x32_bf16 v[96:99], a[248:251], v[136:139], v[96:99]
    ds_write_b128 v66, v[24:27] offset:16384
    v_mfma_f32_16x16x32_bf16 v[100:103], a[252:255], v[136:139], v[100:103]
    ds_write_b128 v67, v[28:31] offset:20480
    s_waitcnt vmcnt(7)
    v_mfma_f32_16x16x32_bf16 v[92:95], v[180:183], v[140:143], v[92:95]
    s_waitcnt vmcnt(0)
    buffer_store_dword v73, off, s[40:43], s80
    v_mfma_f32_16x16x32_bf16 v[96:99], v[184:187], v[140:143], v[96:99]
    v_mfma_f32_16x16x32_bf16 v[100:103], v[188:191], v[140:143], v[100:103]
    s_waitcnt lgkmcnt(0)
    s_barrier
    v_mfma_f32_16x16x32_bf16 v[92:95], v[196:199], v[144:147], v[92:95]
    ds_read_b128 v[32:35], v68 offset:12288
    ds_read_b128 v[36:39], v68 offset:16384
    v_mfma_f32_16x16x32_bf16 v[96:99], v[200:203], v[144:147], v[96:99]
    ds_read_b128 v[40:43], v68 offset:20480
    v_mfma_f32_16x16x32_bf16 v[100:103], v[204:207], v[144:147], v[100:103]
    v_subrev_u32 v75, s88, v75
    v_mfma_f32_16x16x32_bf16 v[92:95], v[212:215], v[148:151], v[92:95]
    v_cmp_le_u32 vcc, 64, v75
    v_mfma_f32_16x16x32_bf16 v[96:99], v[216:219], v[148:151], v[96:99]
    s_cbranch_vccnz L_sl_70
L_bk_71:
    buffer_load_dword v75, v74, s[40:43], s81 offen sc1
    s_add_u32 s88, s88, 1
    s_waitcnt lgkmcnt(2)
    v_add_f32 v32, v32, v16
    v_add_f32 v33, v33, v17
    v_mfma_f32_16x16x32_bf16 v[100:103], v[220:223], v[148:151], v[100:103]
    v_add_f32 v34, v34, v18
    v_add_f32 v35, v35, v19
    v_mfma_f32_16x16x32_bf16 v[92:95], v[228:231], v[152:155], v[92:95]
    s_waitcnt lgkmcnt(0)
    v_add_f32 v36, v36, v40
    v_add_f32 v37, v37, v41
    v_mfma_f32_16x16x32_bf16 v[96:99], v[232:235], v[152:155], v[96:99]
    v_add_f32 v38, v38, v42
    v_add_f32 v39, v39, v43
    v_mfma_f32_16x16x32_bf16 v[100:103], v[236:239], v[152:155], v[100:103]
    v_add_f32 v32, v32, v36
    v_add_f32 v33, v33, v37
    v_mfma_f32_16x16x32_bf16 v[92:95], v[244:247], v[156:159], v[92:95]
    v_add_f32 v34, v34, v38
    v_add_f32 v35, v35, v39
    v_mfma_f32_16x16x32_bf16 v[96:99], v[248:251], v[156:159], v[96:99]
    v_cvt_pk_bf16_f32 v32, v32, v33
    v_cvt_pk_bf16_f32 v33, v34, v35
    v_mfma_f32_16x16x32_bf16 v[100:103], v[252:255], v[156:159], v[100:103]
    buffer_store_dwordx2 v[32:33], v72, s[40:43], s74 offen
    s_add_u32 s74, s74, 28672
    v_mfma_f32_16x16x32_bf16 v[88:91], a[224:227], v[132:135], 0
    v_add_u32 v73, 2, v73
    s_nop 0
    v_mfma_f32_16x16x32_bf16 v[88:91], a[240:243], v[136:139], v[88:91]
    s_nop 1
    v_mfma_f32_16x16x32_bf16 v[88:91], v[176:179], v[140:143], v[88:91]
    ds_write_b128 v65, v[92:95] offset:0
    v_mfma_f32_16x16x32_bf16 v[88:91], v[192:195], v[144:147], v[88:91]
    ds_write_b128 v66, v[96:99] offset:4096
    v_mfma_f32_16x16x32_bf16 v[88:91], v[208:211], v[148:151], v[88:91]
    ds_write_b128 v67, v[100:103] offset:8192
    v_mfma_f32_16x16x32_bf16 v[88:91], v[224:227], v[152:155], v[88:91]
    v_mfma_f32_16x16x32_bf16 v[88:91], v[240:243], v[156:159], v[88:91]
    s_waitcnt lgkmcnt(0)
    s_barrier
    ds_read_b128 v[32:35], v68 offset:0
    ds_read_b128 v[36:39], v68 offset:4096
    ds_read_b128 v[40:43], v68 offset:8192
    s_waitcnt vmcnt(1)
    v_subrev_u32 v75, s88, v75
    v_cmp_le_u32 vcc, 64, v75
    s_waitcnt lgkmcnt(0)
    v_add_f32 v36, v36, v40
    v_add_f32 v37, v37, v41
    v_add_f32 v38, v38, v42
    v_add_f32 v39, v39, v43
    s_cbranch_vccz L_bk_75
    s_mov_b32 s71, 0
L_wp_76:
    buffer_load_dword v75, v74, s[40:43], s81 offen sc1
    s_waitcnt vmcnt(0)
    v_subrev_u32 v75, s88, v75
    v_cmp_le_u32 vcc, 64, v75
    s_add_u32 s71, s71, 1
    s_cmp_eq_u64 vcc, 0
    s_cbranch_scc1 L_wpd_77
    s_cmp_lt_u32 s71, 131072
    s_cbranch_scc1 L_wp_76
L_wpd_77:
L_bk_75:
    v_add_f32 v32, v32, v88
    v_add_f32 v33, v33, v89
    v_add_f32 v34, v34, v90
    v_add_f32 v35, v35, v91
    v_add_f32 v32, v32, v36
    v_add_f32 v33, v33, v37
    v_add_f32 v34, v34, v38
    v_add_f32 v35, v35, v39
    v_cvt_pk_bf16_f32 v32, v32, v33
    v_cvt_pk_bf16_f32 v33, v34, v35
    buffer_store_dwordx2 v[32:33], v72, s[40:43], s74 offen
    s_waitcnt vmcnt(0)
    buffer_store_dword v73, off, s[40:43], s80
    s_branch L_done
L_sl_46:
    s_mov_b32 s71, 0
L_wp_48:
    buffer_load_dword v75, v78, s[40:43], s81 offen sc1
    s_waitcnt vmcnt(0)
    v_subrev_u32 v75, v79, v75
    v_cmp_le_u32 vcc, 64, v75
    s_add_u32 s71, s71, 1
    s_cmp_eq_u64 vcc, 0
    s_cbranch_scc1 L_wpd_49
    s_cmp_lt_u32 s71, 131072
    s_cbranch_scc1 L_wp_48
L_wpd_49:
    s_branch L_bk_47
L_sl_50:
    s_mov_b32 s71, 0
L_wp_52:
    buffer_load_dword v75, v78, s[40:43], s81 offen sc1
    s_waitcnt vmcnt(0)
    v_subrev_u32 v75, v79, v75
    v_cmp_le_u32 vcc, 64, v75
    s_add_u32 s71, s71, 1
    s_cmp_eq_u64 vcc, 0
    s_cbranch_scc1 L_wpd_53
    s_cmp_lt_u32 s71, 131072
    s_cbranch_scc1 L_wp_52
L_wpd_53:
    s_branch L_bk_51
L_sl_70:
    s_mov_b32 s71, 0
L_wp_72:
    buffer_load_dword v75, v74, s[40:43], s81 offen sc1
    s_waitcnt vmcnt(0)
    v_subrev_u32 v75, s88, v75
    v_cmp_le_u32 vcc, 64, v75
    s_add_u32 s71, s71, 1
    s_cmp_eq_u64 vcc, 0
    s_cbranch_scc1 L_wpd_73
    s_cmp_lt_u32 s71, 131072
    s_cbranch_scc1 L_wp_72
L_wpd_73:
    s_branch L_bk_71
L_slow_26:
    s_mov_b32 s72, s92
    s_mov_b32 s71, 0
L_wp_80:
    buffer_load_dword v75, v160, s[40:43], s81 offen sc1
    s_waitcnt vmcnt(0)
    v_subrev_u32 v75, s88, v75
    v_cmp_le_u32 vcc, 64, v75
    s_add_u32 s71, s71, 1
    s_cmp_eq_u64 vcc, 0
    s_cbranch_scc1 L_wpd_81
    s_cmp_lt_u32 s71, 131072
    s_cbranch_scc1 L_wp_80
L_wpd_81:
    s_add_u32 m0, s96, 0
    s_nop 0
    buffer_load_dwordx4 v70, s[40:43], s31 offen offset:0 sc1 lds
    buffer_load_dwordx4 v70, s[40:43], s31 offen offset:1024 sc1 lds
    buffer_load_dwordx4 v70, s[40:43], s31 offen offset:2048 sc1 lds
    buffer_load_dwordx4 v70, s[40:43], s31 offen offset:3072 sc1 lds
    s_add_u32 m0, s96, 14336
    s_add_u32 s79, s31, 14336
    buffer_load_dwordx4 v70, s[40:43], s79 offen offset:0 sc1 lds
    buffer_load_dwordx4 v70, s[40:43], s79 offen offset:1024 sc1 lds
    buffer_load_dwordx4 v70, s[40:43], s79 offen offset:2048 sc1 lds
    buffer_load_dwordx4 v70, s[40:43], s79 offen offset:3072 sc1 lds
L_got_79:
    s_waitcnt vmcnt(4)
    s_barrier
    ds_read_b128 v[48:51], v64 offset:0
    ds_read_b128 v[52:55], v64 offset:256
    ds_read_b128 v[56:59], v64 offset:512
    v_lshrrev_b32 v81, 4, v69
    s_waitcnt lgkmcnt(2)
    v_mfma_f32_16x16x32_bf16 v[0:3], a[0:3], v[48:51], 0
    v_add_u32 v80, 65536, v64
    s_add_u32 m0, s91, 49152
    s_mov_b32 s78, 28672
    buffer_load_dwordx4 v172, s[60:63], s78 offen offset:0 lds
    v_mfma_f32_16x16x32_bf16 v[4:7], a[4:7], v[48:51], 0
    v_cmp_gt_u32 vcc, 32, v81
    s_add_u32 s31, s95, 458752
    v_mfma_f32_16x16x32_bf16 v[8:11], a[8:11], v[48:51], 0
    s_add_u32 s88, s69, 1
    v_mfma_f32_16x16x32_bf16 v[12:15], a[12:15], v[48:51], 0
    ds_read_b128 v[60:63], v64 offset:768
    s_add_u32 m0, s91, 49152
    s_mov_b32 s78, 34816
    buffer_load_dwordx4 v172, s[60:63], s78 offen offset:1024 lds
    s_waitcnt lgkmcnt(2)
    v_mfma_f32_16x16x32_bf16 v[0:3], a[16:19], v[52:55], v[0:3]
    v_cndmask_b32 v81, 0, 1, vcc
    v_mfma_f32_16x16x32_bf16 v[4:7], a[20:23], v[52:55], v[4:7]
    v_mfma_f32_16x16x32_bf16 v[8:11], a[24:27], v[52:55], v[8:11]
    s_add_u32 m0, s91, 49152
    s_mov_b32 s78, 40960
    buffer_load_dwordx4 v172, s[60:63], s78 offen offset:2048 lds
    v_mfma_f32_16x16x32_bf16 v[12:15], a[28:31], v[52:55], v[12:15]
    ds_read_b128 v[48:51], v64 offset:1024
    s_waitcnt lgkmcnt(2)
    v_mfma_f32_16x16x32_bf16 v[0:3], a[32:35], v[56:59], v[0:3]
    v_mfma_f32_16x16x32_bf16 v[4:7], a[36:39], v[56:59], v[4:7]
    s_add_u32 m0, s91, 49152
    s_mov_b32 s78, 47104
    buffer_load_dwordx4 v172, s[60:63], s78 offen offset:3072 lds
    v_mfma_f32_16x16x32_bf16 v[8:11], a[40:43], v[56:59], v[8:11]
    v_mfma_f32_16x16x32_bf16 v[12:15], a[44:47], v[56:59], v[12:15]
    ds_read_b128 v[52:55], v64 offset:1280
    s_waitcnt lgkmcnt(2)
    v_mfma_f32_16x16x32_bf16 v[0:3], a[48:51], v[60:63], v[0:3]
    s_add_u32 m0, s91, 65536
    s_mov_b32 s78, 57344
    buffer_load_dwordx4 v172, s[60:63], s78 offen offset:0 lds
    v_mfma_f32_16x16x32_bf16 v[4:7], a[52:55], v[60:63], v[4:7]
    v_mfma_f32_16x16x32_bf16 v[8:11], a[56:59], v[60:63], v[8:11]
    v_mfma_f32_16x16x32_bf16 v[12:15], a[60:63], v[60:63], v[12:15]
    ds_read_b128 v[56:59], v64 offset:1536
    s_add_u32 m0, s91, 65536
    s_mov_b32 s78, 63488
    buffer_load_dwordx4 v172, s[60:63], s78 offen offset:1024 lds
    s_waitcnt lgkmcnt(2)
    v_mfma_f32_16x16x32_bf16 v[0:3], a[64:67], v[48:51], v[0:3]
    v_mfma_f32_16x16x32_bf16 v[4:7], a[68:71], v[48:51], v[4:7]
    v_mfma_f32_16x16x32_bf16 v[8:11], a[72:75], v[48:51], v[8:11]
    s_add_u32 m0, s91, 65536
    s_mov_b32 s78, 69632
    buffer_load_dwordx4 v172, s[60:63], s78 offen offset:2048 lds
    v_mfma_f32_16x16x32_bf16 v[12:15], a[76:79], v[48:51], v[12:15]
    ds_read_b128 v[60:63], v64 offset:1792
    s_waitcnt lgkmcnt(2)
    v_mfma_f32_16x16x32_bf16 v[0:3], a[80:83], v[52:55], v[0:3]
    v_mfma_f32_16x16x32_bf16 v[4:7], a[84:87], v[52:55], v[4:7]
    s_add_u32 m0, s91, 65536
    s_mov_b32 s78, 75776
    buffer_load_dwordx4 v172, s[60:63], s78 offen offset:3072 lds
    v_mfma_f32_16x16x32_bf16 v[8:11], a[88:91], v[52:55], v[8:11]
    v_mfma_f32_16x16x32_bf16 v[12:15], a[92:95], v[52:55], v[12:15]
    ds_read_b128 v[48:51], v64 offset:2048
    s_waitcnt lgkmcnt(2)
    v_mfma_f32_16x16x32_bf16 v[0:3], a[96:99], v[56:59], v[0:3]
    s_add_u32 m0, s91, 81920
    s_mov_b32 s78, 86016
    buffer_load_dwordx4 v172, s[60:63], s78 offen offset:0 lds
    v_mfma_f32_16x16x32_bf16 v[4:7], a[100:103], v[56:59], v[4:7]
    v_mfma_f32_16x16x32_bf16 v[8:11], a[104:107], v[56:59], v[8:11]
    v_mfma_f32_16x16x32_bf16 v[12:15], a[108:111], v[56:59], v[12:15]
    ds_read_b128 v[52:55], v64 offset:2304
    s_add_u32 m0, s91, 81920
    s_mov_b32 s78, 92160
    buffer_load_dwordx4 v172, s[60:63], s78 offen offset:1024 lds
    s_waitcnt lgkmcnt(2)
    v_mfma_f32_16x16x32_bf16 v[0:3], a[112:115], v[60:63], v[0:3]
    buffer_load_dword v75, v74, s[40:43], s81 offen sc1
    v_mfma_f32_16x16x32_bf16 v[4:7], a[116:119], v[60:63], v[4:7]
    v_mfma_f32_16x16x32_bf16 v[8:11], a[120:123], v[60:63], v[8:11]
    s_add_u32 m0, s91, 81920
    s_mov_b32 s78, 98304
    buffer_load_dwordx4 v172, s[60:63], s78 offen offset:2048 lds
    v_mfma_f32_16x16x32_bf16 v[12:15], a[124:127], v[60:63], v[12:15]
    ds_read_b128 v[56:59], v64 offset:2560
    s_waitcnt lgkmcnt(2)
    v_mfma_f32_16x16x32_bf16 v[0:3], a[128:131], v[48:51], v[0:3]
    v_mfma_f32_16x16x32_bf16 v[4:7], a[132:135], v[48:51], v[4:7]
    s_add_u32 m0, s91, 81920
    s_mov_b32 s78, 104448
    buffer_load_dwordx4 v172, s[60:63], s78 offen offset:3072 lds
    v_mfma_f32_16x16x32_bf16 v[8:11], a[136:139], v[48:51], v[8:11]
    v_mfma_f32_16x16x32_bf16 v[12:15], a[140:143], v[48:51], v[12:15]
    ds_read_b128 v[60:63], v64 offset:2816
    s_waitcnt lgkmcnt(2)
    v_mfma_f32_16x16x32_bf16 v[0:3], a[144:147], v[52:55], v[0:3]
    v_mfma_f32_16x16x32_bf16 v[4:7], a[148:151], v[52:55], v[4:7]
    v_mfma_f32_16x16x32_bf16 v[8:11], a[152:155], v[52:55], v[8:11]
    v_mfma_f32_16x16x32_bf16 v[12:15], a[156:159], v[52:55], v[12:15]
    ds_read_b128 v[48:51], v64 offset:3072
    s_waitcnt lgkmcnt(2)
    v_mfma_f32_16x16x32_bf16 v[0:3], a[160:163], v[56:59], v[0:3]
    v_mfma_f32_16x16x32_bf16 v[4:7], a[164:167], v[56:59], v[4:7]
    v_mfma_f32_16x16x32_bf16 v[8:11], a[168:171], v[56:59], v[8:11]
    v_mfma_f32_16x16x32_bf16 v[12:15], a[172:175], v[56:59], v[12:15]
    ds_read_b128 v[52:55], v64 offset:3328
    s_waitcnt lgkmcnt(2)
    v_mfma_f32_16x16x32_bf16 v[0:3], a[176:179], v[60:63], v[0:3]
    v_mfma_f32_16x16x32_bf16 v[4:7], a[180:183], v[60:63], v[4:7]
    s_waitcnt vmcnt(13)
    s_barrier
    v_mfma_f32_16x16x32_bf16 v[8:11], a[184:187], v[60:63], v[8:11]
    v_mfma_f32_16x16x32_bf16 v[12:15], a[188:191], v[60:63], v[12:15]
    ds_read_b128 v[56:59], v64 offset:14336
    s_waitcnt lgkmcnt(2)
    v_mfma_f32_16x16x32_bf16 v[0:3], a[192:195], v[48:51], v[0:3]
    v_mfma_f32_16x16x32_bf16 v[4:7], a[196:199], v[48:51], v[4:7]
    v_mfma_f32_16x16x32_bf16 v[8:11], a[200:203], v[48:51], v[8:11]
    v_mfma_f32_16x16x32_bf16 v[12:15], a[204:207], v[48:51], v[12:15]
    ds_read_b128 v[60:63], v64 offset:14592
    s_waitcnt lgkmcnt(2)
    v_mfma_f32_16x16x32_bf16 v[0:3], a[208:211], v[52:55], v[0:3]
    v_mfma_f32_16x16x32_bf16 v[4:7], a[212:215], v[52:55], v[4:7]
    v_mfma_f32_16x16x32_bf16 v[8:11], a[216:219], v[52:55], v[8:11]
    v_mfma_f32_16x16x32_bf16 v[12:15], a[220:223], v[52:55], v[12:15]
    ds_read_b128 v[48:51], v64 offset:14848
    s_waitcnt lgkmcnt(2)
    v_mfma_f32_16x16x32_bf16 v[88:91], a[0:3], v[56:59], 0
    s_waitcnt vmcnt(2)
    v_subrev_u32 v75, s88, v75
    v_mfma_f32_16x16x32_bf16 v[92:95], a[4:7], v[56:59], 0
    v_cmp_le_u32 vcc, 64, v75
    v_mfma_f32_16x16x32_bf16 v[96:99], a[8:11], v[56:59], 0
    s_cbranch_vccz L_bk_83
    s_mov_b32 s71, 0
L_wp_84:
    buffer_load_dword v75, v74, s[40:43], s81 offen sc1
    s_waitcnt vmcnt(0)
    v_subrev_u32 v75, s88, v75
    v_cmp_le_u32 vcc, 64, v75
    s_add_u32 s71, s71, 1
    s_cmp_eq_u64 vcc, 0
    s_cbranch_scc1 L_wpd_85
    s_cmp_lt_u32 s71, 131072
    s_cbranch_scc1 L_wp_84
L_wpd_85:
L_bk_83:
    s_add_u32 m0, s96, 65536
    v_mfma_f32_16x16x32_bf16 v[100:103], a[12:15], v[56:59], 0
    ds_read_b128 v[52:55], v64 offset:15104
    s_waitcnt lgkmcnt(2)
    v_mfma_f32_16x16x32_bf16 v[88:91], a[16:19], v[60:63], v[88:91]
    v_mul_f32 v0, v0, v4
    v_mul_f32 v1, v1, v5
    s_waitcnt vmcnt(0)
    ds_read_b64_tr_b16 a[224:225], v175 offset:0
    ds_read_b64_tr_b16 a[226:227], v175 offset:2048
    v_mfma_f32_16x16x32_bf16 v[92:95], a[20:23], v[60:63], v[92:95]
    buffer_load_dwordx4 v70, s[40:43], s31 offen offset:0 sc1 lds
    ds_read_b64_tr_b16 a[228:229], v171 offset:0
    ds_read_b64_tr_b16 a[230:231], v171 offset:2048
    v_mfma_f32_16x16x32_bf16 v[96:99], a[24:27], v[60:63], v[96:99]
    v_mul_f32 v2, v2, v6
    v_mul_f32 v3, v3, v7
    ds_read_b64_tr_b16 a[232:233], v167 offset:0
    ds_read_b64_tr_b16 a[234:235], v167 offset:2048
    v_mfma_f32_16x16x32_bf16 v[100:103], a[28:31], v[60:63], v[100:103]
    ds_read_b128 v[56:59], v64 offset:15360
    s_waitcnt lgkmcnt(8)
    v_mfma_f32_16x16x32_bf16 v[88:91], a[32:35], v[48:51], v[88:91]
    v_mul_f32 v8, v8, v12
    v_mul_f32 v9, v9, v13
    ds_read_b64_tr_b16 a[236:237], v168 offset:0
    ds_read_b64_tr_b16 a[238:239], v168 offset:2048
    v_mfma_f32_16x16x32_bf16 v[92:95], a[36:39], v[48:51], v[92:95]
    buffer_load_dwordx4 v70, s[40:43], s31 offen offset:1024 sc1 lds
    ds_read_b64_tr_b16 a[240:241], v175 offset:16384
    ds_read_b64_tr_b16 a[242:243], v175 offset:18432
    v_mfma_f32_16x16x32_bf16 v[96:99], a[40:43], v[48:51], v[96:99]
    v_mul_f32 v10, v10, v14
    v_mul_f32 v11, v11, v15
    ds_read_b64_tr_b16 a[244:245], v171 offset:16384
    ds_read_b64_tr_b16 a[246:247], v171 offset:18432
    v_mfma_f32_16x16x32_bf16 v[100:103], a[44:47], v[48:51], v[100:103]
    ds_read_b128 v[60:63], v64 offset:15616
    s_waitcnt lgkmcnt(14)
    v_mfma_f32_16x16x32_bf16 v[88:91], a[48:51], v[52:55], v[88:91]
    v_cvt_pk_bf16_f32 v44, v0, v1
    v_cvt_pk_bf16_f32 v45, v2, v3
    ds_read_b64_tr_b16 a[248:249], v167 offset:16384
    ds_read_b64_tr_b16 a[250:251], v167 offset:18432
    v_mfma_f32_16x16x32_bf16 v[92:95], a[52:55], v[52:55], v[92:95]
    buffer_load_dwordx4 v70, s[40:43], s31 offen offset:2048 sc1 lds
    ds_read_b64_tr_b16 a[252:253], v168 offset:16384
    ds_read_b64_tr_b16 a[254:255], v168 offset:18432
    v_mfma_f32_16x16x32_bf16 v[96:99], a[56:59], v[52:55], v[96:99]
    v_cvt_pk_bf16_f32 v46, v8, v9
    v_cvt_pk_bf16_f32 v47, v10, v11
    ds_read_b64_tr_b16 v[176:177], v175 offset:32768
    ds_read_b64_tr_b16 v[178:179], v175 offset:34816
    v_mfma_f32_16x16x32_bf16 v[100:103], a[60:63], v[52:55], v[100:103]
    ds_read_b128 v[48:51], v64 offset:15872
    s_waitcnt lgkmcnt(14)
    v_mfma_f32_16x16x32_bf16 v[88:91], a[64:67], v[56:59], v[88:91]
    ds_read_b64_tr_b16 v[180:181], v171 offset:32768
    ds_read_b64_tr_b16 v[182:183], v171 offset:34816
    v_mfma_f32_16x16x32_bf16 v[92:95], a[68:71], v[56:59], v[92:95]
    buffer_load_dwordx4 v70, s[40:43], s31 offen offset:3072 sc1 lds
    ds_read_b64_tr_b16 v[184:185], v167 offset:32768
    ds_read_b64_tr_b16 v[186:187], v167 offset:34816
    v_mfma_f32_16x16x32_bf16 v[96:99], a[72:75], v[56:59], v[96:99]
    buffer_store_dwordx4 v[44:47], v69, s[40:43], s72 offen sc1
    ds_read_b64_tr_b16 v[188:189], v168 offset:32768
    ds_read_b64_tr_b16 v[190:191], v168 offset:34816
    v_mfma_f32_16x16x32_bf16 v[100:103], a[76:79], v[56:59], v[100:103]
    ds_read_b128 v[52:55], v64 offset:16128
    s_waitcnt lgkmcnt(14)
    v_mfma_f32_16x16x32_bf16 v[88:91], a[80:83], v[60:63], v[88:91]
    s_add_u32 s31, s31, 14336
    s_add_u32 s88, s88, 1
    ds_read_b64_tr_b16 v[192:193], v175 offset:49152
    ds_read_b64_tr_b16 v[194:195], v175 offset:51200
    v_mfma_f32_16x16x32_bf16 v[92:95], a[84:87], v[60:63], v[92:95]
    ds_read_b64_tr_b16 v[196:197], v171 offset:49152
    ds_read_b64_tr_b16 v[198:199], v171 offset:51200
    v_mfma_f32_16x16x32_bf16 v[96:99], a[88:91], v[60:63], v[96:99]
    ds_read_b64_tr_b16 v[200:201], v167 offset:49152
    ds_read_b64_tr_b16 v[202:203], v167 offset:51200
    v_mfma_f32_16x16x32_bf16 v[100:103], a[92:95], v[60:63], v[100:103]
    ds_read_b128 v[56:59], v64 offset:16384
    s_waitcnt lgkmcnt(14)
    v_mfma_f32_16x16x32_bf16 v[88:91], a[96:99], v[48:51], v[88:91]
    ds_read_b64_tr_b16 v[204:205], v168 offset:49152
    ds_read_b64_tr_b16 v[206:207], v168 offset:51200
    v_mfma_f32_16x16x32_bf16 v[92:95], a[100:103], v[48:51], v[92:95]
    v_mfma_f32_16x16x32_bf16 v[96:99], a[104:107], v[48:51], v[96:99]
    v_mfma_f32_16x16x32_bf16 v[100:103], a[108:111], v[48:51], v[100:103]
    ds_read_b128 v[60:63], v64 offset:16640
    s_waitcnt lgkmcnt(10)
    v_mfma_f32_16x16x32_bf16 v[88:91], a[112:115], v[52:55], v[88:91]
    buffer_load_dword v75, v74, s[40:43], s81 offen sc1
    s_waitcnt lgkmcnt(1)
    v_mfma_f32_16x16x32_bf16 v[92:95], a[116:119], v[52:55], v[92:95]
    s_add_u32 m0, s91, 32768
    s_mov_b32 s78, 114688
    buffer_load_dwordx4 v172, s[60:63], s78 offen offset:0 lds
    v_mfma_f32_16x16x32_bf16 v[96:99], a[120:123], v[52:55], v[96:99]
    v_mfma_f32_16x16x32_bf16 v[100:103], a[124:127], v[52:55], v[100:103]
    ds_read_b128 v[48:51], v64 offset:16896
    v_mfma_f32_16x16x32_bf16 v[88:91], a[128:131], v[56:59], v[88:91]
    s_add_u32 m0, s91, 32768
    s_mov_b32 s78, 120832
    buffer_load_dwordx4 v172, s[60:63], s78 offen offset:1024 lds
    v_mfma_f32_16x16x32_bf16 v[92:95], a[132:135], v[56:59], v[92:95]
    v_mfma_f32_16x16x32_bf16 v[96:99], a[136:139], v[56:59], v[96:99]
    v_mfma_f32_16x16x32_bf16 v[100:103], a[140:143], v[56:59], v[100:103]
    ds_read_b128 v[52:55], v64 offset:17152
    s_add_u32 m0, s91, 32768
    s_mov_b32 s78, 126976
    buffer_load_dwordx4 v172, s[60:63], s78 offen offset:2048 lds
    s_waitcnt lgkmcnt(2)
    v_mfma_f32_16x16x32_bf16 v[88:91], a[144:147], v[60:63], v[88:91]
    v_mfma_f32_16x16x32_bf16 v[92:95], a[148:151], v[60:63], v[92:95]
    v_mfma_f32_16x16x32_bf16 v[96:99], a[152:155], v[60:63], v[96:99]
    s_add_u32 m0, s91, 32768
    s_mov_b32 s78, 133120
    buffer_load_dwordx4 v172, s[60:63], s78 offen offset:3072 lds
    v_mfma_f32_16x16x32_bf16 v[100:103], a[156:159], v[60:63], v[100:103]
    ds_read_b128 v[56:59], v64 offset:17408
    s_waitcnt lgkmcnt(2)
    v_mfma_f32_16x16x32_bf16 v[88:91], a[160:163], v[48:51], v[88:91]
    v_mfma_f32_16x16x32_bf16 v[92:95], a[164:167], v[48:51], v[92:95]
    s_waitcnt vmcnt(5)
    buffer_store_dword v73, off, s[40:43], s80 sc1
    s_add_u32 m0, s91, 49152
    s_mov_b32 s78, 143360
    buffer_load_dwordx4 v172, s[60:63], s78 offen offset:0 lds
    v_mfma_f32_16x16x32_bf16 v[96:99], a[168:171], v[48:51], v[96:99]
    v_add_u32 v73, 1, v73
    s_add_u32 s72, s92, 28672
    v_mfma_f32_16x16x32_bf16 v[100:103], a[172:175], v[48:51], v[100:103]
    ds_read_b128 v[60:63], v64 offset:17664
    s_waitcnt lgkmcnt(2)
    v_mfma_f32_16x16x32_bf16 v[88:91], a[176:179], v[52:55], v[88:91]
    s_add_u32 m0, s91, 49152
    s_mov_b32 s78, 149504
    buffer_load_dwordx4 v172, s[60:63], s78 offen offset:1024 lds
    v_mfma_f32_16x16x32_bf16 v[92:95], a[180:183], v[52:55], v[92:95]
    s_barrier
    v_mfma_f32_16x16x32_bf16 v[96:99], a[184:187], v[52:55], v[96:99]
    v_mfma_f32_16x16x32_bf16 v[100:103], a[188:191], v[52:55], v[100:103]
    ds_read_b128 v[48:51], v80 offset:0
    s_add_u32 m0, s91, 49152
    s_mov_b32 s78, 155648
    buffer_load_dwordx4 v172, s[60:63], s78 offen offset:2048 lds
    s_waitcnt lgkmcnt(2)
    v_mfma_f32_16x16x32_bf16 v[88:91], a[192:195], v[56:59], v[88:91]
    v_mfma_f32_16x16x32_bf16 v[92:95], a[196:199], v[56:59], v[92:95]
    v_mfma_f32_16x16x32_bf16 v[96:99], a[200:203], v[56:59], v[96:99]
    s_add_u32 m0, s91, 49152
    s_mov_b32 s78, 161792
    buffer_load_dwordx4 v172, s[60:63], s78 offen offset:3072 lds
    v_mfma_f32_16x16x32_bf16 v[100:103], a[204:207], v[56:59], v[100:103]
    ds_read_b128 v[52:55], v80 offset:256
    s_waitcnt lgkmcnt(2)
    v_mfma_f32_16x16x32_bf16 v[88:91], a[208:211], v[60:63], v[88:91]
    v_mfma_f32_16x16x32_bf16 v[92:95], a[212:215], v[60:63], v[92:95]
    s_add_u32 m0, s91, 65536
    s_mov_b32 s78, 172032
    buffer_load_dwordx4 v172, s[60:63], s78 offen offset:0 lds
    v_mfma_f32_16x16x32_bf16 v[96:99], a[216:219], v[60:63], v[96:99]
    v_mfma_f32_16x16x32_bf16 v[100:103], a[220:223], v[60:63], v[100:103]
    ds_read_b128 v[56:59], v80 offset:512
    s_waitcnt lgkmcnt(2)
    v_mfma_f32_16x16x32_bf16 v[0:3], a[0:3], v[48:51], 0
    s_waitcnt vmcnt(10)
    v_subrev_u32 v75, s88, v75
    v_mfma_f32_16x16x32_bf16 v[4:7], a[4:7], v[48:51], 0
    v_cmp_le_u32 vcc, 64, v75
    v_mfma_f32_16x16x32_bf16 v[8:11], a[8:11], v[48:51], 0
    s_cbranch_vccz L_bk_87
    s_mov_b32 s71, 0
L_wp_88:
    buffer_load_dword v75, v74, s[40:43], s81 offen sc1
    s_waitcnt vmcnt(0)
    v_subrev_u32 v75, s88, v75
    v_cmp_le_u32 vcc, 64, v75
    s_add_u32 s71, s71, 1
    s_cmp_eq_u64 vcc, 0
    s_cbranch_scc1 L_wpd_89
    s_cmp_lt_u32 s71, 131072
    s_cbranch_scc1 L_wp_88
L_wpd_89:
L_bk_87:
    s_add_u32 m0, s96, 81920
    v_mfma_f32_16x16x32_bf16 v[12:15], a[12:15], v[48:51], 0
    ds_read_b128 v[60:63], v80 offset:768
    s_waitcnt lgkmcnt(2)
    v_mfma_f32_16x16x32_bf16 v[0:3], a[16:19], v[52:55], v[0:3]
    v_mul_f32 v88, v88, v92
    v_mul_f32 v89, v89, v93
    v_mfma_f32_16x16x32_bf16 v[4:7], a[20:23], v[52:55], v[4:7]
    buffer_load_dwordx4 v70, s[40:43], s31 offen offset:0 sc1 lds
    v_mfma_f32_16x16x32_bf16 v[8:11], a[24:27], v[52:55], v[8:11]
    v_mul_f32 v90, v90, v94
    v_mul_f32 v91, v91, v95
    v_mfma_f32_16x16x32_bf16 v[12:15], a[28:31], v[52:55], v[12:15]
    ds_read_b128 v[48:51], v80 offset:1024
    s_waitcnt lgkmcnt(2)
    v_mfma_f32_16x16x32_bf16 v[0:3], a[32:35], v[56:59], v[0:3]
    v_mul_f32 v96, v96, v100
    v_mul_f32 v97, v97, v101
    v_mfma_f32_16x16x32_bf16 v[4:7], a[36:39], v[56:59], v[4:7]
    buffer_load_dwordx4 v70, s[40:43], s31 offen offset:1024 sc1 lds
    v_mfma_f32_16x16x32_bf16 v[8:11], a[40:43], v[56:59], v[8:11]
    v_mul_f32 v98, v98, v102
    v_mul_f32 v99, v99, v103
    v_mfma_f32_16x16x32_bf16 v[12:15], a[44:47], v[56:59], v[12:15]
    ds_read_b128 v[52:55], v80 offset:1280
    s_waitcnt lgkmcnt(2)
    v_mfma_f32_16x16x32_bf16 v[0:3], a[48:51], v[60:63], v[0:3]
    v_cvt_pk_bf16_f32 v44, v88, v89
    v_cvt_pk_bf16_f32 v45, v90, v91
    v_mfma_f32_16x16x32_bf16 v[4:7], a[52:55], v[60:63], v[4:7]
    buffer_load_dwordx4 v70, s[40:43], s31 offen offset:2048 sc1 lds
    v_mfma_f32_16x16x32_bf16 v[8:11], a[56:59], v[60:63], v[8:11]
    v_cvt_pk_bf16_f32 v46, v96, v97
    v_cvt_pk_bf16_f32 v47, v98, v99
    v_mfma_f32_16x16x32_bf16 v[12:15], a[60:63], v[60:63], v[12:15]
    ds_read_b128 v[56:59], v80 offset:1536
    s_waitcnt lgkmcnt(2)
    v_mfma_f32_16x16x32_bf16 v[0:3], a[64:67], v[48:51], v[0:3]
    v_mfma_f32_16x16x32_bf16 v[4:7], a[68:71], v[48:51], v[4:7]
    buffer_load_dwordx4 v70, s[40:43], s31 offen offset:3072 sc1 lds
    v_mfma_f32_16x16x32_bf16 v[8:11], a[72:75], v[48:51], v[8:11]
    buffer_store_dwordx4 v[44:47], v69, s[40:43], s72 offen sc1
    v_mfma_f32_16x16x32_bf16 v[12:15], a[76:79], v[48:51], v[12:15]
    ds_read_b128 v[60:63], v80 offset:1792
    s_waitcnt lgkmcnt(2)
    v_mfma_f32_16x16x32_bf16 v[0:3], a[80:83], v[52:55], v[0:3]
    s_add_u32 s31, s95, 917504
    s_add_u32 s88, s88, 1
    v_mfma_f32_16x16x32_bf16 v[4:7], a[84:87], v[52:55], v[4:7]
    v_mfma_f32_16x16x32_bf16 v[8:11], a[88:91], v[52:55], v[8:11]
    v_mfma_f32_16x16x32_bf16 v[12:15], a[92:95], v[52:55], v[12:15]
    ds_read_b128 v[48:51], v80 offset:2048
    s_waitcnt lgkmcnt(2)
    v_mfma_f32_16x16x32_bf16 v[0:3], a[96:99], v[56:59], v[0:3]
    v_mfma_f32_16x16x32_bf16 v[4:7], a[100:103], v[56:59], v[4:7]
    v_mfma_f32_16x16x32_bf16 v[8:11], a[104:107], v[56:59], v[8:11]
    v_mfma_f32_16x16x32_bf16 v[12:15], a[108:111], v[56:59], v[12:15]
    ds_read_b128 v[52:55], v80 offset:2304
    s_waitcnt lgkmcnt(2)
    v_mfma_f32_16x16x32_bf16 v[0:3], a[112:115], v[60:63], v[0:3]
    buffer_load_dword v75, v78, s[40:43], s81 offen sc1
    v_mfma_f32_16x16x32_bf16 v[4:7], a[116:119], v[60:63], v[4:7]
    s_add_u32 m0, s91, 65536
    s_mov_b32 s78, 178176
    buffer_load_dwordx4 v172, s[60:63], s78 offen offset:1024 lds
    v_mfma_f32_16x16x32_bf16 v[8:11], a[120:123], v[60:63], v[8:11]
    v_mfma_f32_16x16x32_bf16 v[12:15], a[124:127], v[60:63], v[12:15]
    ds_read_b128 v[56:59], v80 offset:2560
    s_waitcnt lgkmcnt(2)
    v_mfma_f32_16x16x32_bf16 v[0:3], a[128:131], v[48:51], v[0:3]
    s_add_u32 m0, s91, 65536
    s_mov_b32 s78, 184320
    buffer_load_dwordx4 v172, s[60:63], s78 offen offset:2048 lds
    v_mfma_f32_16x16x32_bf16 v[4:7], a[132:135], v[48:51], v[4:7]
    v_mfma_f32_16x16x32_bf16 v[8:11], a[136:139], v[48:51], v[8:11]
    v_mfma_f32_16x16x32_bf16 v[12:15], a[140:143], v[48:51], v[12:15]
    ds_read_b128 v[60:63], v80 offset:2816
    s_add_u32 m0, s91, 65536
    s_mov_b32 s78, 190464
    buffer_load_dwordx4 v172, s[60:63], s78 offen offset:3072 lds
    s_waitcnt lgkmcnt(2)
    v_mfma_f32_16x16x32_bf16 v[0:3], a[144:147], v[52:55], v[0:3]
    v_mfma_f32_16x16x32_bf16 v[4:7], a[148:151], v[52:55], v[4:7]
    v_mfma_f32_16x16x32_bf16 v[8:11], a[152:155], v[52:55], v[8:11]
    v_mfma_f32_16x16x32_bf16 v[12:15], a[156:159], v[52:55], v[12:15]
    ds_read_b128 v[48:51], v80 offset:3072
    s_waitcnt lgkmcnt(2)
    v_mfma_f32_16x16x32_bf16 v[0:3], a[160:163], v[56:59], v[0:3]
    v_mfma_f32_16x16x32_bf16 v[4:7], a[164:167], v[56:59], v[4:7]
    s_waitcnt vmcnt(4)
    buffer_store_dword v73, off, s[40:43], s80 sc1
    v_mfma_f32_16x16x32_bf16 v[8:11], a[168:171], v[56:59], v[8:11]
    v_add_u32 v73, 1, v73
    s_add_u32 s72, s92, 6291456
    v_mfma_f32_16x16x32_bf16 v[12:15], a[172:175], v[56:59], v[12:15]
    ds_read_b128 v[52:55], v80 offset:3328
    s_waitcnt lgkmcnt(2)
    v_mfma_f32_16x16x32_bf16 v[0:3], a[176:179], v[60:63], v[0:3]
    v_mfma_f32_16x16x32_bf16 v[4:7], a[180:183], v[60:63], v[4:7]
    s_barrier
    v_mfma_f32_16x16x32_bf16 v[8:11], a[184:187], v[60:63], v[8:11]
    v_mfma_f32_16x16x32_bf16 v[12:15], a[188:191], v[60:63], v[12:15]
    ds_read_b128 v[56:59], v80 offset:16384
    s_waitcnt lgkmcnt(2)
    v_mfma_f32_16x16x32_bf16 v[0:3], a[192:195], v[48:51], v[0:3]
    v_mfma_f32_16x16x32_bf16 v[4:7], a[196:199], v[48:51], v[4:7]
    v_mfma_f32_16x16x32_bf16 v[8:11], a[200:203], v[48:51], v[8:11]
    v_mfma_f32_16x16x32_bf16 v[12:15], a[204:207], v[48:51], v[12:15]
    ds_read_b128 v[60:63], v80 offset:16640
    s_waitcnt lgkmcnt(2)
    v_mfma_f32_16x16x32_bf16 v[0:3], a[208:211], v[52:55], v[0:3]
    v_mfma_f32_16x16x32_bf16 v[4:7], a[212:215], v[52:55], v[4:7]
    s_add_u32 s75, s93, 32768
    v_mfma_f32_16x16x32_bf16 v[8:11], a[216:219], v[52:55], v[8:11]
    s_add_u32 s77, s93, 4096
    s_add_u32 s73, s93, 28672
    v_mfma_f32_16x16x32_bf16 v[12:15], a[220:223], v[52:55], v[12:15]
    ds_read_b128 v[48:51], v80 offset:16896
    s_waitcnt lgkmcnt(2)
    v_mfma_f32_16x16x32_bf16 v[88:91], a[0:3], v[56:59], 0
    s_waitcnt vmcnt(4)
    v_subrev_u32 v75, v79, v75
    v_mfma_f32_16x16x32_bf16 v[92:95], a[4:7], v[56:59], 0
    v_cmp_le_u32 vcc, 64, v75
    v_mfma_f32_16x16x32_bf16 v[96:99], a[8:11], v[56:59], 0
    s_cbranch_vccz L_bk_91
    s_mov_b32 s71, 0
L_wp_92:
    buffer_load_dword v75, v78, s[40:43], s81 offen sc1
    s_waitcnt vmcnt(0)
    v_subrev_u32 v75, v79, v75
    v_cmp_le_u32 vcc, 64, v75
    s_add_u32 s71, s71, 1
    s_cmp_eq_u64 vcc, 0
    s_cbranch_scc1 L_wpd_93
    s_cmp_lt_u32 s71, 131072
    s_cbranch_scc1 L_wp_92
L_wpd_93:
L_bk_91:
    s_add_u32 m0, s96, 0
    v_mfma_f32_16x16x32_bf16 v[100:103], a[12:15], v[56:59], 0
    ds_read_b128 v[52:55], v80 offset:17152
    s_waitcnt lgkmcnt(2)
    v_mfma_f32_16x16x32_bf16 v[88:91], a[16:19], v[60:63], v[88:91]
    v_mul_f32 v0, v0, v4
    v_mul_f32 v1, v1, v5
    v_mfma_f32_16x16x32_bf16 v[92:95], a[20:23], v[60:63], v[92:95]
    buffer_load_dwordx4 v70, s[40:43], s31 offen offset:0 sc1 lds
    v_mfma_f32_16x16x32_bf16 v[96:99], a[24:27], v[60:63], v[96:99]
    v_mul_f32 v2, v2, v6
    v_mul_f32 v3, v3, v7
    v_mfma_f32_16x16x32_bf16 v[100:103], a[28:31], v[60:63], v[100:103]
    ds_read_b128 v[56:59], v80 offset:17408
    s_waitcnt lgkmcnt(2)
    v_mfma_f32_16x16x32_bf16 v[88:91], a[32:35], v[48:51], v[88:91]
    v_mul_f32 v8, v8, v12
    v_mul_f32 v9, v9, v13
    v_mfma_f32_16x16x32_bf16 v[92:95], a[36:39], v[48:51], v[92:95]
    buffer_load_dwordx4 v70, s[40:43], s31 offen offset:1024 sc1 lds
    v_mfma_f32_16x16x32_bf16 v[96:99], a[40:43], v[48:51], v[96:99]
    v_mul_f32 v10, v10, v14
    v_mul_f32 v11, v11, v15
    v_mfma_f32_16x16x32_bf16 v[100:103], a[44:47], v[48:51], v[100:103]
    ds_read_b128 v[60:63], v80 offset:17664
    s_waitcnt lgkmcnt(2)
    v_mfma_f32_16x16x32_bf16 v[88:91], a[48:51], v[52:55], v[88:91]
    v_cvt_pk_bf16_f32 v44, v0, v1
    v_cvt_pk_bf16_f32 v45, v2, v3
    v_mfma_f32_16x16x32_bf16 v[92:95], a[52:55], v[52:55], v[92:95]
    buffer_load_dwordx4 v70, s[40:43], s31 offen offset:2048 sc1 lds
    v_mfma_f32_16x16x32_bf16 v[96:99], a[56:59], v[52:55], v[96:99]
    v_cvt_pk_bf16_f32 v46, v8, v9
    v_cvt_pk_bf16_f32 v47, v10, v11
    v_mfma_f32_16x16x32_bf16 v[100:103], a[60:63], v[52:55], v[100:103]
    ds_read_b128 v[48:51], v80 offset:17920
    s_waitcnt lgkmcnt(2)
    v_mfma_f32_16x16x32_bf16 v[88:91], a[64:67], v[56:59], v[88:91]
    v_mfma_f32_16x16x32_bf16 v[92:95], a[68:71], v[56:59], v[92:95]
    buffer_load_dwordx4 v70, s[40:43], s31 offen offset:3072 sc1 lds
    v_mfma_f32_16x16x32_bf16 v[96:99], a[72:75], v[56:59], v[96:99]
    buffer_store_dwordx4 v[44:47], v69, s[40:43], s72 offen sc1
    v_mfma_f32_16x16x32_bf16 v[100:103], a[76:79], v[56:59], v[100:103]
    ds_read_b128 v[52:55], v80 offset:18176
    s_waitcnt lgkmcnt(2)
    v_mfma_f32_16x16x32_bf16 v[88:91], a[80:83], v[60:63], v[88:91]
    s_add_u32 s31, s31, 14336
    s_add_u32 s88, s88, 1
    v_mfma_f32_16x16x32_bf16 v[92:95], a[84:87], v[60:63], v[92:95]
    buffer_load_dword v75, v78, s[40:43], s81 offen sc1
    v_add_u32 v79, v81, v79
    v_mfma_f32_16x16x32_bf16 v[96:99], a[88:91], v[60:63], v[96:99]
    buffer_load_dwordx4 v[104:107], v71, s[40:43], s93 offen offset:0 sc1
    s_waitcnt vmcnt(8)
    ds_read_b64_tr_b16 v[208:209], v175 offset:0
    ds_read_b64_tr_b16 v[210:211], v175 offset:2048
    v_mfma_f32_16x16x32_bf16 v[100:103], a[92:95], v[60:63], v[100:103]
    ds_read_b128 v[56:59], v80 offset:18432
    s_waitcnt lgkmcnt(4)
    v_mfma_f32_16x16x32_bf16 v[88:91], a[96:99], v[48:51], v[88:91]
    ds_read_b64_tr_b16 v[212:213], v171 offset:0
    ds_read_b64_tr_b16 v[214:215], v171 offset:2048
    v_mfma_f32_16x16x32_bf16 v[92:95], a[100:103], v[48:51], v[92:95]
    buffer_load_dwordx4 v[108:111], v71, s[40:43], s93 offen offset:1024 sc1
    ds_read_b64_tr_b16 v[216:217], v167 offset:0
    ds_read_b64_tr_b16 v[218:219], v167 offset:2048
    v_mfma_f32_16x16x32_bf16 v[96:99], a[104:107], v[48:51], v[96:99]
    ds_read_b64_tr_b16 v[220:221], v168 offset:0
    ds_read_b64_tr_b16 v[222:223], v168 offset:2048
    v_mfma_f32_16x16x32_bf16 v[100:103], a[108:111], v[48:51], v[100:103]
    ds_read_b128 v[60:63], v80 offset:18688
    s_waitcnt lgkmcnt(10)
    v_mfma_f32_16x16x32_bf16 v[88:91], a[112:115], v[52:55], v[88:91]
    buffer_load_dwordx4 v[112:115], v71, s[40:43], s93 offen offset:2048 sc1
    ds_read_b64_tr_b16 v[224:225], v175 offset:16384
    ds_read_b64_tr_b16 v[226:227], v175 offset:18432
    v_mfma_f32_16x16x32_bf16 v[92:95], a[116:119], v[52:55], v[92:95]
    ds_read_b64_tr_b16 v[228:229], v171 offset:16384
    ds_read_b64_tr_b16 v[230:231], v171 offset:18432
    v_mfma_f32_16x16x32_bf16 v[96:99], a[120:123], v[52:55], v[96:99]
    ds_read_b64_tr_b16 v[232:233], v167 offset:16384
    ds_read_b64_tr_b16 v[234:235], v167 offset:18432
    v_mfma_f32_16x16x32_bf16 v[100:103], a[124:127], v[52:55], v[100:103]
    ds_read_b128 v[48:51], v80 offset:18944
    buffer_load_dwordx4 v[116:119], v71, s[40:43], s93 offen offset:3072 sc1
    s_waitcnt lgkmcnt(14)
    v_mfma_f32_16x16x32_bf16 v[88:91], a[128:131], v[56:59], v[88:91]
    ds_read_b64_tr_b16 v[236:237], v168 offset:16384
    ds_read_b64_tr_b16 v[238:239], v168 offset:18432
    v_mfma_f32_16x16x32_bf16 v[92:95], a[132:135], v[56:59], v[92:95]
    ds_read_b64_tr_b16 v[240:241], v175 offset:32768
    ds_read_b64_tr_b16 v[242:243], v175 offset:34816
    v_mfma_f32_16x16x32_bf16 v[96:99], a[136:139], v[56:59], v[96:99]
    buffer_load_dwordx4 v[120:123], v71, s[40:43], s77 offen offset:0 sc1
    ds_read_b64_tr_b16 v[244:245], v171 offset:32768
    ds_read_b64_tr_b16 v[246:247], v171 offset:34816
    v_mfma_f32_16x16x32_bf16 v[100:103], a[140:143], v[56:59], v[100:103]
    ds_read_b128 v[52:55], v80 offset:19200
    s_waitcnt lgkmcnt(14)
    v_mfma_f32_16x16x32_bf16 v[88:91], a[144:147], v[60:63], v[88:91]
    ds_read_b64_tr_b16 v[248:249], v167 offset:32768
    ds_read_b64_tr_b16 v[250:251], v167 offset:34816
    v_mfma_f32_16x16x32_bf16 v[92:95], a[148:151], v[60:63], v[92:95]
    buffer_load_dwordx4 v[124:127], v71, s[40:43], s77 offen offset:1024 sc1
    ds_read_b64_tr_b16 v[252:253], v168 offset:32768
    ds_read_b64_tr_b16 v[254:255], v168 offset:34816
    v_mfma_f32_16x16x32_bf16 v[96:99], a[152:155], v[60:63], v[96:99]
    v_mfma_f32_16x16x32_bf16 v[100:103], a[156:159], v[60:63], v[100:103]
    ds_read_b128 v[56:59], v80 offset:19456
    s_waitcnt lgkmcnt(12)
    v_mfma_f32_16x16x32_bf16 v[88:91], a[160:163], v[48:51], v[88:91]
    buffer_load_dwordx4 v[128:131], v71, s[40:43], s77 offen offset:2048 sc1
    v_mfma_f32_16x16x32_bf16 v[92:95], a[164:167], v[48:51], v[92:95]
    s_waitcnt vmcnt(8)
    buffer_store_dword v73, off, s[40:43], s80 sc1
    v_mfma_f32_16x16x32_bf16 v[96:99], a[168:171], v[48:51], v[96:99]
    v_add_u32 v73, 1, v73
    s_add_u32 s72, s92, 6320128
    v_mfma_f32_16x16x32_bf16 v[100:103], a[172:175], v[48:51], v[100:103]
    ds_read_b128 v[60:63], v80 offset:19712
    s_waitcnt lgkmcnt(6)
    v_mfma_f32_16x16x32_bf16 v[88:91], a[176:179], v[52:55], v[88:91]
    s_waitcnt vmcnt(8)
    v_subrev_u32 v75, v79, v75
    v_mfma_f32_16x16x32_bf16 v[92:95], a[180:183], v[52:55], v[92:95]
    v_cmp_le_u32 vcc, 64, v75
    v_mfma_f32_16x16x32_bf16 v[96:99], a[184:187], v[52:55], v[96:99]
    s_cbranch_vccz L_bk_95
    s_mov_b32 s71, 0
L_wp_96:
    buffer_load_dword v75, v78, s[40:43], s81 offen sc1
    s_waitcnt vmcnt(0)
    v_subrev_u32 v75, v79, v75
    v_cmp_le_u32 vcc, 64, v75
    s_add_u32 s71, s71, 1
    s_cmp_eq_u64 vcc, 0
    s_cbranch_scc1 L_wpd_97
    s_cmp_lt_u32 s71, 131072
    s_cbranch_scc1 L_wp_96
L_wpd_97:
L_bk_95:
    v_add_u32 v79, 1, v79
    v_mfma_f32_16x16x32_bf16 v[100:103], a[188:191], v[52:55], v[100:103]
    s_waitcnt lgkmcnt(1)
    v_mfma_f32_16x16x32_bf16 v[88:91], a[192:195], v[56:59], v[88:91]
    buffer_load_dwordx4 v[132:135], v71, s[40:43], s73 offen offset:0 sc1
    v_mfma_f32_16x16x32_bf16 v[92:95], a[196:199], v[56:59], v[92:95]
    v_mfma_f32_16x16x32_bf16 v[96:99], a[200:203], v[56:59], v[96:99]
    v_mfma_f32_16x16x32_bf16 v[100:103], a[204:207], v[56:59], v[100:103]
    buffer_load_dwordx4 v[136:139], v71, s[40:43], s73 offen offset:1024 sc1
    s_waitcnt lgkmcnt(0)
    v_mfma_f32_16x16x32_bf16 v[88:91], a[208:211], v[60:63], v[88:91]
    v_mfma_f32_16x16x32_bf16 v[92:95], a[212:215], v[60:63], v[92:95]
    v_mfma_f32_16x16x32_bf16 v[96:99], a[216:219], v[60:63], v[96:99]
    buffer_load_dwordx4 v[140:143], v71, s[40:43], s73 offen offset:2048 sc1
    v_mfma_f32_16x16x32_bf16 v[100:103], a[220:223], v[60:63], v[100:103]
    s_waitcnt vmcnt(10)
    v_mfma_f32_16x16x32_bf16 v[16:19], a[224:227], v[104:107], 0
    v_mfma_f32_16x16x32_bf16 v[20:23], a[228:231], v[104:107], 0
    buffer_load_dwordx4 v[144:147], v71, s[40:43], s73 offen offset:3072 sc1
    v_mfma_f32_16x16x32_bf16 v[24:27], a[232:235], v[104:107], 0
    v_mfma_f32_16x16x32_bf16 v[28:31], a[236:239], v[104:107], 0
    s_waitcnt vmcnt(10)
    v_mfma_f32_16x16x32_bf16 v[16:19], a[240:243], v[108:111], v[16:19]
    buffer_load_dwordx4 v[148:151], v71, s[40:43], s75 offen offset:0 sc1
    v_mul_f32 v88, v88, v92
    v_mul_f32 v89, v89, v93
    v_mfma_f32_16x16x32_bf16 v[20:23], a[244:247], v[108:111], v[20:23]
    v_mul_f32 v90, v90, v94
    v_mul_f32 v91, v91, v95
    v_mfma_f32_16x16x32_bf16 v[24:27], a[248:251], v[108:111], v[24:27]
    v_mul_f32 v96, v96, v100
    v_mul_f32 v97, v97, v101
    v_mfma_f32_16x16x32_bf16 v[28:31], a[252:255], v[108:111], v[28:31]
    buffer_load_dwordx4 v[152:155], v71, s[40:43], s75 offen offset:1024 sc1
    v_mul_f32 v98, v98, v102
    v_mul_f32 v99, v99, v103
    s_waitcnt vmcnt(11)
    v_mfma_f32_16x16x32_bf16 v[16:19], v[176:179], v[112:115], v[16:19]
    v_cvt_pk_bf16_f32 v44, v88, v89
    v_cvt_pk_bf16_f32 v45, v90, v91
    v_mfma_f32_16x16x32_bf16 v[20:23], v[180:183], v[112:115], v[20:23]
    v_cvt_pk_bf16_f32 v46, v96, v97
    v_cvt_pk_bf16_f32 v47, v98, v99
    v_mfma_f32_16x16x32_bf16 v[24:27], v[184:187], v[112:115], v[24:27]
    buffer_load_dwordx4 v[156:159], v71, s[40:43], s75 offen offset:2048 sc1
    buffer_store_dwordx4 v[44:47], v69, s[40:43], s72 offen sc1
    v_mfma_f32_16x16x32_bf16 v[28:31], v[188:191], v[112:115], v[28:31]
    s_mov_b32 s72, s92
    s_mov_b32 s74, s94
    s_waitcnt vmcnt(12)
    v_mfma_f32_16x16x32_bf16 v[16:19], v[192:195], v[116:119], v[16:19]
    v_mfma_f32_16x16x32_bf16 v[20:23], v[196:199], v[116:119], v[20:23]
    s_mov_b32 s100, 2
    v_mfma_f32_16x16x32_bf16 v[24:27], v[200:203], v[116:119], v[24:27]
    s_add_u32 s73, s93, 6291456
    s_add_u32 s77, s73, 4096
    v_mfma_f32_16x16x32_bf16 v[28:31], v[204:207], v[116:119], v[28:31]
    s_waitcnt vmcnt(11)
    v_mfma_f32_16x16x32_bf16 v[16:19], v[208:211], v[120:123], v[16:19]
    v_mfma_f32_16x16x32_bf16 v[20:23], v[212:215], v[120:123], v[20:23]
    v_mfma_f32_16x16x32_bf16 v[24:27], v[216:219], v[120:123], v[24:27]
    v_mfma_f32_16x16x32_bf16 v[28:31], v[220:223], v[120:123], v[28:31]
    s_waitcnt vmcnt(10)
    v_mfma_f32_16x16x32_bf16 v[16:19], v[224:227], v[124:127], v[16:19]
    v_mfma_f32_16x16x32_bf16 v[20:23], v[228:231], v[124:127], v[20:23]
    v_mfma_f32_16x16x32_bf16 v[24:27], v[232:235], v[124:127], v[24:27]
    v_mfma_f32_16x16x32_bf16 v[28:31], v[236:239], v[124:127], v[28:31]
    s_waitcnt vmcnt(9)
    v_mfma_f32_16x16x32_bf16 v[16:19], v[240:243], v[128:131], v[16:19]
    v_mfma_f32_16x16x32_bf16 v[20:23], v[244:247], v[128:131], v[20:23]
    v_mfma_f32_16x16x32_bf16 v[24:27], v[248:251], v[128:131], v[24:27]
    v_mfma_f32_16x16x32_bf16 v[28:31], v[252:255], v[128:131], v[28:31]
    s_waitcnt vmcnt(7)
    v_mfma_f32_16x16x32_bf16 v[88:91], a[224:227], v[132:135], 0
    v_mfma_f32_16x16x32_bf16 v[92:95], a[228:231], v[132:135], 0
    v_mfma_f32_16x16x32_bf16 v[96:99], a[232:235], v[132:135], 0
    v_mfma_f32_16x16x32_bf16 v[100:103], a[236:239], v[132:135], 0
    s_waitcnt vmcnt(6)
    v_mfma_f32_16x16x32_bf16 v[88:91], a[240:243], v[136:139], v[88:91]
    ds_write_b128 v65, v[20:23] offset:12288
    v_mfma_f32_16x16x32_bf16 v[92:95], a[244:247], v[136:139], v[92:95]
    v_mfma_f32_16x16x32_bf16 v[96:99], a[248:251], v[136:139], v[96:99]
    ds_write_b128 v66, v[24:27] offset:16384
    v_mfma_f32_16x16x32_bf16 v[100:103], a[252:255], v[136:139], v[100:103]
    s_waitcnt vmcnt(5)
    v_mfma_f32_16x16x32_bf16 v[88:91], v[176:179], v[140:143], v[88:91]
    ds_write_b128 v67, v[28:31] offset:20480
    v_mfma_f32_16x16x32_bf16 v[92:95], v[180:183], v[140:143], v[92:95]
    v_mfma_f32_16x16x32_bf16 v[96:99], v[184:187], v[140:143], v[96:99]
    v_mfma_f32_16x16x32_bf16 v[100:103], v[188:191], v[140:143], v[100:103]
    s_waitcnt lgkmcnt(0)
    s_barrier
    s_waitcnt vmcnt(4)
    v_mfma_f32_16x16x32_bf16 v[88:91], v[192:195], v[144:147], v[88:91]
    buffer_load_dword v75, v78, s[40:43], s81 offen sc1
    v_mfma_f32_16x16x32_bf16 v[92:95], v[196:199], v[144:147], v[92:95]
    ds_read_b128 v[32:35], v68 offset:12288
    ds_read_b128 v[36:39], v68 offset:16384
    v_mfma_f32_16x16x32_bf16 v[96:99], v[200:203], v[144:147], v[96:99]
    ds_read_b128 v[40:43], v68 offset:20480
    v_mfma_f32_16x16x32_bf16 v[100:103], v[204:207], v[144:147], v[100:103]
    s_waitcnt vmcnt(4)
    v_mfma_f32_16x16x32_bf16 v[88:91], v[208:211], v[148:151], v[88:91]
    v_mfma_f32_16x16x32_bf16 v[92:95], v[212:215], v[148:151], v[92:95]
    s_waitcnt lgkmcnt(2)
    v_add_f32 v32, v32, v16
    v_add_f32 v33, v33, v17
    v_mfma_f32_16x16x32_bf16 v[96:99], v[216:219], v[148:151], v[96:99]
    v_add_f32 v34, v34, v18
    v_add_f32 v35, v35, v19
    v_mfma_f32_16x16x32_bf16 v[100:103], v[220:223], v[148:151], v[100:103]
    ds_read_b128 v[48:51], v64 offset:0
    s_waitcnt lgkmcnt(1)
    v_add_f32 v36, v36, v40
    v_add_f32 v37, v37, v41
    s_waitcnt vmcnt(3)
    v_mfma_f32_16x16x32_bf16 v[88:91], v[224:227], v[152:155], v[88:91]
    v_add_f32 v38, v38, v42
    v_add_f32 v39, v39, v43
    v_mfma_f32_16x16x32_bf16 v[92:95], v[228:231], v[152:155], v[92:95]
    v_add_f32 v32, v32, v36
    v_add_f32 v33, v33, v37
    v_mfma_f32_16x16x32_bf16 v[96:99], v[232:235], v[152:155], v[96:99]
    v_add_f32 v34, v34, v38
    v_add_f32 v35, v35, v39
    v_mfma_f32_16x16x32_bf16 v[100:103], v[236:239], v[152:155], v[100:103]
    ds_read_b128 v[52:55], v64 offset:256
    v_cvt_pk_bf16_f32 v32, v32, v33
    v_cvt_pk_bf16_f32 v33, v34, v35
    s_waitcnt vmcnt(2)
    v_mfma_f32_16x16x32_bf16 v[88:91], v[240:243], v[156:159], v[88:91]
    v_mfma_f32_16x16x32_bf16 v[92:95], v[244:247], v[156:159], v[92:95]
    buffer_store_dwordx2 v[32:33], v72, s[40:43], s74 offen sc1
    s_add_u32 s74, s74, 28672
    v_mfma_f32_16x16x32_bf16 v[96:99], v[248:251], v[156:159], v[96:99]
    v_mfma_f32_16x16x32_bf16 v[100:103], v[252:255], v[156:159], v[100:103]
    ds_read_b128 v[56:59], v64 offset:512
.p2align 6
L_blk_130:
    s_waitcnt lgkmcnt(2)
    v_mfma_f32_16x16x32_bf16 v[0:3], a[0:3], v[48:51], 0
    v_mfma_f32_16x16x32_bf16 v[4:7], a[4:7], v[48:51], 0
    v_mfma_f32_16x16x32_bf16 v[8:11], a[8:11], v[48:51], 0
    v_mfma_f32_16x16x32_bf16 v[12:15], a[12:15], v[48:51], 0
    ds_read_b128 v[60:63], v64 offset:768
    s_waitcnt lgkmcnt(2)
    v_mfma_f32_16x16x32_bf16 v[0:3], a[16:19], v[52:55], v[0:3]
    ds_write_b128 v65, v[92:95] offset:0
    v_mfma_f32_16x16x32_bf16 v[4:7], a[20:23], v[52:55], v[4:7]
    v_mfma_f32_16x16x32_bf16 v[8:11], a[24:27], v[52:55], v[8:11]
    v_mfma_f32_16x16x32_bf16 v[12:15], a[28:31], v[52:55], v[12:15]
    ds_read_b128 v[48:51], v64 offset:1024
    s_waitcnt lgkmcnt(3)
    v_mfma_f32_16x16x32_bf16 v[0:3], a[32:35], v[56:59], v[0:3]
    ds_write_b128 v66, v[96:99] offset:4096
    v_mfma_f32_16x16x32_bf16 v[4:7], a[36:39], v[56:59], v[4:7]
    s_waitcnt vmcnt(1)
    v_subrev_u32 v75, v79, v75
    v_mfma_f32_16x16x32_bf16 v[8:11], a[40:43], v[56:59], v[8:11]
    v_cmp_le_u32 vcc, 64, v75
    v_mfma_f32_16x16x32_bf16 v[12:15], a[44:47], v[56:59], v[12:15]
    ds_read_b128 v[52:55], v64 offset:1280
    s_cbranch_vccnz L_sl_98
L_bk_99:
    s_add_u32 m0, s96, 14336
    s_waitcnt lgkmcnt(4)
    v_mfma_f32_16x16x32_bf16 v[0:3], a[48:51], v[60:63], v[0:3]
    buffer_load_dwordx4 v70, s[40:43], s31 offen offset:0 sc1 lds
    v_mfma_f32_16x16x32_bf16 v[4:7], a[52:55], v[60:63], v[4:7]
    v_mfma_f32_16x16x32_bf16 v[8:11], a[56:59], v[60:63], v[8:11]
    v_mfma_f32_16x16x32_bf16 v[12:15], a[60:63], v[60:63], v[12:15]
    ds_read_b128 v[56:59], v64 offset:1536
    s_waitcnt lgkmcnt(3)
    v_mfma_f32_16x16x32_bf16 v[0:3], a[64:67], v[48:51], v[0:3]
    ds_write_b128 v67, v[100:103] offset:8192
    v_mfma_f32_16x16x32_bf16 v[4:7], a[68:71], v[48:51], v[4:7]
    buffer_load_dwordx4 v70, s[40:43], s31 offen offset:1024 sc1 lds
    v_mfma_f32_16x16x32_bf16 v[8:11], a[72:75], v[48:51], v[8:11]
    v_mfma_f32_16x16x32_bf16 v[12:15], a[76:79], v[48:51], v[12:15]
    ds_read_b128 v[60:63], v64 offset:1792
    s_waitcnt lgkmcnt(3)
    v_mfma_f32_16x16x32_bf16 v[0:3], a[80:83], v[52:55], v[0:3]
    s_waitcnt vmcnt(2)
    s_waitcnt vmcnt(2)
    buffer_store_dword v73, off, s[40:43], s80 sc1
    v_mfma_f32_16x16x32_bf16 v[4:7], a[84:87], v[52:55], v[4:7]
    v_add_u32 v73, 1, v73
    v_mfma_f32_16x16x32_bf16 v[8:11], a[88:91], v[52:55], v[8:11]
    buffer_load_dwordx4 v70, s[40:43], s31 offen offset:2048 sc1 lds
    v_mfma_f32_16x16x32_bf16 v[12:15], a[92:95], v[52:55], v[12:15]
    ds_read_b128 v[48:51], v64 offset:2048
    s_waitcnt lgkmcnt(3)
    v_mfma_f32_16x16x32_bf16 v[0:3], a[96:99], v[56:59], v[0:3]
    buffer_load_dwordx4 v70, s[40:43], s31 offen offset:3072 sc1 lds
    v_mfma_f32_16x16x32_bf16 v[4:7], a[100:103], v[56:59], v[4:7]
    v_mfma_f32_16x16x32_bf16 v[8:11], a[104:107], v[56:59], v[8:11]
    buffer_load_dwordx4 v[104:107], v71, s[40:43], s73 offen offset:0 sc1
    v_mfma_f32_16x16x32_bf16 v[12:15], a[108:111], v[56:59], v[12:15]
    ds_read_b128 v[52:55], v64 offset:2304
    s_waitcnt lgkmcnt(2)
    v_mfma_f32_16x16x32_bf16 v[0:3], a[112:115], v[60:63], v[0:3]
    v_mfma_f32_16x16x32_bf16 v[4:7], a[116:119], v[60:63], v[4:7]
    v_mfma_f32_16x16x32_bf16 v[8:11], a[120:123], v[60:63], v[8:11]
    buffer_load_dwordx4 v[108:111], v71, s[40:43], s73 offen offset:1024 sc1
    v_mfma_f32_16x16x32_bf16 v[12:15], a[124:127], v[60:63], v[12:15]
    ds_read_b128 v[56:59], v64 offset:2560
    s_waitcnt lgkmcnt(2)
    v_mfma_f32_16x16x32_bf16 v[0:3], a[128:131], v[48:51], v[0:3]
    v_mfma_f32_16x16x32_bf16 v[4:7], a[132:135], v[48:51], v[4:7]
    buffer_load_dwordx4 v[112:115], v71, s[40:43], s73 offen offset:2048 sc1
    v_mfma_f32_16x16x32_bf16 v[8:11], a[136:139], v[48:51], v[8:11]
    v_mfma_f32_16x16x32_bf16 v[12:15], a[140:143], v[48:51], v[12:15]
    ds_read_b128 v[60:63], v64 offset:2816
    s_waitcnt lgkmcnt(2)
    v_mfma_f32_16x16x32_bf16 v[0:3], a[144:147], v[52:55], v[0:3]
    v_mfma_f32_16x16x32_bf16 v[4:7], a[148:151], v[52:55], v[4:7]
    buffer_load_dwordx4 v[116:119], v71, s[40:43], s73 offen offset:3072 sc1
    v_mfma_f32_16x16x32_bf16 v[8:11], a[152:155], v[52:55], v[8:11]
    v_mfma_f32_16x16x32_bf16 v[12:15], a[156:159], v[52:55], v[12:15]
    ds_read_b128 v[48:51], v64 offset:3072
    s_waitcnt lgkmcnt(2)
    v_mfma_f32_16x16x32_bf16 v[0:3], a[160:163], v[56:59], v[0:3]
    buffer_load_dwordx4 v[120:123], v71, s[40:43], s77 offen offset:0 sc1
    v_mfma_f32_16x16x32_bf16 v[4:7], a[164:167], v[56:59], v[4:7]
    v_mfma_f32_16x16x32_bf16 v[8:11], a[168:171], v[56:59], v[8:11]
    v_mfma_f32_16x16x32_bf16 v[12:15], a[172:175], v[56:59], v[12:15]
    ds_read_b128 v[52:55], v64 offset:3328
    s_waitcnt lgkmcnt(2)
    v_mfma_f32_16x16x32_bf16 v[0:3], a[176:179], v[60:63], v[0:3]
    buffer_load_dwordx4 v[124:127], v71, s[40:43], s77 offen offset:1024 sc1
    v_mfma_f32_16x16x32_bf16 v[4:7], a[180:183], v[60:63], v[4:7]
    v_mfma_f32_16x16x32_bf16 v[8:11], a[184:187], v[60:63], v[8:11]
    v_mfma_f32_16x16x32_bf16 v[12:15], a[188:191], v[60:63], v[12:15]
    s_waitcnt lgkmcnt(1)
    v_mfma_f32_16x16x32_bf16 v[0:3], a[192:195], v[48:51], v[0:3]
    buffer_load_dwordx4 v[128:131], v71, s[40:43], s77 offen offset:2048 sc1
    v_mfma_f32_16x16x32_bf16 v[4:7], a[196:199], v[48:51], v[4:7]
    v_mfma_f32_16x16x32_bf16 v[8:11], a[200:203], v[48:51], v[8:11]
    v_mfma_f32_16x16x32_bf16 v[12:15], a[204:207], v[48:51], v[12:15]
    s_waitcnt lgkmcnt(0)
    v_mfma_f32_16x16x32_bf16 v[0:3], a[208:211], v[52:55], v[0:3]
    s_waitcnt vmcnt(7)
    s_barrier
    v_mfma_f32_16x16x32_bf16 v[4:7], a[212:215], v[52:55], v[4:7]
    ds_read_b128 v[32:35], v68 offset:0
    v_mfma_f32_16x16x32_bf16 v[8:11], a[216:219], v[52:55], v[8:11]
    ds_read_b128 v[36:39], v68 offset:4096
    v_mfma_f32_16x16x32_bf16 v[12:15], a[220:223], v[52:55], v[12:15]
    ds_read_b128 v[40:43], v68 offset:8192
    s_waitcnt vmcnt(6)
    v_mfma_f32_16x16x32_bf16 v[16:19], a[224:227], v[104:107], 0
    v_mfma_f32_16x16x32_bf16 v[20:23], a[228:231], v[104:107], 0
    s_add_u32 s73, s73, 28672
    s_add_u32 s77, s73, 4096
    v_mfma_f32_16x16x32_bf16 v[24:27], a[232:235], v[104:107], 0
    s_add_u32 s100, s100, 1
    s_and_b32 s75, s100, 3
    v_mfma_f32_16x16x32_bf16 v[28:31], a[236:239], v[104:107], 0
    s_waitcnt vmcnt(5)
    s_mul_i32 s75, s75, 458752
    s_add_u32 s31, s95, s75
    v_mfma_f32_16x16x32_bf16 v[16:19], a[240:243], v[108:111], v[16:19]
    s_waitcnt lgkmcnt(2)
    v_add_f32 v32, v32, v88
    v_add_f32 v33, v33, v89
    v_mfma_f32_16x16x32_bf16 v[20:23], a[244:247], v[108:111], v[20:23]
    v_add_f32 v34, v34, v90
    v_add_f32 v35, v35, v91
    v_mfma_f32_16x16x32_bf16 v[24:27], a[248:251], v[108:111], v[24:27]
    s_waitcnt lgkmcnt(0)
    v_add_f32 v36, v36, v40
    v_add_f32 v37, v37, v41
    v_mfma_f32_16x16x32_bf16 v[28:31], a[252:255], v[108:111], v[28:31]
    v_add_f32 v38, v38, v42
    v_add_f32 v39, v39, v43
    s_waitcnt vmcnt(4)
    v_mfma_f32_16x16x32_bf16 v[16:19], v[176:179], v[112:115], v[16:19]
    v_add_f32 v32, v32, v36
    v_add_f32 v33, v33, v37
    v_mfma_f32_16x16x32_bf16 v[20:23], v[180:183], v[112:115], v[20:23]
    v_add_f32 v34, v34, v38
    v_add_f32 v35, v35, v39
    v_mfma_f32_16x16x32_bf16 v[24:27], v[184:187], v[112:115], v[24:27]
    v_cvt_pk_bf16_f32 v32, v32, v33
    v_cvt_pk_bf16_f32 v33, v34, v35
    v_mfma_f32_16x16x32_bf16 v[28:31], v[188:191], v[112:115], v[28:31]
    buffer_store_dwordx2 v[32:33], v72, s[40:43], s74 offen sc1
    s_waitcnt vmcnt(4)
    v_mfma_f32_16x16x32_bf16 v[16:19], v[192:195], v[116:119], v[16:19]
    v_mul_f32 v0, v0, v4
    v_mul_f32 v1, v1, v5
    buffer_load_dword v75, v78, s[40:43], s81 offen sc1
    v_mfma_f32_16x16x32_bf16 v[20:23], v[196:199], v[116:119], v[20:23]
    v_mul_f32 v2, v2, v6
    v_mul_f32 v3, v3, v7
    v_add_u32 v79, 1, v79
    v_mfma_f32_16x16x32_bf16 v[24:27], v[200:203], v[116:119], v[24:27]
    v_mul_f32 v8, v8, v12
    v_mul_f32 v9, v9, v13
    v_mfma_f32_16x16x32_bf16 v[28:31], v[204:207], v[116:119], v[28:31]
    s_waitcnt vmcnt(4)
    v_mul_f32 v10, v10, v14
    v_mul_f32 v11, v11, v15
    v_mfma_f32_16x16x32_bf16 v[16:19], v[208:211], v[120:123], v[16:19]
    v_cvt_pk_bf16_f32 v44, v0, v1
    v_cvt_pk_bf16_f32 v45, v2, v3
    v_mfma_f32_16x16x32_bf16 v[20:23], v[212:215], v[120:123], v[20:23]
    v_cvt_pk_bf16_f32 v46, v8, v9
    v_cvt_pk_bf16_f32 v47, v10, v11
    v_mfma_f32_16x16x32_bf16 v[24:27], v[216:219], v[120:123], v[24:27]
    buffer_store_dwordx4 v[44:47], v69, s[40:43], s72 offen sc1
    v_mfma_f32_16x16x32_bf16 v[28:31], v[220:223], v[120:123], v[28:31]
    ds_read_b128 v[56:59], v64 offset:14336
    s_waitcnt vmcnt(4)
    v_mfma_f32_16x16x32_bf16 v[16:19], v[224:227], v[124:127], v[16:19]
    v_mfma_f32_16x16x32_bf16 v[20:23], v[228:231], v[124:127], v[20:23]
    v_mfma_f32_16x16x32_bf16 v[24:27], v[232:235], v[124:127], v[24:27]
    s_xor_b32 s30, s30, 57344
    s_add_u32 s74, s30, s94
    v_mfma_f32_16x16x32_bf16 v[28:31], v[236:239], v[124:127], v[28:31]
    ds_read_b128 v[60:63], v64 offset:14592
    s_waitcnt vmcnt(3)
    v_mfma_f32_16x16x32_bf16 v[16:19], v[240:243], v[128:131], v[16:19]
    s_add_u32 s72, s72, 28672
    v_mfma_f32_16x16x32_bf16 v[20:23], v[244:247], v[128:131], v[20:23]
    v_mfma_f32_16x16x32_bf16 v[24:27], v[248:251], v[128:131], v[24:27]
    v_mfma_f32_16x16x32_bf16 v[28:31], v[252:255], v[128:131], v[28:31]
    ds_read_b128 v[48:51], v64 offset:14848
    s_waitcnt lgkmcnt(2)
    v_mfma_f32_16x16x32_bf16 v[0:3], a[0:3], v[56:59], 0
    v_mfma_f32_16x16x32_bf16 v[4:7], a[4:7], v[56:59], 0
    v_mfma_f32_16x16x32_bf16 v[8:11], a[8:11], v[56:59], 0
    v_mfma_f32_16x16x32_bf16 v[12:15], a[12:15], v[56:59], 0
    ds_read_b128 v[52:55], v64 offset:15104
    s_waitcnt lgkmcnt(2)
    v_mfma_f32_16x16x32_bf16 v[0:3], a[16:19], v[60:63], v[0:3]
    ds_write_b128 v65, v[20:23] offset:12288
    v_mfma_f32_16x16x32_bf16 v[4:7], a[20:23], v[60:63], v[4:7]
    v_mfma_f32_16x16x32_bf16 v[8:11], a[24:27], v[60:63], v[8:11]
    v_mfma_f32_16x16x32_bf16 v[12:15], a[28:31], v[60:63], v[12:15]
    ds_read_b128 v[56:59], v64 offset:15360
    s_waitcnt lgkmcnt(3)
    v_mfma_f32_16x16x32_bf16 v[0:3], a[32:35], v[48:51], v[0:3]
    ds_write_b128 v66, v[24:27] offset:16384
    v_mfma_f32_16x16x32_bf16 v[4:7], a[36:39], v[48:51], v[4:7]
    s_waitcnt vmcnt(1)
    v_subrev_u32 v75, v79, v75
    v_mfma_f32_16x16x32_bf16 v[8:11], a[40:43], v[48:51], v[8:11]
    v_cmp_le_u32 vcc, 64, v75
    v_mfma_f32_16x16x32_bf16 v[12:15], a[44:47], v[48:51], v[12:15]
    ds_read_b128 v[60:63], v64 offset:15616
    s_cbranch_vccnz L_sl_102
L_bk_103:
    s_add_u32 m0, s96, 0
    s_waitcnt lgkmcnt(4)
    v_mfma_f32_16x16x32_bf16 v[0:3], a[48:51], v[52:55], v[0:3]
    buffer_load_dwordx4 v70, s[40:43], s31 offen offset:0 sc1 lds
    v_mfma_f32_16x16x32_bf16 v[4:7], a[52:55], v[52:55], v[4:7]
    v_mfma_f32_16x16x32_bf16 v[8:11], a[56:59], v[52:55], v[8:11]
    v_mfma_f32_16x16x32_bf16 v[12:15], a[60:63], v[52:55], v[12:15]
    ds_read_b128 v[48:51], v64 offset:15872
    s_waitcnt lgkmcnt(3)
    v_mfma_f32_16x16x32_bf16 v[0:3], a[64:67], v[56:59], v[0:3]
    ds_write_b128 v67, v[28:31] offset:20480
    v_mfma_f32_16x16x32_bf16 v[4:7], a[68:71], v[56:59], v[4:7]
    buffer_load_dwordx4 v70, s[40:43], s31 offen offset:1024 sc1 lds
    v_mfma_f32_16x16x32_bf16 v[8:11], a[72:75], v[56:59], v[8:11]
    v_mfma_f32_16x16x32_bf16 v[12:15], a[76:79], v[56:59], v[12:15]
    ds_read_b128 v[52:55], v64 offset:16128
    s_waitcnt lgkmcnt(3)
    v_mfma_f32_16x16x32_bf16 v[0:3], a[80:83], v[60:63], v[0:3]
    s_waitcnt vmcnt(2)
    buffer_store_dword v73, off, s[40:43], s80 sc1
    v_mfma_f32_16x16x32_bf16 v[4:7], a[84:87], v[60:63], v[4:7]
    v_add_u32 v73, 1, v73
    v_mfma_f32_16x16x32_bf16 v[8:11], a[88:91], v[60:63], v[8:11]
    buffer_load_dwordx4 v70, s[40:43], s31 offen offset:2048 sc1 lds
    v_mfma_f32_16x16x32_bf16 v[12:15], a[92:95], v[60:63], v[12:15]
    ds_read_b128 v[56:59], v64 offset:16384
    s_waitcnt lgkmcnt(3)
    v_mfma_f32_16x16x32_bf16 v[0:3], a[96:99], v[48:51], v[0:3]
    buffer_load_dwordx4 v70, s[40:43], s31 offen offset:3072 sc1 lds
    v_mfma_f32_16x16x32_bf16 v[4:7], a[100:103], v[48:51], v[4:7]
    v_mfma_f32_16x16x32_bf16 v[8:11], a[104:107], v[48:51], v[8:11]
    buffer_load_dwordx4 v[104:107], v71, s[40:43], s73 offen offset:0 sc1
    v_mfma_f32_16x16x32_bf16 v[12:15], a[108:111], v[48:51], v[12:15]
    ds_read_b128 v[60:63], v64 offset:16640
    s_waitcnt lgkmcnt(2)
    v_mfma_f32_16x16x32_bf16 v[0:3], a[112:115], v[52:55], v[0:3]
    v_mfma_f32_16x16x32_bf16 v[4:7], a[116:119], v[52:55], v[4:7]
    v_mfma_f32_16x16x32_bf16 v[8:11], a[120:123], v[52:55], v[8:11]
    buffer_load_dwordx4 v[108:111], v71, s[40:43], s73 offen offset:1024 sc1
    v_mfma_f32_16x16x32_bf16 v[12:15], a[124:127], v[52:55], v[12:15]
    ds_read_b128 v[48:51], v64 offset:16896
    s_waitcnt lgkmcnt(2)
    v_mfma_f32_16x16x32_bf16 v[0:3], a[128:131], v[56:59], v[0:3]
    v_mfma_f32_16x16x32_bf16 v[4:7], a[132:135], v[56:59], v[4:7]
    buffer_load_dwordx4 v[112:115], v71, s[40:43], s73 offen offset:2048 sc1
    v_mfma_f32_16x16x32_bf16 v[8:11], a[136:139], v[56:59], v[8:11]
    v_mfma_f32_16x16x32_bf16 v[12:15], a[140:143], v[56:59], v[12:15]
    ds_read_b128 v[52:55], v64 offset:17152
    s_waitcnt lgkmcnt(2)
    v_mfma_f32_16x16x32_bf16 v[0:3], a[144:147], v[60:63], v[0:3]
    v_mfma_f32_16x16x32_bf16 v[4:7], a[148:151], v[60:63], v[4:7]
    buffer_load_dwordx4 v[116:119], v71, s[40:43], s73 offen offset:3072 sc1
    v_mfma_f32_16x16x32_bf16 v[8:11], a[152:155], v[60:63], v[8:11]
    v_mfma_f32_16x16x32_bf16 v[12:15], a[156:159], v[60:63], v[12:15]
    ds_read_b128 v[56:59], v64 offset:17408
    s_waitcnt lgkmcnt(2)
    v_mfma_f32_16x16x32_bf16 v[0:3], a[160:163], v[48:51], v[0:3]
    buffer_load_dwordx4 v[120:123], v71, s[40:43], s77 offen offset:0 sc1
    v_mfma_f32_16x16x32_bf16 v[4:7], a[164:167], v[48:51], v[4:7]
    v_mfma_f32_16x16x32_bf16 v[8:11], a[168:171], v[48:51], v[8:11]
    v_mfma_f32_16x16x32_bf16 v[12:15], a[172:175], v[48:51], v[12:15]
    ds_read_b128 v[60:63], v64 offset:17664
    s_waitcnt lgkmcnt(2)
    v_mfma_f32_16x16x32_bf16 v[0:3], a[176:179], v[52:55], v[0:3]
    buffer_load_dwordx4 v[124:127], v71, s[40:43], s77 offen offset:1024 sc1
    v_mfma_f32_16x16x32_bf16 v[4:7], a[180:183], v[52:55], v[4:7]
    v_mfma_f32_16x16x32_bf16 v[8:11], a[184:187], v[52:55], v[8:11]
    v_mfma_f32_16x16x32_bf16 v[12:15], a[188:191], v[52:55], v[12:15]
    s_waitcnt lgkmcnt(1)
    v_mfma_f32_16x16x32_bf16 v[0:3], a[192:195], v[56:59], v[0:3]
    buffer_load_dwordx4 v[128:131], v71, s[40:43], s77 offen offset:2048 sc1
    v_mfma_f32_16x16x32_bf16 v[4:7], a[196:199], v[56:59], v[4:7]
    v_mfma_f32_16x16x32_bf16 v[8:11], a[200:203], v[56:59], v[8:11]
    v_mfma_f32_16x16x32_bf16 v[12:15], a[204:207], v[56:59], v[12:15]
    s_waitcnt lgkmcnt(0)
    v_mfma_f32_16x16x32_bf16 v[0:3], a[208:211], v[60:63], v[0:3]
    s_waitcnt vmcnt(7)
    s_barrier
    v_mfma_f32_16x16x32_bf16 v[4:7], a[212:215], v[60:63], v[4:7]
    ds_read_b128 v[32:35], v68 offset:12288
    v_mfma_f32_16x16x32_bf16 v[8:11], a[216:219], v[60:63], v[8:11]
    ds_read_b128 v[36:39], v68 offset:16384
    v_mfma_f32_16x16x32_bf16 v[12:15], a[220:223], v[60:63], v[12:15]
    ds_read_b128 v[40:43], v68 offset:20480
    s_waitcnt vmcnt(6)
    v_mfma_f32_16x16x32_bf16 v[88:91], a[224:227], v[104:107], 0
    v_mfma_f32_16x16x32_bf16 v[92:95], a[228:231], v[104:107], 0
    s_add_u32 s73, s93, s89
    s_add_u32 s77, s73, 4096
    v_mfma_f32_16x16x32_bf16 v[96:99], a[232:235], v[104:107], 0
    s_xor_b32 s89, s89, 6291456
    s_add_u32 s31, s31, 14336
    v_mfma_f32_16x16x32_bf16 v[100:103], a[236:239], v[104:107], 0
    s_waitcnt vmcnt(5)
    v_mfma_f32_16x16x32_bf16 v[88:91], a[240:243], v[108:111], v[88:91]
    s_waitcnt lgkmcnt(2)
    v_add_f32 v32, v32, v16
    v_add_f32 v33, v33, v17
    v_mfma_f32_16x16x32_bf16 v[92:95], a[244:247], v[108:111], v[92:95]
    v_add_f32 v34, v34, v18
    v_add_f32 v35, v35, v19
    v_mfma_f32_16x16x32_bf16 v[96:99], a[248:251], v[108:111], v[96:99]
    s_waitcnt lgkmcnt(0)
    v_add_f32 v36, v36, v40
    v_add_f32 v37, v37, v41
    v_mfma_f32_16x16x32_bf16 v[100:103], a[252:255], v[108:111], v[100:103]
    v_add_f32 v38, v38, v42
    v_add_f32 v39, v39, v43
    s_waitcnt vmcnt(4)
    v_mfma_f32_16x16x32_bf16 v[88:91], v[176:179], v[112:115], v[88:91]
    v_add_f32 v32, v32, v36
    v_add_f32 v33, v33, v37
    v_mfma_f32_16x16x32_bf16 v[92:95], v[180:183], v[112:115], v[92:95]
    v_add_f32 v34, v34, v38
    v_add_f32 v35, v35, v39
    v_mfma_f32_16x16x32_bf16 v[96:99], v[184:187], v[112:115], v[96:99]
    v_cvt_pk_bf16_f32 v32, v32, v33
    v_cvt_pk_bf16_f32 v33, v34, v35
    v_mfma_f32_16x16x32_bf16 v[100:103], v[188:191], v[112:115], v[100:103]
    buffer_store_dwordx2 v[32:33], v72, s[40:43], s74 offen sc1
    s_waitcnt vmcnt(4)
    v_mfma_f32_16x16x32_bf16 v[88:91], v[192:195], v[116:119], v[88:91]
    v_mul_f32 v0, v0, v4
    v_mul_f32 v1, v1, v5
    buffer_load_dword v75, v78, s[40:43], s81 offen sc1
    v_mfma_f32_16x16x32_bf16 v[92:95], v[196:199], v[116:119], v[92:95]
    v_mul_f32 v2, v2, v6
    v_mul_f32 v3, v3, v7
    v_add_u32 v79, 1, v79
    v_mfma_f32_16x16x32_bf16 v[96:99], v[200:203], v[116:119], v[96:99]
    v_mul_f32 v8, v8, v12
    v_mul_f32 v9, v9, v13
    v_mfma_f32_16x16x32_bf16 v[100:103], v[204:207], v[116:119], v[100:103]
    s_waitcnt vmcnt(4)
    v_mul_f32 v10, v10, v14
    v_mul_f32 v11, v11, v15
    v_mfma_f32_16x16x32_bf16 v[88:91], v[208:211], v[120:123], v[88:91]
    v_cvt_pk_bf16_f32 v44, v0, v1
    v_cvt_pk_bf16_f32 v45, v2, v3
    v_mfma_f32_16x16x32_bf16 v[92:95], v[212:215], v[120:123], v[92:95]
    v_cvt_pk_bf16_f32 v46, v8, v9
    v_cvt_pk_bf16_f32 v47, v10, v11
    v_mfma_f32_16x16x32_bf16 v[96:99], v[216:219], v[120:123], v[96:99]
    buffer_store_dwordx4 v[44:47], v69, s[40:43], s72 offen sc1
    v_mfma_f32_16x16x32_bf16 v[100:103], v[220:223], v[120:123], v[100:103]
    ds_read_b128 v[48:51], v64 offset:0
    s_waitcnt vmcnt(4)
    v_mfma_f32_16x16x32_bf16 v[88:91], v[224:227], v[124:127], v[88:91]
    v_mfma_f32_16x16x32_bf16 v[92:95], v[228:231], v[124:127], v[92:95]
    v_mfma_f32_16x16x32_bf16 v[96:99], v[232:235], v[124:127], v[96:99]
    s_add_u32 s74, s74, 28672
    s_add_u32 s72, s92, s89
    v_mfma_f32_16x16x32_bf16 v[100:103], v[236:239], v[124:127], v[100:103]
    ds_read_b128 v[52:55], v64 offset:256
    s_waitcnt vmcnt(3)
    v_mfma_f32_16x16x32_bf16 v[88:91], v[240:243], v[128:131], v[88:91]
    v_mfma_f32_16x16x32_bf16 v[92:95], v[244:247], v[128:131], v[92:95]
    v_mfma_f32_16x16x32_bf16 v[96:99], v[248:251], v[128:131], v[96:99]
    v_mfma_f32_16x16x32_bf16 v[100:103], v[252:255], v[128:131], v[100:103]
    ds_read_b128 v[56:59], v64 offset:512
    s_cmp_lt_u32 s100, 7
    s_cbranch_scc1 L_blk_130
    s_waitcnt lgkmcnt(2)
    v_mfma_f32_16x16x32_bf16 v[0:3], a[0:3], v[48:51], 0
    v_mfma_f32_16x16x32_bf16 v[4:7], a[4:7], v[48:51], 0
    v_mfma_f32_16x16x32_bf16 v[8:11], a[8:11], v[48:51], 0
    v_mfma_f32_16x16x32_bf16 v[12:15], a[12:15], v[48:51], 0
    ds_read_b128 v[60:63], v64 offset:768
    s_waitcnt lgkmcnt(2)
    v_mfma_f32_16x16x32_bf16 v[0:3], a[16:19], v[52:55], v[0:3]
    ds_write_b128 v65, v[92:95] offset:0
    v_mfma_f32_16x16x32_bf16 v[4:7], a[20:23], v[52:55], v[4:7]
    v_mfma_f32_16x16x32_bf16 v[8:11], a[24:27], v[52:55], v[8:11]
    ds_write_b128 v66, v[96:99] offset:4096
    v_mfma_f32_16x16x32_bf16 v[12:15], a[28:31], v[52:55], v[12:15]
    ds_read_b128 v[48:51], v64 offset:1024
    s_waitcnt lgkmcnt(4)
    v_mfma_f32_16x16x32_bf16 v[0:3], a[32:35], v[56:59], v[0:3]
    ds_write_b128 v67, v[100:103] offset:8192
    v_mfma_f32_16x16x32_bf16 v[4:7], a[36:39], v[56:59], v[4:7]
    s_waitcnt vmcnt(1)
    v_subrev_u32 v75, v79, v75
    v_mfma_f32_16x16x32_bf16 v[8:11], a[40:43], v[56:59], v[8:11]
    v_cmp_le_u32 vcc, 64, v75
    v_mfma_f32_16x16x32_bf16 v[12:15], a[44:47], v[56:59], v[12:15]
    ds_read_b128 v[52:55], v64 offset:1280
    s_cbranch_vccz L_bk_107
    s_mov_b32 s71, 0
L_wp_108:
    buffer_load_dword v75, v78, s[40:43], s81 offen sc1
    s_waitcnt vmcnt(0)
    v_subrev_u32 v75, v79, v75
    v_cmp_le_u32 vcc, 64, v75
    s_add_u32 s71, s71, 1
    s_cmp_eq_u64 vcc, 0
    s_cbranch_scc1 L_wpd_109
    s_cmp_lt_u32 s71, 131072
    s_cbranch_scc1 L_wp_108
L_wpd_109:
L_bk_107:
    s_add_u32 m0, s96, 14336
    s_waitcnt lgkmcnt(5)
    v_mfma_f32_16x16x32_bf16 v[0:3], a[48:51], v[60:63], v[0:3]
    buffer_load_dwordx4 v70, s[40:43], s31 offen offset:0 sc1 lds
    v_mfma_f32_16x16x32_bf16 v[4:7], a[52:55], v[60:63], v[4:7]
    v_mfma_f32_16x16x32_bf16 v[8:11], a[56:59], v[60:63], v[8:11]
    v_mfma_f32_16x16x32_bf16 v[12:15], a[60:63], v[60:63], v[12:15]
    ds_read_b128 v[56:59], v64 offset:1536
    s_waitcnt lgkmcnt(3)
    v_mfma_f32_16x16x32_bf16 v[0:3], a[64:67], v[48:51], v[0:3]
    buffer_load_dwordx4 v70, s[40:43], s31 offen offset:1024 sc1 lds
    v_mfma_f32_16x16x32_bf16 v[4:7], a[68:71], v[48:51], v[4:7]
    v_mfma_f32_16x16x32_bf16 v[8:11], a[72:75], v[48:51], v[8:11]
    v_mfma_f32_16x16x32_bf16 v[12:15], a[76:79], v[48:51], v[12:15]
    ds_read_b128 v[60:63], v64 offset:1792
    s_waitcnt lgkmcnt(2)
    v_mfma_f32_16x16x32_bf16 v[0:3], a[80:83], v[52:55], v[0:3]
    buffer_load_dwordx4 v70, s[40:43], s31 offen offset:2048 sc1 lds
    v_mfma_f32_16x16x32_bf16 v[4:7], a[84:87], v[52:55], v[4:7]
    s_waitcnt vmcnt(3)
    buffer_store_dword v73, off, s[40:43], s80 sc1
    v_mfma_f32_16x16x32_bf16 v[8:11], a[88:91], v[52:55], v[8:11]
    v_add_u32 v73, 1, v73
    v_add_u32 v79, 1, v79
    v_mfma_f32_16x16x32_bf16 v[12:15], a[92:95], v[52:55], v[12:15]
    ds_read_b128 v[48:51], v64 offset:2048
    s_waitcnt lgkmcnt(2)
    v_mfma_f32_16x16x32_bf16 v[0:3], a[96:99], v[56:59], v[0:3]
    buffer_load_dwordx4 v70, s[40:43], s31 offen offset:3072 sc1 lds
    v_mfma_f32_16x16x32_bf16 v[4:7], a[100:103], v[56:59], v[4:7]
    v_mfma_f32_16x16x32_bf16 v[8:11], a[104:107], v[56:59], v[8:11]
    buffer_load_dwordx4 v[104:107], v71, s[40:43], s73 offen offset:0 sc1
    v_mfma_f32_16x16x32_bf16 v[12:15], a[108:111], v[56:59], v[12:15]
    ds_read_b128 v[52:55], v64 offset:2304
    s_waitcnt lgkmcnt(2)
    v_mfma_f32_16x16x32_bf16 v[0:3], a[112:115], v[60:63], v[0:3]
    v_mfma_f32_16x16x32_bf16 v[4:7], a[116:119], v[60:63], v[4:7]
    v_mfma_f32_16x16x32_bf16 v[8:11], a[120:123], v[60:63], v[8:11]
    buffer_load_dwordx4 v[108:111], v71, s[40:43], s73 offen offset:1024 sc1
    v_mfma_f32_16x16x32_bf16 v[12:15], a[124:127], v[60:63], v[12:15]
    ds_read_b128 v[56:59], v64 offset:2560
    s_waitcnt lgkmcnt(2)
    v_mfma_f32_16x16x32_bf16 v[0:3], a[128:131], v[48:51], v[0:3]
    v_mfma_f32_16x16x32_bf16 v[4:7], a[132:135], v[48:51], v[4:7]
    v_mfma_f32_16x16x32_bf16 v[8:11], a[136:139], v[48:51], v[8:11]
    buffer_load_dwordx4 v[112:115], v71, s[40:43], s73 offen offset:2048 sc1
    v_mfma_f32_16x16x32_bf16 v[12:15], a[140:143], v[48:51], v[12:15]
    ds_read_b128 v[60:63], v64 offset:2816
    s_waitcnt lgkmcnt(2)
    v_mfma_f32_16x16x32_bf16 v[0:3], a[144:147], v[52:55], v[0:3]
    v_mfma_f32_16x16x32_bf16 v[4:7], a[148:151], v[52:55], v[4:7]
    v_mfma_f32_16x16x32_bf16 v[8:11], a[152:155], v[52:55], v[8:11]
    buffer_load_dwordx4 v[116:119], v71, s[40:43], s73 offen offset:3072 sc1
    v_mfma_f32_16x16x32_bf16 v[12:15], a[156:159], v[52:55], v[12:15]
    ds_read_b128 v[48:51], v64 offset:3072
    s_waitcnt lgkmcnt(2)
    v_mfma_f32_16x16x32_bf16 v[0:3], a[160:163], v[56:59], v[0:3]
    v_mfma_f32_16x16x32_bf16 v[4:7], a[164:167], v[56:59], v[4:7]
    buffer_load_dword v75, v78, s[40:43], s81 offen sc1
    v_mfma_f32_16x16x32_bf16 v[8:11], a[168:171], v[56:59], v[8:11]
    buffer_load_dwordx4 v[120:123], v71, s[40:43], s77 offen offset:0 sc1
    v_mfma_f32_16x16x32_bf16 v[12:15], a[172:175], v[56:59], v[12:15]
    ds_read_b128 v[52:55], v64 offset:3328
    s_waitcnt lgkmcnt(2)
    v_mfma_f32_16x16x32_bf16 v[0:3], a[176:179], v[60:63], v[0:3]
    v_mfma_f32_16x16x32_bf16 v[4:7], a[180:183], v[60:63], v[4:7]
    s_waitcnt vmcnt(6)
    s_barrier
    v_mfma_f32_16x16x32_bf16 v[8:11], a[184:187], v[60:63], v[8:11]
    buffer_load_dwordx4 v[124:127], v71, s[40:43], s77 offen offset:1024 sc1
    v_mfma_f32_16x16x32_bf16 v[12:15], a[188:191], v[60:63], v[12:15]
    ds_read_b128 v[56:59], v64 offset:14336
    s_waitcnt lgkmcnt(2)
    v_mfma_f32_16x16x32_bf16 v[0:3], a[192:195], v[48:51], v[0:3]
    v_mfma_f32_16x16x32_bf16 v[4:7], a[196:199], v[48:51], v[4:7]
    v_mfma_f32_16x16x32_bf16 v[8:11], a[200:203], v[48:51], v[8:11]
    buffer_load_dwordx4 v[128:131], v71, s[40:43], s77 offen offset:2048 sc1
    v_mfma_f32_16x16x32_bf16 v[12:15], a[204:207], v[48:51], v[12:15]
    ds_read_b128 v[60:63], v64 offset:14592
    s_waitcnt lgkmcnt(2)
    v_mfma_f32_16x16x32_bf16 v[0:3], a[208:211], v[52:55], v[0:3]
    ds_read_b128 v[32:35], v68 offset:0
    v_mfma_f32_16x16x32_bf16 v[4:7], a[212:215], v[52:55], v[4:7]
    ds_read_b128 v[36:39], v68 offset:4096
    s_add_u32 s73, s93, 28672
    s_add_u32 s77, s73, 4096
    v_mfma_f32_16x16x32_bf16 v[8:11], a[216:219], v[52:55], v[8:11]
    ds_read_b128 v[40:43], v68 offset:8192
    v_mfma_f32_16x16x32_bf16 v[12:15], a[220:223], v[52:55], v[12:15]
    ds_read_b128 v[48:51], v64 offset:14848
    s_waitcnt lgkmcnt(5)
    v_mfma_f32_16x16x32_bf16 v[160:163], a[0:3], v[56:59], 0
    v_mfma_f32_16x16x32_bf16 v[164:167], a[4:7], v[56:59], 0
    v_mfma_f32_16x16x32_bf16 v[168:171], a[8:11], v[56:59], 0
    v_mfma_f32_16x16x32_bf16 v[172:175], a[12:15], v[56:59], 0
    ds_read_b128 v[52:55], v64 offset:15104
    s_waitcnt lgkmcnt(5)
    v_mfma_f32_16x16x32_bf16 v[160:163], a[16:19], v[60:63], v[160:163]
    v_mul_f32 v0, v0, v4
    v_mul_f32 v1, v1, v5
    v_mfma_f32_16x16x32_bf16 v[164:167], a[20:23], v[60:63], v[164:167]
    v_mul_f32 v2, v2, v6
    v_mul_f32 v3, v3, v7
    v_mfma_f32_16x16x32_bf16 v[168:171], a[24:27], v[60:63], v[168:171]
    v_mul_f32 v8, v8, v12
    v_mul_f32 v9, v9, v13
    v_mfma_f32_16x16x32_bf16 v[172:175], a[28:31], v[60:63], v[172:175]
    ds_read_b128 v[56:59], v64 offset:15360
    v_mul_f32 v10, v10, v14
    v_mul_f32 v11, v11, v15
    s_waitcnt lgkmcnt(2)
    v_mfma_f32_16x16x32_bf16 v[160:163], a[32:35], v[48:51], v[160:163]
    v_cvt_pk_bf16_f32 v44, v0, v1
    v_cvt_pk_bf16_f32 v45, v2, v3
    v_mfma_f32_16x16x32_bf16 v[164:167], a[36:39], v[48:51], v[164:167]
    v_cvt_pk_bf16_f32 v46, v8, v9
    v_cvt_pk_bf16_f32 v47, v10, v11
    v_mfma_f32_16x16x32_bf16 v[168:171], a[40:43], v[48:51], v[168:171]
    buffer_store_dwordx4 v[44:47], v69, s[40:43], s72 offen sc1
    v_mfma_f32_16x16x32_bf16 v[172:175], a[44:47], v[48:51], v[172:175]
    ds_read_b128 v[60:63], v64 offset:15616
    s_waitcnt lgkmcnt(2)
    v_mfma_f32_16x16x32_bf16 v[160:163], a[48:51], v[52:55], v[160:163]
    s_waitcnt vmcnt(4)
    v_subrev_u32 v75, v79, v75
    v_mfma_f32_16x16x32_bf16 v[164:167], a[52:55], v[52:55], v[164:167]
    v_cmp_le_u32 vcc, 64, v75
    v_mfma_f32_16x16x32_bf16 v[168:171], a[56:59], v[52:55], v[168:171]
    s_cbranch_vccz L_bk_111
    s_mov_b32 s71, 0
L_wp_112:
    buffer_load_dword v75, v78, s[40:43], s81 offen sc1
    s_waitcnt vmcnt(0)
    v_subrev_u32 v75, v79, v75
    v_cmp_le_u32 vcc, 64, v75
    s_add_u32 s71, s71, 1
    s_cmp_eq_u64 vcc, 0
    s_cbranch_scc1 L_wpd_113
    s_cmp_lt_u32 s71, 131072
    s_cbranch_scc1 L_wp_112
L_wpd_113:
L_bk_111:
    v_mfma_f32_16x16x32_bf16 v[172:175], a[60:63], v[52:55], v[172:175]
    ds_read_b128 v[48:51], v64 offset:15872
    s_waitcnt lgkmcnt(2)
    v_mfma_f32_16x16x32_bf16 v[160:163], a[64:67], v[56:59], v[160:163]
    v_add_f32 v32, v32, v88
    v_add_f32 v33, v33, v89
    v_mfma_f32_16x16x32_bf16 v[164:167], a[68:71], v[56:59], v[164:167]
    v_add_f32 v34, v34, v90
    v_add_f32 v35, v35, v91
    v_mfma_f32_16x16x32_bf16 v[168:171], a[72:75], v[56:59], v[168:171]
    v_add_f32 v36, v36, v40
    v_add_f32 v37, v37, v41
    v_mfma_f32_16x16x32_bf16 v[172:175], a[76:79], v[56:59], v[172:175]
    ds_read_b128 v[52:55], v64 offset:16128
    v_add_f32 v38, v38, v42
    v_add_f32 v39, v39, v43
    s_waitcnt lgkmcnt(2)
    v_mfma_f32_16x16x32_bf16 v[160:163], a[80:83], v[60:63], v[160:163]
    v_add_f32 v32, v32, v36
    v_add_f32 v33, v33, v37
    v_mfma_f32_16x16x32_bf16 v[164:167], a[84:87], v[60:63], v[164:167]
    v_add_f32 v34, v34, v38
    v_add_f32 v35, v35, v39
    v_mfma_f32_16x16x32_bf16 v[168:171], a[88:91], v[60:63], v[168:171]
    v_cvt_pk_bf16_f32 v32, v32, v33
    v_cvt_pk_bf16_f32 v33, v34, v35
    v_mfma_f32_16x16x32_bf16 v[172:175], a[92:95], v[60:63], v[172:175]
    ds_read_b128 v[56:59], v64 offset:16384
    s_waitcnt lgkmcnt(2)
    v_mfma_f32_16x16x32_bf16 v[160:163], a[96:99], v[48:51], v[160:163]
    buffer_store_dwordx2 v[32:33], v72, s[40:43], s74 offen sc1
    v_add_u32 v79, 1, v79
    v_mfma_f32_16x16x32_bf16 v[164:167], a[100:103], v[48:51], v[164:167]
    buffer_load_dwordx4 v[132:135], v71, s[40:43], s73 offen offset:0 sc1
    v_mfma_f32_16x16x32_bf16 v[168:171], a[104:107], v[48:51], v[168:171]
    s_add_u32 s72, s72, 28672
    s_mov_b32 s74, s94
    v_mfma_f32_16x16x32_bf16 v[172:175], a[108:111], v[48:51], v[172:175]
    ds_read_b128 v[60:63], v64 offset:16640
    s_waitcnt lgkmcnt(2)
    v_mfma_f32_16x16x32_bf16 v[160:163], a[112:115], v[52:55], v[160:163]
    v_mfma_f32_16x16x32_bf16 v[164:167], a[116:119], v[52:55], v[164:167]
    buffer_load_dwordx4 v[136:139], v71, s[40:43], s73 offen offset:1024 sc1
    v_mfma_f32_16x16x32_bf16 v[168:171], a[120:123], v[52:55], v[168:171]
    v_mfma_f32_16x16x32_bf16 v[172:175], a[124:127], v[52:55], v[172:175]
    ds_read_b128 v[48:51], v64 offset:16896
    s_waitcnt lgkmcnt(2)
    v_mfma_f32_16x16x32_bf16 v[160:163], a[128:131], v[56:59], v[160:163]
    v_mfma_f32_16x16x32_bf16 v[164:167], a[132:135], v[56:59], v[164:167]
    buffer_load_dwordx4 v[140:143], v71, s[40:43], s73 offen offset:2048 sc1
    v_mfma_f32_16x16x32_bf16 v[168:171], a[136:139], v[56:59], v[168:171]
    v_mfma_f32_16x16x32_bf16 v[172:175], a[140:143], v[56:59], v[172:175]
    ds_read_b128 v[52:55], v64 offset:17152
    s_waitcnt lgkmcnt(2)
    v_mfma_f32_16x16x32_bf16 v[160:163], a[144:147], v[60:63], v[160:163]
    v_mfma_f32_16x16x32_bf16 v[164:167], a[148:151], v[60:63], v[164:167]
    buffer_load_dwordx4 v[144:147], v71, s[40:43], s73 offen offset:3072 sc1
    v_mfma_f32_16x16x32_bf16 v[168:171], a[152:155], v[60:63], v[168:171]
    v_mfma_f32_16x16x32_bf16 v[172:175], a[156:159], v[60:63], v[172:175]
    ds_read_b128 v[56:59], v64 offset:17408
    s_waitcnt lgkmcnt(2)
    v_mfma_f32_16x16x32_bf16 v[160:163], a[160:163], v[48:51], v[160:163]
    v_mfma_f32_16x16x32_bf16 v[164:167], a[164:167], v[48:51], v[164:167]
    buffer_load_dwordx4 v[148:151], v71, s[40:43], s77 offen offset:0 sc1
    v_mfma_f32_16x16x32_bf16 v[168:171], a[168:171], v[48:51], v[168:171]
    v_mfma_f32_16x16x32_bf16 v[172:175], a[172:175], v[48:51], v[172:175]
    ds_read_b128 v[60:63], v64 offset:17664
    s_waitcnt lgkmcnt(2)
    v_mfma_f32_16x16x32_bf16 v[160:163], a[176:179], v[52:55], v[160:163]
    v_mfma_f32_16x16x32_bf16 v[164:167], a[180:183], v[52:55], v[164:167]
    buffer_load_dwordx4 v[152:155], v71, s[40:43], s77 offen offset:1024 sc1
    v_mfma_f32_16x16x32_bf16 v[168:171], a[184:187], v[52:55], v[168:171]
    s_waitcnt vmcnt(7)
    s_waitcnt vmcnt(6)
    buffer_store_dword v73, off, s[40:43], s80 sc1
    v_mfma_f32_16x16x32_bf16 v[172:175], a[188:191], v[52:55], v[172:175]
    v_add_u32 v73, 1, v73
    s_waitcnt lgkmcnt(1)
    v_mfma_f32_16x16x32_bf16 v[160:163], a[192:195], v[56:59], v[160:163]
    v_mfma_f32_16x16x32_bf16 v[164:167], a[196:199], v[56:59], v[164:167]
    buffer_load_dwordx4 v[156:159], v71, s[40:43], s77 offen offset:2048 sc1
    v_mfma_f32_16x16x32_bf16 v[168:171], a[200:203], v[56:59], v[168:171]
    v_mfma_f32_16x16x32_bf16 v[172:175], a[204:207], v[56:59], v[172:175]
    s_waitcnt lgkmcnt(0)
    v_mfma_f32_16x16x32_bf16 v[160:163], a[208:211], v[60:63], v[160:163]
    s_add_u32 s73, s93, 6291456
    s_add_u32 s77, s73, 4096
    v_mfma_f32_16x16x32_bf16 v[164:167], a[212:215], v[60:63], v[164:167]
    v_mfma_f32_16x16x32_bf16 v[168:171], a[216:219], v[60:63], v[168:171]
    v_mfma_f32_16x16x32_bf16 v[172:175], a[220:223], v[60:63], v[172:175]
    v_mfma_f32_16x16x32_bf16 v[16:19], a[224:227], v[104:107], 0
    s_nop 1
    v_mfma_f32_16x16x32_bf16 v[20:23], a[228:231], v[104:107], 0
    s_nop 1
    v_mfma_f32_16x16x32_bf16 v[24:27], a[232:235], v[104:107], 0
    v_mul_f32 v160, v160, v164
    v_mul_f32 v161, v161, v165
    v_mfma_f32_16x16x32_bf16 v[28:31], a[236:239], v[104:107], 0
    v_mul_f32 v162, v162, v166
    v_mul_f32 v163, v163, v167
    v_mfma_f32_16x16x32_bf16 v[16:19], a[240:243], v[108:111], v[16:19]
    v_mul_f32 v168, v168, v172
    v_mul_f32 v169, v169, v173
    v_mfma_f32_16x16x32_bf16 v[20:23], a[244:247], v[108:111], v[20:23]
    v_mul_f32 v170, v170, v174
    v_mul_f32 v171, v171, v175
    buffer_load_dword v75, v78, s[40:43], s81 offen sc1
    v_mfma_f32_16x16x32_bf16 v[24:27], a[248:251], v[108:111], v[24:27]
    v_cvt_pk_bf16_f32 v44, v160, v161
    v_cvt_pk_bf16_f32 v45, v162, v163
    v_mfma_f32_16x16x32_bf16 v[28:31], a[252:255], v[108:111], v[28:31]
    v_cvt_pk_bf16_f32 v46, v168, v169
    v_cvt_pk_bf16_f32 v47, v170, v171
    v_mfma_f32_16x16x32_bf16 v[16:19], v[176:179], v[112:115], v[16:19]
    buffer_store_dwordx4 v[44:47], v69, s[40:43], s72 offen sc1
    v_mfma_f32_16x16x32_bf16 v[20:23], v[180:183], v[112:115], v[20:23]
    v_mfma_f32_16x16x32_bf16 v[24:27], v[184:187], v[112:115], v[24:27]
    v_mfma_f32_16x16x32_bf16 v[28:31], v[188:191], v[112:115], v[28:31]
    v_mfma_f32_16x16x32_bf16 v[16:19], v[192:195], v[116:119], v[16:19]
    v_mfma_f32_16x16x32_bf16 v[20:23], v[196:199], v[116:119], v[20:23]
    v_mfma_f32_16x16x32_bf16 v[24:27], v[200:203], v[116:119], v[24:27]
    v_mfma_f32_16x16x32_bf16 v[28:31], v[204:207], v[116:119], v[28:31]
    v_mfma_f32_16x16x32_bf16 v[16:19], v[208:211], v[120:123], v[16:19]
    v_mfma_f32_16x16x32_bf16 v[20:23], v[212:215], v[120:123], v[20:23]
    v_mfma_f32_16x16x32_bf16 v[24:27], v[216:219], v[120:123], v[24:27]
    v_mfma_f32_16x16x32_bf16 v[28:31], v[220:223], v[120:123], v[28:31]
    v_mfma_f32_16x16x32_bf16 v[16:19], v[224:227], v[124:127], v[16:19]
    v_mfma_f32_16x16x32_bf16 v[20:23], v[228:231], v[124:127], v[20:23]
    v_mfma_f32_16x16x32_bf16 v[24:27], v[232:235], v[124:127], v[24:27]
    v_mfma_f32_16x16x32_bf16 v[28:31], v[236:239], v[124:127], v[28:31]
    v_mfma_f32_16x16x32_bf16 v[16:19], v[240:243], v[128:131], v[16:19]
    v_mfma_f32_16x16x32_bf16 v[20:23], v[244:247], v[128:131], v[20:23]
    s_waitcnt vmcnt(1)
    v_subrev_u32 v75, v79, v75
    v_mfma_f32_16x16x32_bf16 v[24:27], v[248:251], v[128:131], v[24:27]
    v_cmp_le_u32 vcc, 64, v75
    v_mfma_f32_16x16x32_bf16 v[28:31], v[252:255], v[128:131], v[28:31]
    s_cbranch_vccz L_bk_115
    s_mov_b32 s71, 0
L_wp_116:
    buffer_load_dword v75, v78, s[40:43], s81 offen sc1
    s_waitcnt vmcnt(0)
    v_subrev_u32 v75, v79, v75
    v_cmp_le_u32 vcc, 64, v75
    s_add_u32 s71, s71, 1
    s_cmp_eq_u64 vcc, 0
    s_cbranch_scc1 L_wpd_117
    s_cmp_lt_u32 s71, 131072
    s_cbranch_scc1 L_wp_116
L_wpd_117:
L_bk_115:
    v_mfma_f32_16x16x32_bf16 v[88:91], a[224:227], v[132:135], 0
    buffer_load_dwordx4 v[104:107], v71, s[40:43], s73 offen offset:0 sc1
    v_mfma_f32_16x16x32_bf16 v[92:95], a[228:231], v[132:135], 0
    v_mfma_f32_16x16x32_bf16 v[96:99], a[232:235], v[132:135], 0
    buffer_load_dwordx4 v[108:111], v71, s[40:43], s73 offen offset:1024 sc1
    s_waitcnt vmcnt(2)
    buffer_store_dword v73, off, s[40:43], s80 sc1
    v_mfma_f32_16x16x32_bf16 v[100:103], a[236:239], v[132:135], 0
    v_add_u32 v73, 1, v73
    v_add_u32 v79, 1, v79
    v_mfma_f32_16x16x32_bf16 v[88:91], a[240:243], v[136:139], v[88:91]
    buffer_load_dwordx4 v[112:115], v71, s[40:43], s73 offen offset:2048 sc1
    v_mfma_f32_16x16x32_bf16 v[92:95], a[244:247], v[136:139], v[92:95]
    ds_write_b128 v65, v[20:23] offset:12288
    v_mfma_f32_16x16x32_bf16 v[96:99], a[248:251], v[136:139], v[96:99]
    buffer_load_dwordx4 v[116:119], v71, s[40:43], s73 offen offset:3072 sc1
    v_mfma_f32_16x16x32_bf16 v[100:103], a[252:255], v[136:139], v[100:103]
    ds_write_b128 v66, v[24:27] offset:16384
    v_mfma_f32_16x16x32_bf16 v[88:91], v[176:179], v[140:143], v[88:91]
    buffer_load_dwordx4 v[120:123], v71, s[40:43], s77 offen offset:0 sc1
    v_mfma_f32_16x16x32_bf16 v[92:95], v[180:183], v[140:143], v[92:95]
    ds_write_b128 v67, v[28:31] offset:20480
    v_mfma_f32_16x16x32_bf16 v[96:99], v[184:187], v[140:143], v[96:99]
    buffer_load_dwordx4 v[124:127], v71, s[40:43], s77 offen offset:1024 sc1
    v_mfma_f32_16x16x32_bf16 v[100:103], v[188:191], v[140:143], v[100:103]
    v_mfma_f32_16x16x32_bf16 v[88:91], v[192:195], v[144:147], v[88:91]
    buffer_load_dwordx4 v[128:131], v71, s[40:43], s77 offen offset:2048 sc1
    buffer_load_dword v75, v78, s[40:43], s81 offen sc1
    v_mfma_f32_16x16x32_bf16 v[92:95], v[196:199], v[144:147], v[92:95]
    s_waitcnt lgkmcnt(0)
    s_barrier
    v_mfma_f32_16x16x32_bf16 v[96:99], v[200:203], v[144:147], v[96:99]
    ds_read_b128 v[32:35], v68 offset:12288
    ds_read_b128 v[36:39], v68 offset:16384
    v_mfma_f32_16x16x32_bf16 v[100:103], v[204:207], v[144:147], v[100:103]
    ds_read_b128 v[40:43], v68 offset:20480
    v_mfma_f32_16x16x32_bf16 v[88:91], v[208:211], v[148:151], v[88:91]
    v_mfma_f32_16x16x32_bf16 v[92:95], v[212:215], v[148:151], v[92:95]
    v_mfma_f32_16x16x32_bf16 v[96:99], v[216:219], v[148:151], v[96:99]
    v_mfma_f32_16x16x32_bf16 v[100:103], v[220:223], v[148:151], v[100:103]
    s_waitcnt lgkmcnt(2)
    v_add_f32 v32, v32, v16
    v_add_f32 v33, v33, v17
    v_mfma_f32_16x16x32_bf16 v[88:91], v[224:227], v[152:155], v[88:91]
    v_add_f32 v34, v34, v18
    v_add_f32 v35, v35, v19
    v_mfma_f32_16x16x32_bf16 v[92:95], v[228:231], v[152:155], v[92:95]
    s_waitcnt lgkmcnt(0)
    v_add_f32 v36, v36, v40
    v_add_f32 v37, v37, v41
    v_mfma_f32_16x16x32_bf16 v[96:99], v[232:235], v[152:155], v[96:99]
    v_add_f32 v38, v38, v42
    v_add_f32 v39, v39, v43
    v_mfma_f32_16x16x32_bf16 v[100:103], v[236:239], v[152:155], v[100:103]
    v_add_f32 v32, v32, v36
    v_add_f32 v33, v33, v37
    v_mfma_f32_16x16x32_bf16 v[88:91], v[240:243], v[156:159], v[88:91]
    v_add_f32 v34, v34, v38
    v_add_f32 v35, v35, v39
    v_mfma_f32_16x16x32_bf16 v[92:95], v[244:247], v[156:159], v[92:95]
    v_cvt_pk_bf16_f32 v32, v32, v33
    v_cvt_pk_bf16_f32 v33, v34, v35
    v_mfma_f32_16x16x32_bf16 v[96:99], v[248:251], v[156:159], v[96:99]
    buffer_store_dwordx2 v[32:33], v72, s[40:43], s74 offen sc1
    s_add_u32 s74, s74, 28672
    v_mfma_f32_16x16x32_bf16 v[100:103], v[252:255], v[156:159], v[100:103]
    s_add_u32 s73, s73, 28672
    s_add_u32 s77, s73, 4096
    s_waitcnt vmcnt(9)
    v_mfma_f32_16x16x32_bf16 v[16:19], a[224:227], v[104:107], 0
    v_mfma_f32_16x16x32_bf16 v[20:23], a[228:231], v[104:107], 0
    v_mfma_f32_16x16x32_bf16 v[24:27], a[232:235], v[104:107], 0
    v_mfma_f32_16x16x32_bf16 v[28:31], a[236:239], v[104:107], 0
    s_waitcnt vmcnt(1)
    v_subrev_u32 v75, v79, v75
    v_mfma_f32_16x16x32_bf16 v[16:19], a[240:243], v[108:111], v[16:19]
    v_cmp_le_u32 vcc, 64, v75
    v_mfma_f32_16x16x32_bf16 v[20:23], a[244:247], v[108:111], v[20:23]
    s_cbranch_vccz L_bk_119
    s_mov_b32 s71, 0
L_wp_120:
    buffer_load_dword v75, v78, s[40:43], s81 offen sc1
    s_waitcnt vmcnt(0)
    v_subrev_u32 v75, v79, v75
    v_cmp_le_u32 vcc, 64, v75
    s_add_u32 s71, s71, 1
    s_cmp_eq_u64 vcc, 0
    s_cbranch_scc1 L_wpd_121
    s_cmp_lt_u32 s71, 131072
    s_cbranch_scc1 L_wp_120
L_wpd_121:
L_bk_119:
    buffer_load_dwordx4 v[132:135], v71, s[40:43], s73 offen offset:0 sc1
    ds_write_b128 v65, v[92:95] offset:0
    v_mfma_f32_16x16x32_bf16 v[24:27], a[248:251], v[108:111], v[24:27]
    buffer_load_dwordx4 v[136:139], v71, s[40:43], s73 offen offset:1024 sc1
    v_mfma_f32_16x16x32_bf16 v[28:31], a[252:255], v[108:111], v[28:31]
    buffer_load_dwordx4 v[140:143], v71, s[40:43], s73 offen offset:2048 sc1
    ds_write_b128 v66, v[96:99] offset:4096
    v_mfma_f32_16x16x32_bf16 v[16:19], v[176:179], v[112:115], v[16:19]
    buffer_load_dwordx4 v[144:147], v71, s[40:43], s73 offen offset:3072 sc1
    v_mfma_f32_16x16x32_bf16 v[20:23], v[180:183], v[112:115], v[20:23]
    buffer_load_dwordx4 v[148:151], v71, s[40:43], s77 offen offset:0 sc1
    ds_write_b128 v67, v[100:103] offset:8192
    v_mfma_f32_16x16x32_bf16 v[24:27], v[184:187], v[112:115], v[24:27]
    buffer_load_dwordx4 v[152:155], v71, s[40:43], s77 offen offset:1024 sc1
    v_mfma_f32_16x16x32_bf16 v[28:31], v[188:191], v[112:115], v[28:31]
    buffer_load_dwordx4 v[156:159], v71, s[40:43], s77 offen offset:2048 sc1
    v_mfma_f32_16x16x32_bf16 v[16:19], v[192:195], v[116:119], v[16:19]
    v_mfma_f32_16x16x32_bf16 v[20:23], v[196:199], v[116:119], v[20:23]
    s_waitcnt lgkmcnt(0)
    s_barrier
    v_mfma_f32_16x16x32_bf16 v[24:27], v[200:203], v[116:119], v[24:27]
    ds_read_b128 v[32:35], v68 offset:0
    ds_read_b128 v[36:39], v68 offset:4096
    v_mfma_f32_16x16x32_bf16 v[28:31], v[204:207], v[116:119], v[28:31]
    ds_read_b128 v[40:43], v68 offset:8192
    v_mfma_f32_16x16x32_bf16 v[16:19], v[208:211], v[120:123], v[16:19]
    v_mfma_f32_16x16x32_bf16 v[20:23], v[212:215], v[120:123], v[20:23]
    s_add_u32 s88, s69, 17
    buffer_load_dword v75, v74, s[40:43], s81 offen sc1
    v_mfma_f32_16x16x32_bf16 v[24:27], v[216:219], v[120:123], v[24:27]
    s_waitcnt vmcnt(8)
    buffer_store_dword v73, off, s[40:43], s80 sc1
    v_mfma_f32_16x16x32_bf16 v[28:31], v[220:223], v[120:123], v[28:31]
    s_waitcnt lgkmcnt(2)
    v_add_f32 v32, v32, v88
    v_add_f32 v33, v33, v89
    v_mfma_f32_16x16x32_bf16 v[16:19], v[224:227], v[124:127], v[16:19]
    v_add_f32 v34, v34, v90
    v_add_f32 v35, v35, v91
    v_mfma_f32_16x16x32_bf16 v[20:23], v[228:231], v[124:127], v[20:23]
    s_waitcnt lgkmcnt(0)
    v_add_f32 v36, v36, v40
    v_add_f32 v37, v37, v41
    v_mfma_f32_16x16x32_bf16 v[24:27], v[232:235], v[124:127], v[24:27]
    v_add_f32 v38, v38, v42
    v_add_f32 v39, v39, v43
    v_mfma_f32_16x16x32_bf16 v[28:31], v[236:239], v[124:127], v[28:31]
    v_add_f32 v32, v32, v36
    v_add_f32 v33, v33, v37
    v_mfma_f32_16x16x32_bf16 v[16:19], v[240:243], v[128:131], v[16:19]
    v_add_f32 v34, v34, v38
    v_add_f32 v35, v35, v39
    v_mfma_f32_16x16x32_bf16 v[20:23], v[244:247], v[128:131], v[20:23]
    v_cvt_pk_bf16_f32 v32, v32, v33
    v_cvt_pk_bf16_f32 v33, v34, v35
    v_mfma_f32_16x16x32_bf16 v[24:27], v[248:251], v[128:131], v[24:27]
    buffer_store_dwordx2 v[32:33], v72, s[40:43], s74 offen sc1
    s_add_u32 s74, s74, 28672
    v_mfma_f32_16x16x32_bf16 v[28:31], v[252:255], v[128:131], v[28:31]
    v_add_u32 v73, 1, v73
    s_waitcnt vmcnt(9)
    v_mfma_f32_16x16x32_bf16 v[92:95], a[228:231], v[132:135], 0
    v_mfma_f32_16x16x32_bf16 v[96:99], a[232:235], v[132:135], 0
    v_mfma_f32_16x16x32_bf16 v[100:103], a[236:239], v[132:135], 0
    s_waitcnt vmcnt(8)
    v_mfma_f32_16x16x32_bf16 v[92:95], a[244:247], v[136:139], v[92:95]
    ds_write_b128 v65, v[20:23] offset:12288
    v_mfma_f32_16x16x32_bf16 v[96:99], a[248:251], v[136:139], v[96:99]
    ds_write_b128 v66, v[24:27] offset:16384
    v_mfma_f32_16x16x32_bf16 v[100:103], a[252:255], v[136:139], v[100:103]
    ds_write_b128 v67, v[28:31] offset:20480
    s_waitcnt vmcnt(7)
    v_mfma_f32_16x16x32_bf16 v[92:95], v[180:183], v[140:143], v[92:95]
    s_waitcnt vmcnt(0)
    buffer_store_dword v73, off, s[40:43], s80 sc1
    v_mfma_f32_16x16x32_bf16 v[96:99], v[184:187], v[140:143], v[96:99]
    v_mfma_f32_16x16x32_bf16 v[100:103], v[188:191], v[140:143], v[100:103]
    s_waitcnt lgkmcnt(0)
    s_barrier
    v_mfma_f32_16x16x32_bf16 v[92:95], v[196:199], v[144:147], v[92:95]
    ds_read_b128 v[32:35], v68 offset:12288
    ds_read_b128 v[36:39], v68 offset:16384
    v_mfma_f32_16x16x32_bf16 v[96:99], v[200:203], v[144:147], v[96:99]
    ds_read_b128 v[40:43], v68 offset:20480
    v_mfma_f32_16x16x32_bf16 v[100:103], v[204:207], v[144:147], v[100:103]
    v_subrev_u32 v75, s88, v75
    v_mfma_f32_16x16x32_bf16 v[92:95], v[212:215], v[148:151], v[92:95]
    v_cmp_le_u32 vcc, 64, v75
    v_mfma_f32_16x16x32_bf16 v[96:99], v[216:219], v[148:151], v[96:99]
    s_cbranch_vccnz L_sl_122
L_bk_123:
    buffer_load_dword v75, v74, s[40:43], s81 offen sc1
    s_add_u32 s88, s88, 1
    s_waitcnt lgkmcnt(2)
    v_add_f32 v32, v32, v16
    v_add_f32 v33, v33, v17
    v_mfma_f32_16x16x32_bf16 v[100:103], v[220:223], v[148:151], v[100:103]
    v_add_f32 v34, v34, v18
    v_add_f32 v35, v35, v19
    v_mfma_f32_16x16x32_bf16 v[92:95], v[228:231], v[152:155], v[92:95]
    s_waitcnt lgkmcnt(0)
    v_add_f32 v36, v36, v40
    v_add_f32 v37, v37, v41
    v_mfma_f32_16x16x32_bf16 v[96:99], v[232:235], v[152:155], v[96:99]
    v_add_f32 v38, v38, v42
    v_add_f32 v39, v39, v43
    v_mfma_f32_16x16x32_bf16 v[100:103], v[236:239], v[152:155], v[100:103]
    v_add_f32 v32, v32, v36
    v_add_f32 v33, v33, v37
    v_mfma_f32_16x16x32_bf16 v[92:95], v[244:247], v[156:159], v[92:95]
    v_add_f32 v34, v34, v38
    v_add_f32 v35, v35, v39
    v_mfma_f32_16x16x32_bf16 v[96:99], v[248:251], v[156:159], v[96:99]
    v_cvt_pk_bf16_f32 v32, v32, v33
    v_cvt_pk_bf16_f32 v33, v34, v35
    v_mfma_f32_16x16x32_bf16 v[100:103], v[252:255], v[156:159], v[100:103]
    buffer_store_dwordx2 v[32:33], v72, s[40:43], s74 offen sc1
    s_add_u32 s74, s74, 28672
    v_mfma_f32_16x16x32_bf16 v[88:91], a[224:227], v[132:135], 0
    v_add_u32 v73, 2, v73
    s_nop 0
    v_mfma_f32_16x16x32_bf16 v[88:91], a[240:243], v[136:139], v[88:91]
    s_nop 1
    v_mfma_f32_16x16x32_bf16 v[88:91], v[176:179], v[140:143], v[88:91]
    ds_write_b128 v65, v[92:95] offset:0
    v_mfma_f32_16x16x32_bf16 v[88:91], v[192:195], v[144:147], v[88:91]
    ds_write_b128 v66, v[96:99] offset:4096
    v_mfma_f32_16x16x32_bf16 v[88:91], v[208:211], v[148:151], v[88:91]
    ds_write_b128 v67, v[100:103] offset:8192
    v_mfma_f32_16x16x32_bf16 v[88:91], v[224:227], v[152:155], v[88:91]
    v_mfma_f32_16x16x32_bf16 v[88:91], v[240:243], v[156:159], v[88:91]
    s_waitcnt lgkmcnt(0)
    s_barrier
    ds_read_b128 v[32:35], v68 offset:0
    ds_read_b128 v[36:39], v68 offset:4096
    ds_read_b128 v[40:43], v68 offset:8192
    s_waitcnt vmcnt(1)
    v_subrev_u32 v75, s88, v75
    v_cmp_le_u32 vcc, 64, v75
    s_waitcnt lgkmcnt(0)
    v_add_f32 v36, v36, v40
    v_add_f32 v37, v37, v41
    v_add_f32 v38, v38, v42
    v_add_f32 v39, v39, v43
    s_cbranch_vccz L_bk_127
    s_mov_b32 s71, 0
L_wp_128:
    buffer_load_dword v75, v74, s[40:43], s81 offen sc1
    s_waitcnt vmcnt(0)
    v_subrev_u32 v75, s88, v75
    v_cmp_le_u32 vcc, 64, v75
    s_add_u32 s71, s71, 1
    s_cmp_eq_u64 vcc, 0
    s_cbranch_scc1 L_wpd_129
    s_cmp_lt_u32 s71, 131072
    s_cbranch_scc1 L_wp_128
L_wpd_129:
L_bk_127:
    v_add_f32 v32, v32, v88
    v_add_f32 v33, v33, v89
    v_add_f32 v34, v34, v90
    v_add_f32 v35, v35, v91
    v_add_f32 v32, v32, v36
    v_add_f32 v33, v33, v37
    v_add_f32 v34, v34, v38
    v_add_f32 v35, v35, v39
    v_cvt_pk_bf16_f32 v32, v32, v33
    v_cvt_pk_bf16_f32 v33, v34, v35
    buffer_store_dwordx2 v[32:33], v72, s[40:43], s74 offen sc1
    s_waitcnt vmcnt(0)
    buffer_store_dword v73, off, s[40:43], s80 sc1
    s_branch L_done
L_sl_98:
    s_mov_b32 s71, 0
L_wp_100:
    buffer_load_dword v75, v78, s[40:43], s81 offen sc1
    s_waitcnt vmcnt(0)
    v_subrev_u32 v75, v79, v75
    v_cmp_le_u32 vcc, 64, v75
    s_add_u32 s71, s71, 1
    s_cmp_eq_u64 vcc, 0
    s_cbranch_scc1 L_wpd_101
    s_cmp_lt_u32 s71, 131072
    s_cbranch_scc1 L_wp_100
L_wpd_101:
    s_branch L_bk_99
L_sl_102:
    s_mov_b32 s71, 0
L_wp_104:
    buffer_load_dword v75, v78, s[40:43], s81 offen sc1
    s_waitcnt vmcnt(0)
    v_subrev_u32 v75, v79, v75
    v_cmp_le_u32 vcc, 64, v75
    s_add_u32 s71, s71, 1
    s_cmp_eq_u64 vcc, 0
    s_cbranch_scc1 L_wpd_105
    s_cmp_lt_u32 s71, 131072
    s_cbranch_scc1 L_wp_104
L_wpd_105:
    s_branch L_bk_103
L_sl_122:
    s_mov_b32 s71, 0
L_wp_124:
    buffer_load_dword v75, v74, s[40:43], s81 offen sc1
    s_waitcnt vmcnt(0)
    v_subrev_u32 v75, s88, v75
    v_cmp_le_u32 vcc, 64, v75
    s_add_u32 s71, s71, 1
    s_cmp_eq_u64 vcc, 0
    s_cbranch_scc1 L_wpd_125
    s_cmp_lt_u32 s71, 131072
    s_cbranch_scc1 L_wp_124
L_wpd_125:
    s_branch L_bk_123
L_row:
    s_waitcnt lgkmcnt(0)
    s_mov_b32 s40, s28
    s_and_b32 s41, s29, 0xffff
    s_mov_b32 s42, 16777216
    s_mov_b32 s43, 0x20000
    buffer_load_dword v10, off, s[40:43], 0 sc1
    v_and_b32 v143, 3, v1
    v_lshlrev_b32 v143, 21, v143
    v_add_u32 v143, 0x2e0000, v143
    buffer_load_dword v143, v143, s[40:43], 0 offen
    s_mov_b32 s48, s4
    s_and_b32 s49, s5, 0xffff
    s_mov_b32 s50, 1835008
    s_mov_b32 s51, 0x20000
    v_mov_b32 v9, s70
    s_lshl_b32 s74, s2, 7
    s_add_u32 s74, s74, 4096
    v_and_b32 v56, 31, v1
    v_lshlrev_b32 v56, 10, v56
    s_lshl_b32 s72, s64, 7
    s_add_u32 s72, s72, 4096
    s_waitcnt vmcnt(1)
    v_readfirstlane_b32 s69, v10
    s_nop 0
    s_mul_i32 s69, s69, 1664525
    s_add_u32 s69, s69, 1013904223
    v_mov_b32 v8, s69
    s_barrier
    s_cmp_lg_u32 s68, 0
    s_cbranch_scc1 L_rf_131
    buffer_store_dwordx2 v[8:9], off, s[40:43], s74 sc1
L_rf_131:
    s_sub_u32 s90, s67, 14
    s_lshl1_add_u32 s76, s66, s90
    s_mul_i32 s76, s76, 57344
    s_add_u32 s76, s76, 7340032
    s_add_u32 s77, s76, 28672
    v_min_u32 v60, 223, v0
    v_lshlrev_b32 v60, 7, v60
    buffer_load_dword v141, v60, s[40:43], s76 offen sc1
    buffer_load_dword v141, v60, s[40:43], s77 offen sc1
    s_mov_b32 s71, 0
L_poll_132:
    buffer_load_dwordx2 v[58:59], v56, s[40:43], s72 offen sc1
    s_add_u32 s71, s71, 1
    s_waitcnt vmcnt(0)
    v_cmp_ne_u32 vcc, s69, v58
    s_cmp_ge_u32 s71, 131072
    s_cbranch_scc1 L_polld_133
    s_and_b64 exec, exec, vcc
    s_cbranch_scc1 L_poll_132
L_polld_133:
    s_mov_b64 exec, -1
    v_cmp_ne_u32 vcc, s70, v59
    s_nop 0
    s_cmp_eq_u64 vcc, 0
    s_cselect_b32 s101, 1, 0
    s_mov_b32 s60, s24
    s_and_b32 s61, s25, 0xffff
    s_mov_b32 s62, 1835008
    s_mov_b32 s63, 0x20000
    s_sub_u32 s90, s67, 14
    v_lshrrev_b32 v56, 2, v1
    v_and_b32 v57, 3, v1
    s_lshl_b32 s72, s66, 5
    s_lshl_b32 s73, s90, 4
    s_add_u32 s72, s72, s73
    s_lshl_b32 s74, s68, 2
    s_add_u32 s75, s72, s74
    v_add_u32 v58, s75, v57
    v_mul_u32_u24 v58, 896, v58
    v_lshlrev_b32 v59, 3, v56
    s_lshl_b32 s76, s68, 9
    s_add_u32 s76, s76, s72
    s_mul_i32 s76, s76, 896
    s_mul_i32 s77, s68, 14336
    v_lshlrev_b32 v60, 4, v1
    s_add_u32 m0, s77, 65536
    s_add_u32 s78, s76, 0
    buffer_load_dwordx4 v60, s[48:51], s78 offen offset:0 nt lds
    buffer_load_dwordx4 v60, s[48:51], s78 offen offset:1024 nt lds
    buffer_load_dwordx4 v60, s[48:51], s78 offen offset:2048 nt lds
    buffer_load_dwordx4 v60, s[48:51], s78 offen offset:3072 nt lds
    s_add_u32 m0, s77, 69632
    s_add_u32 s78, s76, 4096
    buffer_load_dwordx4 v60, s[48:51], s78 offen offset:0 nt lds
    buffer_load_dwordx4 v60, s[48:51], s78 offen offset:1024 nt lds
    buffer_load_dwordx4 v60, s[48:51], s78 offen offset:2048 nt lds
    buffer_load_dwordx4 v60, s[48:51], s78 offen offset:3072 nt lds
    s_add_u32 m0, s77, 73728
    s_add_u32 s78, s76, 8192
    buffer_load_dwordx4 v60, s[48:51], s78 offen offset:0 nt lds
    buffer_load_dwordx4 v60, s[48:51], s78 offen offset:1024 nt lds
    buffer_load_dwordx4 v60, s[48:51], s78 offen offset:2048 nt lds
    buffer_load_dwordx4 v60, s[48:51], s78 offen offset:3072 nt lds
    s_add_u32 m0, s77, 77824
    s_add_u32 s78, s76, 12288
    buffer_load_dwordx4 v60, s[48:51], s78 offen offset:0 nt lds
    buffer_load_dwordx4 v60, s[48:51], s78 offen offset:1024 nt lds
    v_add_u32 v61, s74, v57
    v_mul_u32_u24 v61, 896, v61
    v_add_u32 v61, v61, v59
    v_add_u32 v142, 65536, v61
    v_add_u32 v208, 131072, v61
    s_mul_i32 s78, s68, 3584
    v_add_u32 v62, s78, v60
    v_add_u32 v209, 131072, v62
    s_mul_i32 s78, s72, 896
    v_add_u32 v210, s78, v62
    v_cmp_gt_u32 vcc, 32, v1
    v_mov_b32 v62, 0x40000000
    s_nop 0
    v_cndmask_b32 v211, v62, v210, vcc
    v_lshlrev_b32 v58, 4, v0
    v_add_u32 v128, 8192, v58
    v_lshlrev_b32 v58, 3, v0
    v_add_u32 v129, 20480, v58
    v_bfe_u32 v58, v56, 1, 2
    v_xor_b32 v59, s68, v58
    v_lshl_add_u32 v59, v56, 2, v59
    v_lshlrev_b32 v59, 4, v59
    v_lshl_add_u32 v59, v57, 2, v59
    v_add_u32 v131, 65536, v59
    s_lshr_b32 s76, s72, 4
    s_mul_i32 s80, s76, 14336
    s_add_u32 s80, s80, 3145728
    s_mul_i32 s76, s68, 13
    s_add_u32 s76, s76, 3
    s_lshr_b32 s76, s76, 2
    s_lshl_b32 s76, s76, 10
    v_lshl_add_u32 v132, v1, 4, s76
    s_add_u32 s81, s76, 65536
    v_lshlrev_b32 v133, 3, v0
    v_min_u32 v58, 13, v56
    v_lshlrev_b32 v58, 7, v58
    v_lshl_add_u32 v58, v57, 3, v58
    v_mov_b32 v135, v58
    s_mul_i32 s77, s90, 14336
    s_mul_i32 s76, s68, 3584
    s_add_u32 s77, s77, s76
    v_lshl_add_u32 v58, v57, 4, s77
    s_and_b32 s76, s68, 1
    s_lshl_b32 s76, s76, 1
    v_xor_b32 v59, s76, v56
    v_lshl_add_u32 v136, v59, 6, v58
    v_lshrrev_b32 v59, 1, v56
    v_xor_b32 v59, s76, v59
    v_lshl_add_u32 v59, v59, 6, v58
    v_and_b32 v60, 1, v56
    v_lshl_add_u32 v59, v60, 3, v59
    v_add_u32 v137, 3072, v59
    v_min_u32 v58, 55, v1
    s_mul_i32 s77, s68, 56
    v_add_u32 v58, s77, v58
    v_lshlrev_b32 v139, 7, v58
    s_lshl_b32 s77, s66, 11
    s_add_u32 s77, s77, 131072
    buffer_load_dword v141, v135, s[40:43], s77 offen sc1
    s_mov_b32 s77, 65536
    buffer_load_dword v141, v139, s[40:43], s77 offen sc1
    s_waitcnt vmcnt(2)
    s_barrier
    ds_read_b64 v[144:145], v142 offset:0
    ds_read_b64 v[146:147], v142 offset:128
    ds_read_b64 v[148:149], v142 offset:256
    ds_read_b64 v[150:151], v142 offset:384
    ds_read_b64 v[152:153], v142 offset:512
    ds_read_b64 v[154:155], v142 offset:640
    ds_read_b64 v[156:157], v142 offset:768
    ds_read_b64 v[160:161], v142 offset:14336
    ds_read_b64 v[162:163], v142 offset:14464
    ds_read_b64 v[164:165], v142 offset:14592
    ds_read_b64 v[166:167], v142 offset:14720
    ds_read_b64 v[168:169], v142 offset:14848
    ds_read_b64 v[170:171], v142 offset:14976
    ds_read_b64 v[172:173], v142 offset:15104
    s_waitcnt lgkmcnt(0)
    ds_read_b64 v[176:177], v142 offset:28672
    ds_read_b64 v[178:179], v142 offset:28800
    ds_read_b64 v[180:181], v142 offset:28928
    ds_read_b64 v[182:183], v142 offset:29056
    ds_read_b64 v[184:185], v142 offset:29184
    ds_read_b64 v[186:187], v142 offset:29312
    ds_read_b64 v[188:189], v142 offset:29440
    ds_read_b64 v[192:193], v142 offset:43008
    ds_read_b64 v[194:195], v142 offset:43136
    ds_read_b64 v[196:197], v142 offset:43264
    ds_read_b64 v[198:199], v142 offset:43392
    ds_read_b64 v[200:201], v142 offset:43520
    ds_read_b64 v[202:203], v142 offset:43648
    ds_read_b64 v[204:205], v142 offset:43776
    s_waitcnt lgkmcnt(0)
    ds_write_b128 v128, v[144:147] offset:0
    ds_write_b128 v128, v[148:151] offset:4096
    ds_write_b128 v128, v[152:155] offset:8192
    ds_write_b64 v129, v[156:157] offset:0
    ds_write_b128 v128, v[160:163] offset:14336
    ds_write_b128 v128, v[164:167] offset:18432
    ds_write_b128 v128, v[168:171] offset:22528
    ds_write_b64 v129, v[172:173] offset:14336
    s_waitcnt lgkmcnt(0)
    ds_write_b128 v128, v[176:179] offset:28672
    ds_write_b128 v128, v[180:183] offset:32768
    ds_write_b128 v128, v[184:187] offset:36864
    ds_write_b64 v129, v[188:189] offset:28672
    ds_write_b128 v128, v[192:195] offset:43008
    ds_write_b128 v128, v[196:199] offset:47104
    ds_write_b128 v128, v[200:203] offset:51200
    ds_write_b64 v129, v[204:205] offset:43008
    v_and_b32 v57, 3, v1
    v_and_b32 v58, 1, v57
    v_lshlrev_b32 v58, 4, v58
    s_movk_i32 s72, 0x3f80
    v_lshlrev_b32 v58, v58, s72
    v_mov_b32 v59, 0
    v_cmp_gt_u32 vcc, 2, v57
    v_mov_b32 v138, s69
    s_mov_b32 s79, 0x3b124925
    v_cndmask_b32 v2, v59, v58, vcc
    v_cndmask_b32 v3, v58, v59, vcc
    s_mov_b32 s91, 0
    s_mov_b32 s92, 0
    s_mov_b32 s93, 0
    s_mov_b32 s100, 0
    s_mov_b32 s88, 1
    s_lshl_b32 s95, s66, 11
    s_add_u32 s95, s95, 131072
    s_lshl_b32 s72, s90, 4
    s_add_u32 s97, s95, s72
    s_lshl_b32 s72, s68, 2
    s_add_u32 s97, s97, s72
    s_add_u32 s97, s97, 1792
    s_add_u32 s98, s69, s90
    s_waitcnt lgkmcnt(0)
    s_cmp_eq_u32 s101, 0
    s_cbranch_scc1 L_slow_134
.p2align 6
L_rl_135:
    ds_read_b128 v[60:63], v128
    ds_read_b128 v[64:67], v128 offset:4096
    ds_read_b128 v[68:71], v128 offset:8192
    ds_read_b64 v[72:73], v129
    s_lshl_b32 s96, s91, 4
    s_add_u32 s96, s96, s66
    s_mul_i32 s96, s96, 28672
    s_add_u32 s96, s96, 3145728
    v_mov_b32 v140, s98
    s_waitcnt lgkmcnt(0)
    v_mfma_f32_4x4x4_16b_bf16 v[4:7], v[2:3], v[60:61], 0
    v_mfma_f32_4x4x4_16b_bf16 v[8:11], v[2:3], v[62:63], 0
    v_mfma_f32_4x4x4_16b_bf16 v[12:15], v[2:3], v[64:65], 0
    v_mfma_f32_4x4x4_16b_bf16 v[16:19], v[2:3], v[66:67], 0
    v_mfma_f32_4x4x4_16b_bf16 v[20:23], v[2:3], v[68:69], 0
    v_mfma_f32_4x4x4_16b_bf16 v[24:27], v[2:3], v[70:71], 0
    v_mfma_f32_4x4x4_16b_bf16 v[28:31], v[2:3], v[72:73], 0
    s_cmp_eq_u32 s92, 0
    s_cbranch_scc1 L_rnos_136
    s_cmp_ge_u32 s100, 10
    s_cselect_b32 s72, 4, 5
    s_sub_u32 s99, s98, s72
    s_and_b32 s94, s91, 1
    s_lshl_b32 s94, s94, 1
    s_add_u32 s94, s94, s90
    s_lshl_b32 s72, s66, 2
    s_add_u32 s94, s94, s72
    s_mul_i32 s94, s94, 28672
    s_add_u32 s94, s94, 5242880
    s_cmp_eq_u32 s92, 2
    s_cbranch_scc1 L_ny_142
    ds_read_b32 v74, v131 offset:0
    ds_read_b32 v75, v131 offset:1024
    ds_read_b32 v76, v131 offset:2048
    ds_read_b32 v77, v131 offset:3072
    ds_read_b32 v78, v131 offset:4096
    ds_read_b32 v79, v131 offset:5120
    ds_read_b32 v80, v131 offset:6144
    ds_read_b32 v81, v131 offset:7168
    ds_read_b32 v82, v131 offset:8192
    ds_read_b32 v83, v131 offset:9216
    ds_read_b32 v84, v131 offset:10240
    ds_read_b32 v85, v131 offset:11264
    ds_read_b32 v86, v131 offset:12288
    ds_read_b32 v87, v131 offset:13312
L_ny_142:
    s_cmp_eq_u32 s100, 10
    s_cbranch_scc1 L_dp_143
    s_mov_b32 s71, 0
L_wp_145:
    buffer_load_dword v88, v135, s[40:43], s95 offen sc1
    s_waitcnt vmcnt(0)
    v_subrev_u32 v88, s99, v88
    v_cmp_le_u32 vcc, 64, v88
    s_add_u32 s71, s71, 1
    s_cmp_eq_u64 vcc, 0
    s_cbranch_scc1 L_wpd_146
    s_cmp_lt_u32 s71, 131072
    s_cbranch_scc1 L_wp_145
L_wpd_146:
    buffer_load_dwordx2 v[144:145], v133, s[40:43], s94 offen offset:0 sc1
    buffer_load_dwordx2 v[146:147], v133, s[40:43], s94 offen offset:2048 sc1
    s_add_u32 s94, s94, 4096
    buffer_load_dwordx2 v[148:149], v133, s[40:43], s94 offen offset:0 sc1
    buffer_load_dwordx2 v[150:151], v133, s[40:43], s94 offen offset:2048 sc1
    s_add_u32 s94, s94, 4096
    buffer_load_dwordx2 v[152:153], v133, s[40:43], s94 offen offset:0 sc1
    buffer_load_dwordx2 v[154:155], v133, s[40:43], s94 offen offset:2048 sc1
    s_add_u32 s94, s94, 4096
    buffer_load_dwordx2 v[156:157], v133, s[40:43], s94 offen offset:0 sc1
    buffer_load_dwordx2 v[158:159], v133, s[40:43], s94 offen offset:2048 sc1
    s_add_u32 s94, s94, 4096
    buffer_load_dwordx2 v[160:161], v133, s[40:43], s94 offen offset:0 sc1
    buffer_load_dwordx2 v[162:163], v133, s[40:43], s94 offen offset:2048 sc1
    s_add_u32 s94, s94, 4096
    buffer_load_dwordx2 v[164:165], v133, s[40:43], s94 offen offset:0 sc1
    buffer_load_dwordx2 v[166:167], v133, s[40:43], s94 offen offset:2048 sc1
    s_add_u32 s94, s94, 4096
    buffer_load_dwordx2 v[168:169], v133, s[40:43], s94 offen offset:0 sc1
    buffer_load_dwordx2 v[170:171], v133, s[40:43], s94 offen offset:2048 sc1
    s_waitcnt lgkmcnt(0)
    v_mfma_f32_4x4x4_16b_bf16 v[32:35], v[2:3], v[74:75], 0
    v_mfma_f32_4x4x4_16b_bf16 v[36:39], v[2:3], v[76:77], 0
    v_mfma_f32_4x4x4_16b_bf16 v[40:43], v[2:3], v[78:79], 0
    v_mfma_f32_4x4x4_16b_bf16 v[44:47], v[2:3], v[80:81], 0
    v_mfma_f32_4x4x4_16b_bf16 v[48:51], v[2:3], v[82:83], 0
    v_mfma_f32_4x4x4_16b_bf16 v[52:55], v[2:3], v[84:85], 0
    v_mfma_f32_4x4x4_16b_bf16 v[56:59], v[2:3], v[86:87], 0
L_sum_144:
    s_waitcnt vmcnt(13)
    v_mfma_f32_4x4x4_16b_bf16 v[4:7], v[2:3], v[144:145], v[4:7]
    s_waitcnt vmcnt(12)
    v_mfma_f32_4x4x4_16b_bf16 v[8:11], v[2:3], v[146:147], v[8:11]
    s_waitcnt vmcnt(11)
    v_mfma_f32_4x4x4_16b_bf16 v[12:15], v[2:3], v[148:149], v[12:15]
    s_waitcnt vmcnt(10)
    v_mfma_f32_4x4x4_16b_bf16 v[16:19], v[2:3], v[150:151], v[16:19]
    s_waitcnt vmcnt(9)
    v_mfma_f32_4x4x4_16b_bf16 v[20:23], v[2:3], v[152:153], v[20:23]
    s_waitcnt vmcnt(8)
    v_mfma_f32_4x4x4_16b_bf16 v[24:27], v[2:3], v[154:155], v[24:27]
    s_waitcnt vmcnt(7)
    v_mfma_f32_4x4x4_16b_bf16 v[28:31], v[2:3], v[156:157], v[28:31]
    s_waitcnt vmcnt(6)
    v_mfma_f32_4x4x4_16b_bf16 v[4:7], v[2:3], v[158:159], v[4:7]
    s_waitcnt vmcnt(5)
    v_mfma_f32_4x4x4_16b_bf16 v[8:11], v[2:3], v[160:161], v[8:11]
    s_waitcnt vmcnt(4)
    v_mfma_f32_4x4x4_16b_bf16 v[12:15], v[2:3], v[162:163], v[12:15]
    s_waitcnt vmcnt(3)
    v_mfma_f32_4x4x4_16b_bf16 v[16:19], v[2:3], v[164:165], v[16:19]
    s_waitcnt vmcnt(2)
    v_mfma_f32_4x4x4_16b_bf16 v[20:23], v[2:3], v[166:167], v[20:23]
    s_waitcnt vmcnt(1)
    v_mfma_f32_4x4x4_16b_bf16 v[24:27], v[2:3], v[168:169], v[24:27]
    s_waitcnt vmcnt(0)
    v_mfma_f32_4x4x4_16b_bf16 v[28:31], v[2:3], v[170:171], v[28:31]
    s_nop 2
    s_cmp_eq_u32 s92, 2
    s_cbranch_scc1 L_rfin_139
L_rnos_136:
    s_nop 2
    v_pk_add_f32 v[116:117], v[4:5], v[6:7]
    v_pk_mul_f32 v[118:119], v[4:5], v[4:5]
    v_pk_fma_f32 v[118:119], v[6:7], v[6:7], v[118:119]
    v_pk_add_f32 v[116:117], v[116:117], v[8:9]
    v_pk_fma_f32 v[118:119], v[8:9], v[8:9], v[118:119]
    v_pk_add_f32 v[116:117], v[116:117], v[10:11]
    v_pk_fma_f32 v[118:119], v[10:11], v[10:11], v[118:119]
    v_pk_add_f32 v[116:117], v[116:117], v[12:13]
    v_pk_fma_f32 v[118:119], v[12:13], v[12:13], v[118:119]
    v_pk_add_f32 v[116:117], v[116:117], v[14:15]
    v_pk_fma_f32 v[118:119], v[14:15], v[14:15], v[118:119]
    v_pk_add_f32 v[116:117], v[116:117], v[16:17]
    v_pk_fma_f32 v[118:119], v[16:17], v[16:17], v[118:119]
    v_pk_add_f32 v[116:117], v[116:117], v[18:19]
    v_pk_fma_f32 v[118:119], v[18:19], v[18:19], v[118:119]
    v_pk_add_f32 v[116:117], v[116:117], v[20:21]
    v_pk_fma_f32 v[118:119], v[20:21], v[20:21], v[118:119]
    v_pk_add_f32 v[116:117], v[116:117], v[22:23]
    v_pk_fma_f32 v[118:119], v[22:23], v[22:23], v[118:119]
    v_pk_add_f32 v[116:117], v[116:117], v[24:25]
    v_pk_fma_f32 v[118:119], v[24:25], v[24:25], v[118:119]
    v_pk_add_f32 v[116:117], v[116:117], v[26:27]
    v_pk_fma_f32 v[118:119], v[26:27], v[26:27], v[118:119]
    v_pk_add_f32 v[116:117], v[116:117], v[28:29]
    v_pk_fma_f32 v[118:119], v[28:29], v[28:29], v[118:119]
    v_pk_add_f32 v[116:117], v[116:117], v[30:31]
    v_pk_fma_f32 v[118:119], v[30:31], v[30:31], v[118:119]
    v_add_f32 v116, v116, v117
    v_add_f32 v118, v118, v119
    s_nop 0
    v_add_f32_dpp v116, v116, v116 row_ror:4 row_mask:0xf bank_mask:0xf
    v_add_f32_dpp v118, v118, v118 row_ror:4 row_mask:0xf bank_mask:0xf
    s_nop 0
    v_add_f32_dpp v116, v116, v116 row_ror:8 row_mask:0xf bank_mask:0xf
    v_add_f32_dpp v118, v118, v118 row_ror:8 row_mask:0xf bank_mask:0xf
    s_nop 0
    v_mov_b32 v117, v116
    v_mov_b32 v119, v118
    s_nop 0
    v_permlane16_swap_b32 v116, v117
    v_permlane16_swap_b32 v118, v119
    v_add_f32 v116, v116, v117
    v_add_f32 v118, v118, v119
    v_mov_b32 v117, v116
    v_mov_b32 v119, v118
    s_nop 0
    v_permlane32_swap_b32 v116, v117
    v_permlane32_swap_b32 v118, v119
    v_add_f32 v116, v116, v117
    v_add_f32 v118, v118, v119
    v_mul_f32 v116, s79, v116
    v_mul_f32 v118, s79, v118
    v_fma_f32 v118, -v116, v116, v118
    v_max_f32 v118, 0, v118
    v_add_f32 v118, 0x3727c5ac, v118
    v_rsq_f32 v122, v118
    s_nop 0
    v_mul_f32 v123, v116, v122
    v_sub_f32 v123, 0, v123
    v_pk_fma_f32 v[88:89], v[4:5], v[122:123], v[122:123] op_sel:[0,0,1] op_sel_hi:[1,0,1]
    v_pk_fma_f32 v[90:91], v[6:7], v[122:123], v[122:123] op_sel:[0,0,1] op_sel_hi:[1,0,1]
    v_pk_fma_f32 v[92:93], v[8:9], v[122:123], v[122:123] op_sel:[0,0,1] op_sel_hi:[1,0,1]
    v_pk_fma_f32 v[94:95], v[10:11], v[122:123], v[122:123] op_sel:[0,0,1] op_sel_hi:[1,0,1]
    v_pk_fma_f32 v[96:97], v[12:13], v[122:123], v[122:123] op_sel:[0,0,1] op_sel_hi:[1,0,1]
    v_pk_fma_f32 v[98:99], v[14:15], v[122:123], v[122:123] op_sel:[0,0,1] op_sel_hi:[1,0,1]
    v_pk_fma_f32 v[100:101], v[16:17], v[122:123], v[122:123] op_sel:[0,0,1] op_sel_hi:[1,0,1]
    v_pk_fma_f32 v[102:103], v[18:19], v[122:123], v[122:123] op_sel:[0,0,1] op_sel_hi:[1,0,1]
    v_pk_fma_f32 v[104:105], v[20:21], v[122:123], v[122:123] op_sel:[0,0,1] op_sel_hi:[1,0,1]
    v_pk_fma_f32 v[106:107], v[22:23], v[122:123], v[122:123] op_sel:[0,0,1] op_sel_hi:[1,0,1]
    v_pk_fma_f32 v[108:109], v[24:25], v[122:123], v[122:123] op_sel:[0,0,1] op_sel_hi:[1,0,1]
    v_pk_fma_f32 v[110:111], v[26:27], v[122:123], v[122:123] op_sel:[0,0,1] op_sel_hi:[1,0,1]
    v_pk_fma_f32 v[112:113], v[28:29], v[122:123], v[122:123] op_sel:[0,0,1] op_sel_hi:[1,0,1]
    v_pk_fma_f32 v[114:115], v[30:31], v[122:123], v[122:123] op_sel:[0,0,1] op_sel_hi:[1,0,1]
    s_cmp_lg_u32 s92, 0
    s_cbranch_scc1 L_rnoy_138
    s_cmp_lg_u32 s91, 0
    s_cbranch_scc1 L_rny2_148
    s_mov_b32 s72, 65536
    s_mov_b32 s71, 0
L_poll_150:
    buffer_load_dword v142, v139, s[40:43], s72 offen sc1
    s_add_u32 s71, s71, 1
    s_waitcnt vmcnt(0)
    v_cmp_ne_u32 vcc, s69, v142
    s_cmp_ge_u32 s71, 131072
    s_cbranch_scc1 L_polld_151
    s_and_b64 exec, exec, vcc
    s_cbranch_scc1 L_poll_150
L_polld_151:
    s_mov_b64 exec, -1
    s_barrier
    s_mov_b32 m0, s81
    s_add_u32 s81, s81, 14336
    buffer_load_dwordx4 v132, s[40:43], s80 offen offset:0 sc1 lds
    buffer_load_dwordx4 v132, s[40:43], s80 offen offset:1024 sc1 lds
    buffer_load_dwordx4 v132, s[40:43], s80 offen offset:2048 sc1 lds
    buffer_load_dwordx4 v132, s[40:43], s80 offen offset:3072 sc1 lds
    s_add_u32 s80, s80, 458752
    s_mov_b32 m0, s81
    s_add_u32 s81, s81, 14336
    buffer_load_dwordx4 v132, s[40:43], s80 offen offset:0 sc1 lds
    buffer_load_dwordx4 v132, s[40:43], s80 offen offset:1024 sc1 lds
    buffer_load_dwordx4 v132, s[40:43], s80 offen offset:2048 sc1 lds
    buffer_load_dwordx4 v132, s[40:43], s80 offen offset:3072 sc1 lds
    s_add_u32 s80, s80, 458752
    s_or_b32 s72, s66, s90
    s_or_b32 s72, s72, s68
    s_cmp_lg_u32 s72, 0
    s_waitcnt vmcnt(4)
    s_cbranch_scc1 L_rny1_147
    buffer_store_dword v138, off, s[40:43], 0 sc1
    s_branch L_rny1_147
L_rny2_148:
    s_cmp_lg_u32 s91, 1
    s_cbranch_scc1 L_rny3_149
    s_mov_b32 s72, 65540
    buffer_load_dword v142, v139, s[40:43], s72 offen sc1
    s_branch L_rny1_147
L_rny3_149:
    s_waitcnt vmcnt(4)
L_rny1_147:
    s_barrier
    ds_read_b32 v74, v131 offset:0
    ds_read_b32 v75, v131 offset:1024
    ds_read_b32 v76, v131 offset:2048
    ds_read_b32 v77, v131 offset:3072
    ds_read_b32 v78, v131 offset:4096
    ds_read_b32 v79, v131 offset:5120
    ds_read_b32 v80, v131 offset:6144
    ds_read_b32 v81, v131 offset:7168
    ds_read_b32 v82, v131 offset:8192
    ds_read_b32 v83, v131 offset:9216
    ds_read_b32 v84, v131 offset:10240
    ds_read_b32 v85, v131 offset:11264
    ds_read_b32 v86, v131 offset:12288
    ds_read_b32 v87, v131 offset:13312
    s_waitcnt lgkmcnt(0)
    v_mfma_f32_4x4x4_16b_bf16 v[32:35], v[2:3], v[74:75], 0
    v_mfma_f32_4x4x4_16b_bf16 v[36:39], v[2:3], v[76:77], 0
    v_mfma_f32_4x4x4_16b_bf16 v[40:43], v[2:3], v[78:79], 0
    v_mfma_f32_4x4x4_16b_bf16 v[44:47], v[2:3], v[80:81], 0
    v_mfma_f32_4x4x4_16b_bf16 v[48:51], v[2:3], v[82:83], 0
    v_mfma_f32_4x4x4_16b_bf16 v[52:55], v[2:3], v[84:85], 0
    v_mfma_f32_4x4x4_16b_bf16 v[56:59], v[2:3], v[86:87], 0
L_rnoy_138:
    s_nop 3
    v_pk_fma_f32 v[4:5], v[88:89], v[32:33], v[4:5]
    v_pk_fma_f32 v[6:7], v[90:91], v[34:35], v[6:7]
    v_pk_fma_f32 v[8:9], v[92:93], v[36:37], v[8:9]
    v_pk_fma_f32 v[10:11], v[94:95], v[38:39], v[10:11]
    v_pk_fma_f32 v[12:13], v[96:97], v[40:41], v[12:13]
    v_pk_fma_f32 v[14:15], v[98:99], v[42:43], v[14:15]
    v_pk_fma_f32 v[16:17], v[100:101], v[44:45], v[16:17]
    v_pk_fma_f32 v[18:19], v[102:103], v[46:47], v[18:19]
    v_pk_fma_f32 v[20:21], v[104:105], v[48:49], v[20:21]
    v_pk_fma_f32 v[22:23], v[106:107], v[50:51], v[22:23]
    v_pk_fma_f32 v[24:25], v[108:109], v[52:53], v[24:25]
    v_pk_fma_f32 v[26:27], v[110:111], v[54:55], v[26:27]
    v_pk_fma_f32 v[28:29], v[112:113], v[56:57], v[28:29]
    v_pk_fma_f32 v[30:31], v[114:115], v[58:59], v[30:31]
    v_pk_add_f32 v[116:117], v[4:5], v[6:7]
    v_pk_mul_f32 v[118:119], v[4:5], v[4:5]
    v_pk_fma_f32 v[118:119], v[6:7], v[6:7], v[118:119]
    v_pk_add_f32 v[116:117], v[116:117], v[8:9]
    v_pk_fma_f32 v[118:119], v[8:9], v[8:9], v[118:119]
    v_pk_add_f32 v[116:117], v[116:117], v[10:11]
    v_pk_fma_f32 v[118:119], v[10:11], v[10:11], v[118:119]
    v_pk_add_f32 v[116:117], v[116:117], v[12:13]
    v_pk_fma_f32 v[118:119], v[12:13], v[12:13], v[118:119]
    v_pk_add_f32 v[116:117], v[116:117], v[14:15]
    v_pk_fma_f32 v[118:119], v[14:15], v[14:15], v[118:119]
    v_pk_add_f32 v[116:117], v[116:117], v[16:17]
    v_pk_fma_f32 v[118:119], v[16:17], v[16:17], v[118:119]
    v_pk_add_f32 v[116:117], v[116:117], v[18:19]
    v_pk_fma_f32 v[118:119], v[18:19], v[18:19], v[118:119]
    v_pk_add_f32 v[116:117], v[116:117], v[20:21]
    v_pk_fma_f32 v[118:119], v[20:21], v[20:21], v[118:119]
    v_pk_add_f32 v[116:117], v[116:117], v[22:23]
    v_pk_fma_f32 v[118:119], v[22:23], v[22:23], v[118:119]
    v_pk_add_f32 v[116:117], v[116:117], v[24:25]
    v_pk_fma_f32 v[118:119], v[24:25], v[24:25], v[118:119]
    v_pk_add_f32 v[116:117], v[116:117], v[26:27]
    v_pk_fma_f32 v[118:119], v[26:27], v[26:27], v[118:119]
    v_pk_add_f32 v[116:117], v[116:117], v[28:29]
    v_pk_fma_f32 v[118:119], v[28:29], v[28:29], v[118:119]
    v_pk_add_f32 v[116:117], v[116:117], v[30:31]
    v_pk_fma_f32 v[118:119], v[30:31], v[30:31], v[118:119]
    v_add_f32 v116, v116, v117
    v_add_f32 v118, v118, v119
    s_nop 0
    v_add_f32_dpp v116, v116, v116 row_ror:4 row_mask:0xf bank_mask:0xf
    v_add_f32_dpp v118, v118, v118 row_ror:4 row_mask:0xf bank_mask:0xf
    s_nop 0
    v_add_f32_dpp v116, v116, v116 row_ror:8 row_mask:0xf bank_mask:0xf
    v_add_f32_dpp v118, v118, v118 row_ror:8 row_mask:0xf bank_mask:0xf
    s_nop 0
    v_mov_b32 v117, v116
    v_mov_b32 v119, v118
    s_nop 0
    v_permlane16_swap_b32 v116, v117
    v_permlane16_swap_b32 v118, v119
    v_add_f32 v116, v116, v117
    v_add_f32 v118, v118, v119
    v_mov_b32 v117, v116
    v_mov_b32 v119, v118
    s_nop 0
    v_permlane32_swap_b32 v116, v117
    v_permlane32_swap_b32 v118, v119
    v_add_f32 v116, v116, v117
    v_add_f32 v118, v118, v119
    v_mul_f32 v116, s79, v116
    v_mul_f32 v118, s79, v118
    v_fma_f32 v118, -v116, v116, v118
    v_max_f32 v118, 0, v118
    v_add_f32 v118, 0x3727c5ac, v118
    v_rsq_f32 v122, v118
    s_nop 0
    v_mul_f32 v123, v116, v122
    v_sub_f32 v123, 0, v123
    v_pk_fma_f32 v[88:89], v[4:5], v[122:123], v[122:123] op_sel:[0,0,1] op_sel_hi:[1,0,1]
    v_pk_fma_f32 v[90:91], v[6:7], v[122:123], v[122:123] op_sel:[0,0,1] op_sel_hi:[1,0,1]
    v_pk_fma_f32 v[92:93], v[8:9], v[122:123], v[122:123] op_sel:[0,0,1] op_sel_hi:[1,0,1]
    v_pk_fma_f32 v[94:95], v[10:11], v[122:123], v[122:123] op_sel:[0,0,1] op_sel_hi:[1,0,1]
    v_pk_fma_f32 v[96:97], v[12:13], v[122:123], v[122:123] op_sel:[0,0,1] op_sel_hi:[1,0,1]
    v_pk_fma_f32 v[98:99], v[14:15], v[122:123], v[122:123] op_sel:[0,0,1] op_sel_hi:[1,0,1]
    v_pk_fma_f32 v[100:101], v[16:17], v[122:123], v[122:123] op_sel:[0,0,1] op_sel_hi:[1,0,1]
    v_pk_fma_f32 v[102:103], v[18:19], v[122:123], v[122:123] op_sel:[0,0,1] op_sel_hi:[1,0,1]
    v_pk_fma_f32 v[104:105], v[20:21], v[122:123], v[122:123] op_sel:[0,0,1] op_sel_hi:[1,0,1]
    v_pk_fma_f32 v[106:107], v[22:23], v[122:123], v[122:123] op_sel:[0,0,1] op_sel_hi:[1,0,1]
    v_pk_fma_f32 v[108:109], v[24:25], v[122:123], v[122:123] op_sel:[0,0,1] op_sel_hi:[1,0,1]
    v_pk_fma_f32 v[110:111], v[26:27], v[122:123], v[122:123] op_sel:[0,0,1] op_sel_hi:[1,0,1]
    v_pk_fma_f32 v[112:113], v[28:29], v[122:123], v[122:123] op_sel:[0,0,1] op_sel_hi:[1,0,1]
    v_pk_fma_f32 v[114:115], v[30:31], v[122:123], v[122:123] op_sel:[0,0,1] op_sel_hi:[1,0,1]
    v_cvt_pk_bf16_f32 v32, v88, v89
    v_cvt_pk_bf16_f32 v33, v90, v91
    v_cvt_pk_bf16_f32 v34, v92, v93
    v_cvt_pk_bf16_f32 v35, v94, v95
    buffer_store_dwordx4 v[32:35], v136, s[40:43], s96 offen offset:0
    v_cvt_pk_bf16_f32 v36, v96, v97
    v_cvt_pk_bf16_f32 v37, v98, v99
    v_cvt_pk_bf16_f32 v38, v100, v101
    v_cvt_pk_bf16_f32 v39, v102, v103
    buffer_store_dwordx4 v[36:39], v136, s[40:43], s96 offen offset:1024
    v_cvt_pk_bf16_f32 v40, v104, v105
    v_cvt_pk_bf16_f32 v41, v106, v107
    v_cvt_pk_bf16_f32 v42, v108, v109
    v_cvt_pk_bf16_f32 v43, v110, v111
    buffer_store_dwordx4 v[40:43], v136, s[40:43], s96 offen offset:2048
    v_cvt_pk_bf16_f32 v44, v112, v113
    v_cvt_pk_bf16_f32 v45, v114, v115
    buffer_store_dwordx2 v[44:45], v137, s[40:43], s96 offen
    v_cvt_pk_bf16_f32 v60, v4, v5
    v_cvt_pk_bf16_f32 v61, v6, v7
    v_cvt_pk_bf16_f32 v62, v8, v9
    v_cvt_pk_bf16_f32 v63, v10, v11
    v_cvt_pk_bf16_f32 v64, v12, v13
    v_cvt_pk_bf16_f32 v65, v14, v15
    v_cvt_pk_bf16_f32 v66, v16, v17
    v_cvt_pk_bf16_f32 v67, v18, v19
    v_cvt_pk_bf16_f32 v68, v20, v21
    v_cvt_pk_bf16_f32 v69, v22, v23
    v_cvt_pk_bf16_f32 v70, v24, v25
    v_cvt_pk_bf16_f32 v71, v26, v27
    v_cvt_pk_bf16_f32 v72, v28, v29
    v_cvt_pk_bf16_f32 v73, v30, v31
    s_waitcnt vmcnt(0)
    buffer_store_dword v140, off, s[40:43], s97
    ds_write_b128 v128, v[60:63]
    ds_write_b128 v128, v[64:67] offset:4096
    ds_write_b128 v128, v[68:71] offset:8192
    ds_write_b64 v129, v[72:73]
    s_cmp_lg_u32 s100, 1
    s_cbranch_scc1 L_rnx_140
    v_cmp_ne_u32 vcc, s69, v142
    s_mov_b32 s72, 65540
    s_nop 0
    s_cbranch_vccz L_y2ok_141
    s_mov_b32 s71, 0
L_poll_152:
    buffer_load_dword v142, v139, s[40:43], s72 offen sc1
    s_add_u32 s71, s71, 1
    s_waitcnt vmcnt(0)
    v_cmp_ne_u32 vcc, s69, v142
    s_cmp_ge_u32 s71, 131072
    s_cbranch_scc1 L_polld_153
    s_and_b64 exec, exec, vcc
    s_cbranch_scc1 L_poll_152
L_polld_153:
    s_mov_b64 exec, -1
L_y2ok_141:
    s_barrier
    s_mov_b32 m0, s81
    s_add_u32 s81, s81, 14336
    buffer_load_dwordx4 v132, s[40:43], s80 offen offset:0 sc1 lds
    buffer_load_dwordx4 v132, s[40:43], s80 offen offset:1024 sc1 lds
    buffer_load_dwordx4 v132, s[40:43], s80 offen offset:2048 sc1 lds
    buffer_load_dwordx4 v132, s[40:43], s80 offen offset:3072 sc1 lds
    s_add_u32 s80, s80, 458752
    s_mov_b32 m0, s81
    s_add_u32 s81, s81, 14336
    buffer_load_dwordx4 v132, s[40:43], s80 offen offset:0 sc1 lds
    buffer_load_dwordx4 v132, s[40:43], s80 offen offset:1024 sc1 lds
    buffer_load_dwordx4 v132, s[40:43], s80 offen offset:2048 sc1 lds
    buffer_load_dwordx4 v132, s[40:43], s80 offen offset:3072 sc1 lds
    s_add_u32 s80, s80, 458752
    s_branch L_rnx_140
L_rfin_139:
    buffer_store_dword v140, off, s[40:43], s97
    v_cvt_pk_bf16_f32 v60, v4, v5
    v_cvt_pk_bf16_f32 v61, v6, v7
    ds_write_b64 v208, v[60:61] offset:0
    v_cvt_pk_bf16_f32 v62, v8, v9
    v_cvt_pk_bf16_f32 v63, v10, v11
    ds_write_b64 v208, v[62:63] offset:128
    v_cvt_pk_bf16_f32 v64, v12, v13
    v_cvt_pk_bf16_f32 v65, v14, v15
    ds_write_b64 v208, v[64:65] offset:256
    v_cvt_pk_bf16_f32 v66, v16, v17
    v_cvt_pk_bf16_f32 v67, v18, v19
    ds_write_b64 v208, v[66:67] offset:384
    v_cvt_pk_bf16_f32 v68, v20, v21
    v_cvt_pk_bf16_f32 v69, v22, v23
    ds_write_b64 v208, v[68:69] offset:512
    v_cvt_pk_bf16_f32 v70, v24, v25
    v_cvt_pk_bf16_f32 v71, v26, v27
    ds_write_b64 v208, v[70:71] offset:640
    v_cvt_pk_bf16_f32 v72, v28, v29
    v_cvt_pk_bf16_f32 v73, v30, v31
    ds_write_b64 v208, v[72:73] offset:768
    s_waitcnt lgkmcnt(0)
    ds_read_b128 v[176:179], v209 offset:0
    ds_read_b128 v[180:183], v209 offset:1024
    ds_read_b128 v[184:187], v209 offset:2048
    ds_read_b128 v[188:191], v209 offset:3072
    s_waitcnt lgkmcnt(3)
    buffer_store_dwordx4 v[176:179], v210, s[60:63], s93 offen offset:0 nt
    s_waitcnt lgkmcnt(2)
    buffer_store_dwordx4 v[180:183], v210, s[60:63], s93 offen offset:1024 nt
    s_waitcnt lgkmcnt(1)
    buffer_store_dwordx4 v[184:187], v210, s[60:63], s93 offen offset:2048 nt
    s_waitcnt lgkmcnt(0)
    buffer_store_dwordx4 v[188:191], v211, s[60:63], s93 offen offset:3072 nt
    s_add_u32 s93, s93, 458752
L_rnx_140:
    s_cmp_lg_u32 s100, 2
    s_cbranch_scc1 L_npt_154
    s_lshl_b32 s72, s66, 2
    s_add_u32 s72, s72, s90
    s_mul_i32 s72, s72, 28672
    s_add_u32 s72, s72, 5242880
    v_lshlrev_b32 v88, 4, v133
    v_min_u32 v88, 28544, v88
    buffer_load_dword v141, v88, s[40:43], s72 offen sc1
L_npt_154:
    s_cmp_lg_u32 s100, 3
    s_cbranch_scc1 L_npt_155
    s_lshl_b32 s72, s66, 2
    s_add_u32 s72, s72, s90
    s_mul_i32 s72, s72, 28672
    s_add_u32 s72, s72, 5300224
    v_lshlrev_b32 v88, 4, v133
    v_min_u32 v88, 28544, v88
    buffer_load_dword v141, v88, s[40:43], s72 offen sc1
L_npt_155:
    s_add_u32 s91, s91, 1
    s_cmp_eq_u32 s91, 4
    s_movk_i32 s72, 14336
    s_cselect_b32 s72, 4294924288, s72
    s_cselect_b32 s73, 1, 0
    s_cselect_b32 s91, 0, s91
    s_add_u32 s92, s92, s73
    s_waitcnt lgkmcnt(0)
    v_add_u32 v128, s72, v128
    v_add_u32 v129, s72, v129
    v_add_u32 v131, s72, v131
    s_add_u32 s98, s98, 2
    s_add_u32 s100, s100, 1
    s_cmp_lt_u32 s100, 12
    s_cbranch_scc1 L_rl_135
    s_branch L_done
L_dp_143:
    ds_read_b128 v[60:63], v128 offset:14336
    ds_read_b128 v[64:67], v128 offset:18432
    ds_read_b128 v[68:71], v128 offset:22528
    ds_read_b64 v[72:73], v129 offset:14336
    s_add_u32 s73, s94, 57344
    s_waitcnt lgkmcnt(0)
    v_mfma_f32_4x4x4_16b_bf16 v[32:35], v[2:3], v[60:61], 0
    v_mfma_f32_4x4x4_16b_bf16 v[36:39], v[2:3], v[62:63], 0
    v_mfma_f32_4x4x4_16b_bf16 v[40:43], v[2:3], v[64:65], 0
    v_mfma_f32_4x4x4_16b_bf16 v[44:47], v[2:3], v[66:67], 0
    v_mfma_f32_4x4x4_16b_bf16 v[48:51], v[2:3], v[68:69], 0
    v_mfma_f32_4x4x4_16b_bf16 v[52:55], v[2:3], v[70:71], 0
    v_mfma_f32_4x4x4_16b_bf16 v[56:59], v[2:3], v[72:73], 0
    s_mov_b32 s71, 0
L_wp_157:
    buffer_load_dword v88, v135, s[40:43], s95 offen sc1
    s_waitcnt vmcnt(0)
    v_subrev_u32 v88, s99, v88
    v_cmp_le_u32 vcc, 64, v88
    s_add_u32 s71, s71, 1
    s_cmp_eq_u64 vcc, 0
    s_cbranch_scc1 L_wpd_158
    s_cmp_lt_u32 s71, 131072
    s_cbranch_scc1 L_wp_157
L_wpd_158:
    buffer_load_dwordx2 v[144:145], v133, s[40:43], s94 offen offset:0 sc1
    buffer_load_dwordx2 v[146:147], v133, s[40:43], s94 offen offset:2048 sc1
    s_add_u32 s94, s94, 4096
    buffer_load_dwordx2 v[148:149], v133, s[40:43], s94 offen offset:0 sc1
    buffer_load_dwordx2 v[150:151], v133, s[40:43], s94 offen offset:2048 sc1
    s_add_u32 s94, s94, 4096
    buffer_load_dwordx2 v[152:153], v133, s[40:43], s94 offen offset:0 sc1
    buffer_load_dwordx2 v[154:155], v133, s[40:43], s94 offen offset:2048 sc1
    s_add_u32 s94, s94, 4096
    buffer_load_dwordx2 v[156:157], v133, s[40:43], s94 offen offset:0 sc1
    buffer_load_dwordx2 v[158:159], v133, s[40:43], s94 offen offset:2048 sc1
    s_add_u32 s94, s94, 4096
    buffer_load_dwordx2 v[160:161], v133, s[40:43], s94 offen offset:0 sc1
    buffer_load_dwordx2 v[162:163], v133, s[40:43], s94 offen offset:2048 sc1
    s_add_u32 s94, s94, 4096
    buffer_load_dwordx2 v[164:165], v133, s[40:43], s94 offen offset:0 sc1
    buffer_load_dwordx2 v[166:167], v133, s[40:43], s94 offen offset:2048 sc1
    s_add_u32 s94, s94, 4096
    buffer_load_dwordx2 v[168:169], v133, s[40:43], s94 offen offset:0 sc1
    buffer_load_dwordx2 v[170:171], v133, s[40:43], s94 offen offset:2048 sc1
    s_add_u32 s99, s99, 2
    s_waitcnt vmcnt(13)
    v_mfma_f32_4x4x4_16b_bf16 v[4:7], v[2:3], v[144:145], v[4:7]
    s_waitcnt vmcnt(12)
    v_mfma_f32_4x4x4_16b_bf16 v[8:11], v[2:3], v[146:147], v[8:11]
    s_waitcnt vmcnt(11)
    v_mfma_f32_4x4x4_16b_bf16 v[12:15], v[2:3], v[148:149], v[12:15]
    s_waitcnt vmcnt(10)
    v_mfma_f32_4x4x4_16b_bf16 v[16:19], v[2:3], v[150:151], v[16:19]
    s_waitcnt vmcnt(9)
    v_mfma_f32_4x4x4_16b_bf16 v[20:23], v[2:3], v[152:153], v[20:23]
    s_waitcnt vmcnt(8)
    v_mfma_f32_4x4x4_16b_bf16 v[24:27], v[2:3], v[154:155], v[24:27]
    s_waitcnt vmcnt(7)
    v_mfma_f32_4x4x4_16b_bf16 v[28:31], v[2:3], v[156:157], v[28:31]
    s_waitcnt vmcnt(6)
    v_mfma_f32_4x4x4_16b_bf16 v[4:7], v[2:3], v[158:159], v[4:7]
    s_waitcnt vmcnt(5)
    v_mfma_f32_4x4x4_16b_bf16 v[8:11], v[2:3], v[160:161], v[8:11]
    s_waitcnt vmcnt(4)
    v_mfma_f32_4x4x4_16b_bf16 v[12:15], v[2:3], v[162:163], v[12:15]
    s_waitcnt vmcnt(3)
    v_mfma_f32_4x4x4_16b_bf16 v[16:19], v[2:3], v[164:165], v[16:19]
    s_waitcnt vmcnt(2)
    v_mfma_f32_4x4x4_16b_bf16 v[20:23], v[2:3], v[166:167], v[20:23]
    s_waitcnt vmcnt(1)
    v_mfma_f32_4x4x4_16b_bf16 v[24:27], v[2:3], v[168:169], v[24:27]
    s_waitcnt vmcnt(0)
    v_mfma_f32_4x4x4_16b_bf16 v[28:31], v[2:3], v[170:171], v[28:31]
    buffer_load_dword v88, v135, s[40:43], s95 offen sc1
    s_nop 1
    v_cvt_pk_bf16_f32 v60, v4, v5
    v_cvt_pk_bf16_f32 v61, v6, v7
    ds_write_b64 v208, v[60:61] offset:0
    v_cvt_pk_bf16_f32 v62, v8, v9
    v_cvt_pk_bf16_f32 v63, v10, v11
    ds_write_b64 v208, v[62:63] offset:128
    v_cvt_pk_bf16_f32 v64, v12, v13
    v_cvt_pk_bf16_f32 v65, v14, v15
    ds_write_b64 v208, v[64:65] offset:256
    v_cvt_pk_bf16_f32 v66, v16, v17
    v_cvt_pk_bf16_f32 v67, v18, v19
    ds_write_b64 v208, v[66:67] offset:384
    v_cvt_pk_bf16_f32 v68, v20, v21
    v_cvt_pk_bf16_f32 v69, v22, v23
    ds_write_b64 v208, v[68:69] offset:512
    v_cvt_pk_bf16_f32 v70, v24, v25
    v_cvt_pk_bf16_f32 v71, v26, v27
    ds_write_b64 v208, v[70:71] offset:640
    v_cvt_pk_bf16_f32 v72, v28, v29
    v_cvt_pk_bf16_f32 v73, v30, v31
    ds_write_b64 v208, v[72:73] offset:768
    s_waitcnt vmcnt(0)
    v_subrev_u32 v88, s99, v88
    v_cmp_le_u32 vcc, 64, v88
    s_waitcnt lgkmcnt(0)
    ds_read_b128 v[176:179], v209 offset:0
    ds_read_b128 v[180:183], v209 offset:1024
    ds_read_b128 v[184:187], v209 offset:2048
    ds_read_b128 v[188:191], v209 offset:3072
    s_cbranch_vccz L_lk_156
    s_mov_b32 s71, 0
L_wp_159:
    buffer_load_dword v88, v135, s[40:43], s95 offen sc1
    s_waitcnt vmcnt(0)
    v_subrev_u32 v88, s99, v88
    v_cmp_le_u32 vcc, 64, v88
    s_add_u32 s71, s71, 1
    s_cmp_eq_u64 vcc, 0
    s_cbranch_scc1 L_wpd_160
    s_cmp_lt_u32 s71, 131072
    s_cbranch_scc1 L_wp_159
L_wpd_160:
L_lk_156:
    buffer_load_dwordx2 v[144:145], v133, s[40:43], s73 offen offset:0 sc1
    buffer_load_dwordx2 v[146:147], v133, s[40:43], s73 offen offset:2048 sc1
    s_add_u32 s73, s73, 4096
    buffer_load_dwordx2 v[148:149], v133, s[40:43], s73 offen offset:0 sc1
    buffer_load_dwordx2 v[150:151], v133, s[40:43], s73 offen offset:2048 sc1
    s_add_u32 s73, s73, 4096
    buffer_load_dwordx2 v[152:153], v133, s[40:43], s73 offen offset:0 sc1
    buffer_load_dwordx2 v[154:155], v133, s[40:43], s73 offen offset:2048 sc1
    s_add_u32 s73, s73, 4096
    buffer_load_dwordx2 v[156:157], v133, s[40:43], s73 offen offset:0 sc1
    buffer_load_dwordx2 v[158:159], v133, s[40:43], s73 offen offset:2048 sc1
    s_add_u32 s73, s73, 4096
    buffer_load_dwordx2 v[160:161], v133, s[40:43], s73 offen offset:0 sc1
    buffer_load_dwordx2 v[162:163], v133, s[40:43], s73 offen offset:2048 sc1
    s_add_u32 s73, s73, 4096
    buffer_load_dwordx2 v[164:165], v133, s[40:43], s73 offen offset:0 sc1
    buffer_load_dwordx2 v[166:167], v133, s[40:43], s73 offen offset:2048 sc1
    s_add_u32 s73, s73, 4096
    buffer_load_dwordx2 v[168:169], v133, s[40:43], s73 offen offset:0 sc1
    buffer_load_dwordx2 v[170:171], v133, s[40:43], s73 offen offset:2048 sc1
    s_waitcnt lgkmcnt(3)
    buffer_store_dwordx4 v[176:179], v210, s[60:63], s93 offen offset:0 nt
    s_waitcnt lgkmcnt(2)
    buffer_store_dwordx4 v[180:183], v210, s[60:63], s93 offen offset:1024 nt
    s_waitcnt lgkmcnt(1)
    buffer_store_dwordx4 v[184:187], v210, s[60:63], s93 offen offset:2048 nt
    s_waitcnt lgkmcnt(0)
    buffer_store_dwordx4 v[188:191], v211, s[60:63], s93 offen offset:3072 nt
    s_add_u32 s93, s93, 458752
    s_waitcnt vmcnt(17)
    v_mfma_f32_4x4x4_16b_bf16 v[32:35], v[2:3], v[144:145], v[32:35]
    s_waitcnt vmcnt(16)
    v_mfma_f32_4x4x4_16b_bf16 v[36:39], v[2:3], v[146:147], v[36:39]
    s_waitcnt vmcnt(15)
    v_mfma_f32_4x4x4_16b_bf16 v[40:43], v[2:3], v[148:149], v[40:43]
    s_waitcnt vmcnt(14)
    v_mfma_f32_4x4x4_16b_bf16 v[44:47], v[2:3], v[150:151], v[44:47]
    s_waitcnt vmcnt(13)
    v_mfma_f32_4x4x4_16b_bf16 v[48:51], v[2:3], v[152:153], v[48:51]
    s_waitcnt vmcnt(12)
    v_mfma_f32_4x4x4_16b_bf16 v[52:55], v[2:3], v[154:155], v[52:55]
    s_waitcnt vmcnt(11)
    v_mfma_f32_4x4x4_16b_bf16 v[56:59], v[2:3], v[156:157], v[56:59]
    s_waitcnt vmcnt(10)
    v_mfma_f32_4x4x4_16b_bf16 v[32:35], v[2:3], v[158:159], v[32:35]
    s_waitcnt vmcnt(9)
    v_mfma_f32_4x4x4_16b_bf16 v[36:39], v[2:3], v[160:161], v[36:39]
    s_waitcnt vmcnt(8)
    v_mfma_f32_4x4x4_16b_bf16 v[40:43], v[2:3], v[162:163], v[40:43]
    s_waitcnt vmcnt(7)
    v_mfma_f32_4x4x4_16b_bf16 v[44:47], v[2:3], v[164:165], v[44:47]
    s_waitcnt vmcnt(6)
    v_mfma_f32_4x4x4_16b_bf16 v[48:51], v[2:3], v[166:167], v[48:51]
    s_waitcnt vmcnt(5)
    v_mfma_f32_4x4x4_16b_bf16 v[52:55], v[2:3], v[168:169], v[52:55]
    s_waitcnt vmcnt(4)
    v_mfma_f32_4x4x4_16b_bf16 v[56:59], v[2:3], v[170:171], v[56:59]
    s_nop 2
    v_cvt_pk_bf16_f32 v60, v32, v33
    v_cvt_pk_bf16_f32 v61, v34, v35
    ds_write_b64 v208, v[60:61] offset:0
    v_cvt_pk_bf16_f32 v62, v36, v37
    v_cvt_pk_bf16_f32 v63, v38, v39
    ds_write_b64 v208, v[62:63] offset:128
    v_cvt_pk_bf16_f32 v64, v40, v41
    v_cvt_pk_bf16_f32 v65, v42, v43
    ds_write_b64 v208, v[64:65] offset:256
    v_cvt_pk_bf16_f32 v66, v44, v45
    v_cvt_pk_bf16_f32 v67, v46, v47
    ds_write_b64 v208, v[66:67] offset:384
    v_cvt_pk_bf16_f32 v68, v48, v49
    v_cvt_pk_bf16_f32 v69, v50, v51
    ds_write_b64 v208, v[68:69] offset:512
    v_cvt_pk_bf16_f32 v70, v52, v53
    v_cvt_pk_bf16_f32 v71, v54, v55
    ds_write_b64 v208, v[70:71] offset:640
    v_cvt_pk_bf16_f32 v72, v56, v57
    v_cvt_pk_bf16_f32 v73, v58, v59
    ds_write_b64 v208, v[72:73] offset:768
    s_waitcnt lgkmcnt(0)
    ds_read_b128 v[88:91], v209 offset:0
    ds_read_b128 v[92:95], v209 offset:1024
    ds_read_b128 v[96:99], v209 offset:2048
    ds_read_b128 v[100:103], v209 offset:3072
    s_waitcnt lgkmcnt(3)
    buffer_store_dwordx4 v[88:91], v210, s[60:63], s93 offen offset:0 nt
    s_waitcnt lgkmcnt(2)
    buffer_store_dwordx4 v[92:95], v210, s[60:63], s93 offen offset:1024 nt
    s_waitcnt lgkmcnt(1)
    buffer_store_dwordx4 v[96:99], v210, s[60:63], s93 offen offset:2048 nt
    s_waitcnt lgkmcnt(0)
    buffer_store_dwordx4 v[100:103], v211, s[60:63], s93 offen offset:3072 nt
    s_branch L_done
L_slow_134:
.p2align 6
L_rl_161:
    ds_read_b128 v[60:63], v128
    ds_read_b128 v[64:67], v128 offset:4096
    ds_read_b128 v[68:71], v128 offset:8192
    ds_read_b64 v[72:73], v129
    s_lshl_b32 s96, s91, 4
    s_add_u32 s96, s96, s66
    s_mul_i32 s96, s96, 28672
    s_add_u32 s96, s96, 3145728
    v_mov_b32 v140, s98
    s_waitcnt lgkmcnt(0)
    v_mfma_f32_4x4x4_16b_bf16 v[4:7], v[2:3], v[60:61], 0
    v_mfma_f32_4x4x4_16b_bf16 v[8:11], v[2:3], v[62:63], 0
    v_mfma_f32_4x4x4_16b_bf16 v[12:15], v[2:3], v[64:65], 0
    v_mfma_f32_4x4x4_16b_bf16 v[16:19], v[2:3], v[66:67], 0
    v_mfma_f32_4x4x4_16b_bf16 v[20:23], v[2:3], v[68:69], 0
    v_mfma_f32_4x4x4_16b_bf16 v[24:27], v[2:3], v[70:71], 0
    v_mfma_f32_4x4x4_16b_bf16 v[28:31], v[2:3], v[72:73], 0
    s_cmp_eq_u32 s92, 0
    s_cbranch_scc1 L_rnos_162
    s_cmp_ge_u32 s100, 10
    s_cselect_b32 s72, 4, 5
    s_sub_u32 s99, s98, s72
    s_and_b32 s94, s91, 1
    s_lshl_b32 s94, s94, 1
    s_add_u32 s94, s94, s90
    s_lshl_b32 s72, s66, 2
    s_add_u32 s94, s94, s72
    s_mul_i32 s94, s94, 28672
    s_add_u32 s94, s94, 5242880
    s_cmp_eq_u32 s92, 2
    s_cbranch_scc1 L_ny_168
    ds_read_b32 v74, v131 offset:0
    ds_read_b32 v75, v131 offset:1024
    ds_read_b32 v76, v131 offset:2048
    ds_read_b32 v77, v131 offset:3072
    ds_read_b32 v78, v131 offset:4096
    ds_read_b32 v79, v131 offset:5120
    ds_read_b32 v80, v131 offset:6144
    ds_read_b32 v81, v131 offset:7168
    ds_read_b32 v82, v131 offset:8192
    ds_read_b32 v83, v131 offset:9216
    ds_read_b32 v84, v131 offset:10240
    ds_read_b32 v85, v131 offset:11264
    ds_read_b32 v86, v131 offset:12288
    ds_read_b32 v87, v131 offset:13312
L_ny_168:
    s_cmp_eq_u32 s100, 10
    s_cbranch_scc1 L_dp_169
    s_mov_b32 s71, 0
L_wp_171:
    buffer_load_dword v88, v135, s[40:43], s95 offen sc1
    s_waitcnt vmcnt(0)
    v_subrev_u32 v88, s99, v88
    v_cmp_le_u32 vcc, 64, v88
    s_add_u32 s71, s71, 1
    s_cmp_eq_u64 vcc, 0
    s_cbranch_scc1 L_wpd_172
    s_cmp_lt_u32 s71, 131072
    s_cbranch_scc1 L_wp_171
L_wpd_172:
    buffer_load_dwordx2 v[144:145], v133, s[40:43], s94 offen offset:0 sc1
    buffer_load_dwordx2 v[146:147], v133, s[40:43], s94 offen offset:2048 sc1
    s_add_u32 s94, s94, 4096
    buffer_load_dwordx2 v[148:149], v133, s[40:43], s94 offen offset:0 sc1
    buffer_load_dwordx2 v[150:151], v133, s[40:43], s94 offen offset:2048 sc1
    s_add_u32 s94, s94, 4096
    buffer_load_dwordx2 v[152:153], v133, s[40:43], s94 offen offset:0 sc1
    buffer_load_dwordx2 v[154:155], v133, s[40:43], s94 offen offset:2048 sc1
    s_add_u32 s94, s94, 4096
    buffer_load_dwordx2 v[156:157], v133, s[40:43], s94 offen offset:0 sc1
    buffer_load_dwordx2 v[158:159], v133, s[40:43], s94 offen offset:2048 sc1
    s_add_u32 s94, s94, 4096
    buffer_load_dwordx2 v[160:161], v133, s[40:43], s94 offen offset:0 sc1
    buffer_load_dwordx2 v[162:163], v133, s[40:43], s94 offen offset:2048 sc1
    s_add_u32 s94, s94, 4096
    buffer_load_dwordx2 v[164:165], v133, s[40:43], s94 offen offset:0 sc1
    buffer_load_dwordx2 v[166:167], v133, s[40:43], s94 offen offset:2048 sc1
    s_add_u32 s94, s94, 4096
    buffer_load_dwordx2 v[168:169], v133, s[40:43], s94 offen offset:0 sc1
    buffer_load_dwordx2 v[170:171], v133, s[40:43], s94 offen offset:2048 sc1
    s_waitcnt lgkmcnt(0)
    v_mfma_f32_4x4x4_16b_bf16 v[32:35], v[2:3], v[74:75], 0
    v_mfma_f32_4x4x4_16b_bf16 v[36:39], v[2:3], v[76:77], 0
    v_mfma_f32_4x4x4_16b_bf16 v[40:43], v[2:3], v[78:79], 0
    v_mfma_f32_4x4x4_16b_bf16 v[44:47], v[2:3], v[80:81], 0
    v_mfma_f32_4x4x4_16b_bf16 v[48:51], v[2:3], v[82:83], 0
    v_mfma_f32_4x4x4_16b_bf16 v[52:55], v[2:3], v[84:85], 0
    v_mfma_f32_4x4x4_16b_bf16 v[56:59], v[2:3], v[86:87], 0
L_sum_170:
    s_waitcnt vmcnt(13)
    v_mfma_f32_4x4x4_16b_bf16 v[4:7], v[2:3], v[144:145], v[4:7]
    s_waitcnt vmcnt(12)
    v_mfma_f32_4x4x4_16b_bf16 v[8:11], v[2:3], v[146:147], v[8:11]
    s_waitcnt vmcnt(11)
    v_mfma_f32_4x4x4_16b_bf16 v[12:15], v[2:3], v[148:149], v[12:15]
    s_waitcnt vmcnt(10)
    v_mfma_f32_4x4x4_16b_bf16 v[16:19], v[2:3], v[150:151], v[16:19]
    s_waitcnt vmcnt(9)
    v_mfma_f32_4x4x4_16b_bf16 v[20:23], v[2:3], v[152:153], v[20:23]
    s_waitcnt vmcnt(8)
    v_mfma_f32_4x4x4_16b_bf16 v[24:27], v[2:3], v[154:155], v[24:27]
    s_waitcnt vmcnt(7)
    v_mfma_f32_4x4x4_16b_bf16 v[28:31], v[2:3], v[156:157], v[28:31]
    s_waitcnt vmcnt(6)
    v_mfma_f32_4x4x4_16b_bf16 v[4:7], v[2:3], v[158:159], v[4:7]
    s_waitcnt vmcnt(5)
    v_mfma_f32_4x4x4_16b_bf16 v[8:11], v[2:3], v[160:161], v[8:11]
    s_waitcnt vmcnt(4)
    v_mfma_f32_4x4x4_16b_bf16 v[12:15], v[2:3], v[162:163], v[12:15]
    s_waitcnt vmcnt(3)
    v_mfma_f32_4x4x4_16b_bf16 v[16:19], v[2:3], v[164:165], v[16:19]
    s_waitcnt vmcnt(2)
    v_mfma_f32_4x4x4_16b_bf16 v[20:23], v[2:3], v[166:167], v[20:23]
    s_waitcnt vmcnt(1)
    v_mfma_f32_4x4x4_16b_bf16 v[24:27], v[2:3], v[168:169], v[24:27]
    s_waitcnt vmcnt(0)
    v_mfma_f32_4x4x4_16b_bf16 v[28:31], v[2:3], v[170:171], v[28:31]
    s_nop 2
    s_cmp_eq_u32 s92, 2
    s_cbranch_scc1 L_rfin_165
L_rnos_162:
    s_nop 2
    v_pk_add_f32 v[116:117], v[4:5], v[6:7]
    v_pk_mul_f32 v[118:119], v[4:5], v[4:5]
    v_pk_fma_f32 v[118:119], v[6:7], v[6:7], v[118:119]
    v_pk_add_f32 v[116:117], v[116:117], v[8:9]
    v_pk_fma_f32 v[118:119], v[8:9], v[8:9], v[118:119]
    v_pk_add_f32 v[116:117], v[116:117], v[10:11]
    v_pk_fma_f32 v[118:119], v[10:11], v[10:11], v[118:119]
    v_pk_add_f32 v[116:117], v[116:117], v[12:13]
    v_pk_fma_f32 v[118:119], v[12:13], v[12:13], v[118:119]
    v_pk_add_f32 v[116:117], v[116:117], v[14:15]
    v_pk_fma_f32 v[118:119], v[14:15], v[14:15], v[118:119]
    v_pk_add_f32 v[116:117], v[116:117], v[16:17]
    v_pk_fma_f32 v[118:119], v[16:17], v[16:17], v[118:119]
    v_pk_add_f32 v[116:117], v[116:117], v[18:19]
    v_pk_fma_f32 v[118:119], v[18:19], v[18:19], v[118:119]
    v_pk_add_f32 v[116:117], v[116:117], v[20:21]
    v_pk_fma_f32 v[118:119], v[20:21], v[20:21], v[118:119]
    v_pk_add_f32 v[116:117], v[116:117], v[22:23]
    v_pk_fma_f32 v[118:119], v[22:23], v[22:23], v[118:119]
    v_pk_add_f32 v[116:117], v[116:117], v[24:25]
    v_pk_fma_f32 v[118:119], v[24:25], v[24:25], v[118:119]
    v_pk_add_f32 v[116:117], v[116:117], v[26:27]
    v_pk_fma_f32 v[118:119], v[26:27], v[26:27], v[118:119]
    v_pk_add_f32 v[116:117], v[116:117], v[28:29]
    v_pk_fma_f32 v[118:119], v[28:29], v[28:29], v[118:119]
    v_pk_add_f32 v[116:117], v[116:117], v[30:31]
    v_pk_fma_f32 v[118:119], v[30:31], v[30:31], v[118:119]
    v_add_f32 v116, v116, v117
    v_add_f32 v118, v118, v119
    s_nop 0
    v_add_f32_dpp v116, v116, v116 row_ror:4 row_mask:0xf bank_mask:0xf
    v_add_f32_dpp v118, v118, v118 row_ror:4 row_mask:0xf bank_mask:0xf
    s_nop 0
    v_add_f32_dpp v116, v116, v116 row_ror:8 row_mask:0xf bank_mask:0xf
    v_add_f32_dpp v118, v118, v118 row_ror:8 row_mask:0xf bank_mask:0xf
    s_nop 0
    v_mov_b32 v117, v116
    v_mov_b32 v119, v118
    s_nop 0
    v_permlane16_swap_b32 v116, v117
    v_permlane16_swap_b32 v118, v119
    v_add_f32 v116, v116, v117
    v_add_f32 v118, v118, v119
    v_mov_b32 v117, v116
    v_mov_b32 v119, v118
    s_nop 0
    v_permlane32_swap_b32 v116, v117
    v_permlane32_swap_b32 v118, v119
    v_add_f32 v116, v116, v117
    v_add_f32 v118, v118, v119
    v_mul_f32 v116, s79, v116
    v_mul_f32 v118, s79, v118
    v_fma_f32 v118, -v116, v116, v118
    v_max_f32 v118, 0, v118
    v_add_f32 v118, 0x3727c5ac, v118
    v_rsq_f32 v122, v118
    s_nop 0
    v_mul_f32 v123, v116, v122
    v_sub_f32 v123, 0, v123
    v_pk_fma_f32 v[88:89], v[4:5], v[122:123], v[122:123] op_sel:[0,0,1] op_sel_hi:[1,0,1]
    v_pk_fma_f32 v[90:91], v[6:7], v[122:123], v[122:123] op_sel:[0,0,1] op_sel_hi:[1,0,1]
    v_pk_fma_f32 v[92:93], v[8:9], v[122:123], v[122:123] op_sel:[0,0,1] op_sel_hi:[1,0,1]
    v_pk_fma_f32 v[94:95], v[10:11], v[122:123], v[122:123] op_sel:[0,0,1] op_sel_hi:[1,0,1]
    v_pk_fma_f32 v[96:97], v[12:13], v[122:123], v[122:123] op_sel:[0,0,1] op_sel_hi:[1,0,1]
    v_pk_fma_f32 v[98:99], v[14:15], v[122:123], v[122:123] op_sel:[0,0,1] op_sel_hi:[1,0,1]
    v_pk_fma_f32 v[100:101], v[16:17], v[122:123], v[122:123] op_sel:[0,0,1] op_sel_hi:[1,0,1]
    v_pk_fma_f32 v[102:103], v[18:19], v[122:123], v[122:123] op_sel:[0,0,1] op_sel_hi:[1,0,1]
    v_pk_fma_f32 v[104:105], v[20:21], v[122:123], v[122:123] op_sel:[0,0,1] op_sel_hi:[1,0,1]
    v_pk_fma_f32 v[106:107], v[22:23], v[122:123], v[122:123] op_sel:[0,0,1] op_sel_hi:[1,0,1]
    v_pk_fma_f32 v[108:109], v[24:25], v[122:123], v[122:123] op_sel:[0,0,1] op_sel_hi:[1,0,1]
    v_pk_fma_f32 v[110:111], v[26:27], v[122:123], v[122:123] op_sel:[0,0,1] op_sel_hi:[1,0,1]
    v_pk_fma_f32 v[112:113], v[28:29], v[122:123], v[122:123] op_sel:[0,0,1] op_sel_hi:[1,0,1]
    v_pk_fma_f32 v[114:115], v[30:31], v[122:123], v[122:123] op_sel:[0,0,1] op_sel_hi:[1,0,1]
    s_cmp_lg_u32 s92, 0
    s_cbranch_scc1 L_rnoy_164
    s_cmp_lg_u32 s91, 0
    s_cbranch_scc1 L_rny2_174
    s_mov_b32 s72, 65536
    s_mov_b32 s71, 0
L_poll_176:
    buffer_load_dword v142, v139, s[40:43], s72 offen sc1
    s_add_u32 s71, s71, 1
    s_waitcnt vmcnt(0)
    v_cmp_ne_u32 vcc, s69, v142
    s_cmp_ge_u32 s71, 131072
    s_cbranch_scc1 L_polld_177
    s_and_b64 exec, exec, vcc
    s_cbranch_scc1 L_poll_176
L_polld_177:
    s_mov_b64 exec, -1
    s_barrier
    s_mov_b32 m0, s81
    s_add_u32 s81, s81, 14336
    buffer_load_dwordx4 v132, s[40:43], s80 offen offset:0 sc1 lds
    buffer_load_dwordx4 v132, s[40:43], s80 offen offset:1024 sc1 lds
    buffer_load_dwordx4 v132, s[40:43], s80 offen offset:2048 sc1 lds
    buffer_load_dwordx4 v132, s[40:43], s80 offen offset:3072 sc1 lds
    s_add_u32 s80, s80, 458752
    s_mov_b32 m0, s81
    s_add_u32 s81, s81, 14336
    buffer_load_dwordx4 v132, s[40:43], s80 offen offset:0 sc1 lds
    buffer_load_dwordx4 v132, s[40:43], s80 offen offset:1024 sc1 lds
    buffer_load_dwordx4 v132, s[40:43], s80 offen offset:2048 sc1 lds
    buffer_load_dwordx4 v132, s[40:43], s80 offen offset:3072 sc1 lds
    s_add_u32 s80, s80, 458752
    s_or_b32 s72, s66, s90
    s_or_b32 s72, s72, s68
    s_cmp_lg_u32 s72, 0
    s_waitcnt vmcnt(4)
    s_cbranch_scc1 L_rny1_173
    buffer_store_dword v138, off, s[40:43], 0 sc1
    s_branch L_rny1_173
L_rny2_174:
    s_cmp_lg_u32 s91, 1
    s_cbranch_scc1 L_rny3_175
    s_mov_b32 s72, 65540
    buffer_load_dword v142, v139, s[40:43], s72 offen sc1
    s_branch L_rny1_173
L_rny3_175:
    s_waitcnt vmcnt(4)
L_rny1_173:
    s_barrier
    ds_read_b32 v74, v131 offset:0
    ds_read_b32 v75, v131 offset:1024
    ds_read_b32 v76, v131 offset:2048
    ds_read_b32 v77, v131 offset:3072
    ds_read_b32 v78, v131 offset:4096
    ds_read_b32 v79, v131 offset:5120
    ds_read_b32 v80, v131 offset:6144
    ds_read_b32 v81, v131 offset:7168
    ds_read_b32 v82, v131 offset:8192
    ds_read_b32 v83, v131 offset:9216
    ds_read_b32 v84, v131 offset:10240
    ds_read_b32 v85, v131 offset:11264
    ds_read_b32 v86, v131 offset:12288
    ds_read_b32 v87, v131 offset:13312
    s_waitcnt lgkmcnt(0)
    v_mfma_f32_4x4x4_16b_bf16 v[32:35], v[2:3], v[74:75], 0
    v_mfma_f32_4x4x4_16b_bf16 v[36:39], v[2:3], v[76:77], 0
    v_mfma_f32_4x4x4_16b_bf16 v[40:43], v[2:3], v[78:79], 0
    v_mfma_f32_4x4x4_16b_bf16 v[44:47], v[2:3], v[80:81], 0
    v_mfma_f32_4x4x4_16b_bf16 v[48:51], v[2:3], v[82:83], 0
    v_mfma_f32_4x4x4_16b_bf16 v[52:55], v[2:3], v[84:85], 0
    v_mfma_f32_4x4x4_16b_bf16 v[56:59], v[2:3], v[86:87], 0
L_rnoy_164:
    s_nop 3
    v_pk_fma_f32 v[4:5], v[88:89], v[32:33], v[4:5]
    v_pk_fma_f32 v[6:7], v[90:91], v[34:35], v[6:7]
    v_pk_fma_f32 v[8:9], v[92:93], v[36:37], v[8:9]
    v_pk_fma_f32 v[10:11], v[94:95], v[38:39], v[10:11]
    v_pk_fma_f32 v[12:13], v[96:97], v[40:41], v[12:13]
    v_pk_fma_f32 v[14:15], v[98:99], v[42:43], v[14:15]
    v_pk_fma_f32 v[16:17], v[100:101], v[44:45], v[16:17]
    v_pk_fma_f32 v[18:19], v[102:103], v[46:47], v[18:19]
    v_pk_fma_f32 v[20:21], v[104:105], v[48:49], v[20:21]
    v_pk_fma_f32 v[22:23], v[106:107], v[50:51], v[22:23]
    v_pk_fma_f32 v[24:25], v[108:109], v[52:53], v[24:25]
    v_pk_fma_f32 v[26:27], v[110:111], v[54:55], v[26:27]
    v_pk_fma_f32 v[28:29], v[112:113], v[56:57], v[28:29]
    v_pk_fma_f32 v[30:31], v[114:115], v[58:59], v[30:31]
    v_pk_add_f32 v[116:117], v[4:5], v[6:7]
    v_pk_mul_f32 v[118:119], v[4:5], v[4:5]
    v_pk_fma_f32 v[118:119], v[6:7], v[6:7], v[118:119]
    v_pk_add_f32 v[116:117], v[116:117], v[8:9]
    v_pk_fma_f32 v[118:119], v[8:9], v[8:9], v[118:119]
    v_pk_add_f32 v[116:117], v[116:117], v[10:11]
    v_pk_fma_f32 v[118:119], v[10:11], v[10:11], v[118:119]
    v_pk_add_f32 v[116:117], v[116:117], v[12:13]
    v_pk_fma_f32 v[118:119], v[12:13], v[12:13], v[118:119]
    v_pk_add_f32 v[116:117], v[116:117], v[14:15]
    v_pk_fma_f32 v[118:119], v[14:15], v[14:15], v[118:119]
    v_pk_add_f32 v[116:117], v[116:117], v[16:17]
    v_pk_fma_f32 v[118:119], v[16:17], v[16:17], v[118:119]
    v_pk_add_f32 v[116:117], v[116:117], v[18:19]
    v_pk_fma_f32 v[118:119], v[18:19], v[18:19], v[118:119]
    v_pk_add_f32 v[116:117], v[116:117], v[20:21]
    v_pk_fma_f32 v[118:119], v[20:21], v[20:21], v[118:119]
    v_pk_add_f32 v[116:117], v[116:117], v[22:23]
    v_pk_fma_f32 v[118:119], v[22:23], v[22:23], v[118:119]
    v_pk_add_f32 v[116:117], v[116:117], v[24:25]
    v_pk_fma_f32 v[118:119], v[24:25], v[24:25], v[118:119]
    v_pk_add_f32 v[116:117], v[116:117], v[26:27]
    v_pk_fma_f32 v[118:119], v[26:27], v[26:27], v[118:119]
    v_pk_add_f32 v[116:117], v[116:117], v[28:29]
    v_pk_fma_f32 v[118:119], v[28:29], v[28:29], v[118:119]
    v_pk_add_f32 v[116:117], v[116:117], v[30:31]
    v_pk_fma_f32 v[118:119], v[30:31], v[30:31], v[118:119]
    v_add_f32 v116, v116, v117
    v_add_f32 v118, v118, v119
    s_nop 0
    v_add_f32_dpp v116, v116, v116 row_ror:4 row_mask:0xf bank_mask:0xf
    v_add_f32_dpp v118, v118, v118 row_ror:4 row_mask:0xf bank_mask:0xf
    s_nop 0
    v_add_f32_dpp v116, v116, v116 row_ror:8 row_mask:0xf bank_mask:0xf
    v_add_f32_dpp v118, v118, v118 row_ror:8 row_mask:0xf bank_mask:0xf
    s_nop 0
    v_mov_b32 v117, v116
    v_mov_b32 v119, v118
    s_nop 0
    v_permlane16_swap_b32 v116, v117
    v_permlane16_swap_b32 v118, v119
    v_add_f32 v116, v116, v117
    v_add_f32 v118, v118, v119
    v_mov_b32 v117, v116
    v_mov_b32 v119, v118
    s_nop 0
    v_permlane32_swap_b32 v116, v117
    v_permlane32_swap_b32 v118, v119
    v_add_f32 v116, v116, v117
    v_add_f32 v118, v118, v119
    v_mul_f32 v116, s79, v116
    v_mul_f32 v118, s79, v118
    v_fma_f32 v118, -v116, v116, v118
    v_max_f32 v118, 0, v118
    v_add_f32 v118, 0x3727c5ac, v118
    v_rsq_f32 v122, v118
    s_nop 0
    v_mul_f32 v123, v116, v122
    v_sub_f32 v123, 0, v123
    v_pk_fma_f32 v[88:89], v[4:5], v[122:123], v[122:123] op_sel:[0,0,1] op_sel_hi:[1,0,1]
    v_pk_fma_f32 v[90:91], v[6:7], v[122:123], v[122:123] op_sel:[0,0,1] op_sel_hi:[1,0,1]
    v_pk_fma_f32 v[92:93], v[8:9], v[122:123], v[122:123] op_sel:[0,0,1] op_sel_hi:[1,0,1]
    v_pk_fma_f32 v[94:95], v[10:11], v[122:123], v[122:123] op_sel:[0,0,1] op_sel_hi:[1,0,1]
    v_pk_fma_f32 v[96:97], v[12:13], v[122:123], v[122:123] op_sel:[0,0,1] op_sel_hi:[1,0,1]
    v_pk_fma_f32 v[98:99], v[14:15], v[122:123], v[122:123] op_sel:[0,0,1] op_sel_hi:[1,0,1]
    v_pk_fma_f32 v[100:101], v[16:17], v[122:123], v[122:123] op_sel:[0,0,1] op_sel_hi:[1,0,1]
    v_pk_fma_f32 v[102:103], v[18:19], v[122:123], v[122:123] op_sel:[0,0,1] op_sel_hi:[1,0,1]
    v_pk_fma_f32 v[104:105], v[20:21], v[122:123], v[122:123] op_sel:[0,0,1] op_sel_hi:[1,0,1]
    v_pk_fma_f32 v[106:107], v[22:23], v[122:123], v[122:123] op_sel:[0,0,1] op_sel_hi:[1,0,1]
    v_pk_fma_f32 v[108:109], v[24:25], v[122:123], v[122:123] op_sel:[0,0,1] op_sel_hi:[1,0,1]
    v_pk_fma_f32 v[110:111], v[26:27], v[122:123], v[122:123] op_sel:[0,0,1] op_sel_hi:[1,0,1]
    v_pk_fma_f32 v[112:113], v[28:29], v[122:123], v[122:123] op_sel:[0,0,1] op_sel_hi:[1,0,1]
    v_pk_fma_f32 v[114:115], v[30:31], v[122:123], v[122:123] op_sel:[0,0,1] op_sel_hi:[1,0,1]
    v_cvt_pk_bf16_f32 v32, v88, v89
    v_cvt_pk_bf16_f32 v33, v90, v91
    v_cvt_pk_bf16_f32 v34, v92, v93
    v_cvt_pk_bf16_f32 v35, v94, v95
    buffer_store_dwordx4 v[32:35], v136, s[40:43], s96 offen offset:0 sc1
    v_cvt_pk_bf16_f32 v36, v96, v97
    v_cvt_pk_bf16_f32 v37, v98, v99
    v_cvt_pk_bf16_f32 v38, v100, v101
    v_cvt_pk_bf16_f32 v39, v102, v103
    buffer_store_dwordx4 v[36:39], v136, s[40:43], s96 offen offset:1024 sc1
    v_cvt_pk_bf16_f32 v40, v104, v105
    v_cvt_pk_bf16_f32 v41, v106, v107
    v_cvt_pk_bf16_f32 v42, v108, v109
    v_cvt_pk_bf16_f32 v43, v110, v111
    buffer_store_dwordx4 v[40:43], v136, s[40:43], s96 offen offset:2048 sc1
    v_cvt_pk_bf16_f32 v44, v112, v113
    v_cvt_pk_bf16_f32 v45, v114, v115
    buffer_store_dwordx2 v[44:45], v137, s[40:43], s96 offen sc1
    v_cvt_pk_bf16_f32 v60, v4, v5
    v_cvt_pk_bf16_f32 v61, v6, v7
    v_cvt_pk_bf16_f32 v62, v8, v9
    v_cvt_pk_bf16_f32 v63, v10, v11
    v_cvt_pk_bf16_f32 v64, v12, v13
    v_cvt_pk_bf16_f32 v65, v14, v15
    v_cvt_pk_bf16_f32 v66, v16, v17
    v_cvt_pk_bf16_f32 v67, v18, v19
    v_cvt_pk_bf16_f32 v68, v20, v21
    v_cvt_pk_bf16_f32 v69, v22, v23
    v_cvt_pk_bf16_f32 v70, v24, v25
    v_cvt_pk_bf16_f32 v71, v26, v27
    v_cvt_pk_bf16_f32 v72, v28, v29
    v_cvt_pk_bf16_f32 v73, v30, v31
    s_waitcnt vmcnt(0)
    buffer_store_dword v140, off, s[40:43], s97 sc1
    ds_write_b128 v128, v[60:63]
    ds_write_b128 v128, v[64:67] offset:4096
    ds_write_b128 v128, v[68:71] offset:8192
    ds_write_b64 v129, v[72:73]
    s_cmp_lg_u32 s100, 1
    s_cbranch_scc1 L_rnx_166
    v_cmp_ne_u32 vcc, s69, v142
    s_mov_b32 s72, 65540
    s_nop 0
    s_cbranch_vccz L_y2ok_167
    s_mov_b32 s71, 0
L_poll_178:
    buffer_load_dword v142, v139, s[40:43], s72 offen sc1
    s_add_u32 s71, s71, 1
    s_waitcnt vmcnt(0)
    v_cmp_ne_u32 vcc, s69, v142
    s_cmp_ge_u32 s71, 131072
    s_cbranch_scc1 L_polld_179
    s_and_b64 exec, exec, vcc
    s_cbranch_scc1 L_poll_178
L_polld_179:
    s_mov_b64 exec, -1
L_y2ok_167:
    s_barrier
    s_mov_b32 m0, s81
    s_add_u32 s81, s81, 14336
    buffer_load_dwordx4 v132, s[40:43], s80 offen offset:0 sc1 lds
    buffer_load_dwordx4 v132, s[40:43], s80 offen offset:1024 sc1 lds
    buffer_load_dwordx4 v132, s[40:43], s80 offen offset:2048 sc1 lds
    buffer_load_dwordx4 v132, s[40:43], s80 offen offset:3072 sc1 lds
    s_add_u32 s80, s80, 458752
    s_mov_b32 m0, s81
    s_add_u32 s81, s81, 14336
    buffer_load_dwordx4 v132, s[40:43], s80 offen offset:0 sc1 lds
    buffer_load_dwordx4 v132, s[40:43], s80 offen offset:1024 sc1 lds
    buffer_load_dwordx4 v132, s[40:43], s80 offen offset:2048 sc1 lds
    buffer_load_dwordx4 v132, s[40:43], s80 offen offset:3072 sc1 lds
    s_add_u32 s80, s80, 458752
    s_branch L_rnx_166
L_rfin_165:
    buffer_store_dword v140, off, s[40:43], s97 sc1
    v_cvt_pk_bf16_f32 v60, v4, v5
    v_cvt_pk_bf16_f32 v61, v6, v7
    ds_write_b64 v208, v[60:61] offset:0
    v_cvt_pk_bf16_f32 v62, v8, v9
    v_cvt_pk_bf16_f32 v63, v10, v11
    ds_write_b64 v208, v[62:63] offset:128
    v_cvt_pk_bf16_f32 v64, v12, v13
    v_cvt_pk_bf16_f32 v65, v14, v15
    ds_write_b64 v208, v[64:65] offset:256
    v_cvt_pk_bf16_f32 v66, v16, v17
    v_cvt_pk_bf16_f32 v67, v18, v19
    ds_write_b64 v208, v[66:67] offset:384
    v_cvt_pk_bf16_f32 v68, v20, v21
    v_cvt_pk_bf16_f32 v69, v22, v23
    ds_write_b64 v208, v[68:69] offset:512
    v_cvt_pk_bf16_f32 v70, v24, v25
    v_cvt_pk_bf16_f32 v71, v26, v27
    ds_write_b64 v208, v[70:71] offset:640
    v_cvt_pk_bf16_f32 v72, v28, v29
    v_cvt_pk_bf16_f32 v73, v30, v31
    ds_write_b64 v208, v[72:73] offset:768
    s_waitcnt lgkmcnt(0)
    ds_read_b128 v[176:179], v209 offset:0
    ds_read_b128 v[180:183], v209 offset:1024
    ds_read_b128 v[184:187], v209 offset:2048
    ds_read_b128 v[188:191], v209 offset:3072
    s_waitcnt lgkmcnt(3)
    buffer_store_dwordx4 v[176:179], v210, s[60:63], s93 offen offset:0 nt
    s_waitcnt lgkmcnt(2)
    buffer_store_dwordx4 v[180:183], v210, s[60:63], s93 offen offset:1024 nt
    s_waitcnt lgkmcnt(1)
    buffer_store_dwordx4 v[184:187], v210, s[60:63], s93 offen offset:2048 nt
    s_waitcnt lgkmcnt(0)
    buffer_store_dwordx4 v[188:191], v211, s[60:63], s93 offen offset:3072 nt
    s_add_u32 s93, s93, 458752
L_rnx_166:
    s_add_u32 s91, s91, 1
    s_cmp_eq_u32 s91, 4
    s_movk_i32 s72, 14336
    s_cselect_b32 s72, 4294924288, s72
    s_cselect_b32 s73, 1, 0
    s_cselect_b32 s91, 0, s91
    s_add_u32 s92, s92, s73
    s_waitcnt lgkmcnt(0)
    v_add_u32 v128, s72, v128
    v_add_u32 v129, s72, v129
    v_add_u32 v131, s72, v131
    s_add_u32 s98, s98, 2
    s_add_u32 s100, s100, 1
    s_cmp_lt_u32 s100, 12
    s_cbranch_scc1 L_rl_161
    s_branch L_done
L_dp_169:
    ds_read_b128 v[60:63], v128 offset:14336
    ds_read_b128 v[64:67], v128 offset:18432
    ds_read_b128 v[68:71], v128 offset:22528
    ds_read_b64 v[72:73], v129 offset:14336
    s_add_u32 s73, s94, 57344
    s_waitcnt lgkmcnt(0)
    v_mfma_f32_4x4x4_16b_bf16 v[32:35], v[2:3], v[60:61], 0
    v_mfma_f32_4x4x4_16b_bf16 v[36:39], v[2:3], v[62:63], 0
    v_mfma_f32_4x4x4_16b_bf16 v[40:43], v[2:3], v[64:65], 0
    v_mfma_f32_4x4x4_16b_bf16 v[44:47], v[2:3], v[66:67], 0
    v_mfma_f32_4x4x4_16b_bf16 v[48:51], v[2:3], v[68:69], 0
    v_mfma_f32_4x4x4_16b_bf16 v[52:55], v[2:3], v[70:71], 0
    v_mfma_f32_4x4x4_16b_bf16 v[56:59], v[2:3], v[72:73], 0
    s_mov_b32 s71, 0
L_wp_181:
    buffer_load_dword v88, v135, s[40:43], s95 offen sc1
    s_waitcnt vmcnt(0)
    v_subrev_u32 v88, s99, v88
    v_cmp_le_u32 vcc, 64, v88
    s_add_u32 s71, s71, 1
    s_cmp_eq_u64 vcc, 0
    s_cbranch_scc1 L_wpd_182
    s_cmp_lt_u32 s71, 131072
    s_cbranch_scc1 L_wp_181
L_wpd_182:
    buffer_load_dwordx2 v[144:145], v133, s[40:43], s94 offen offset:0 sc1
    buffer_load_dwordx2 v[146:147], v133, s[40:43], s94 offen offset:2048 sc1
    s_add_u32 s94, s94, 4096
    buffer_load_dwordx2 v[148:149], v133, s[40:43], s94 offen offset:0 sc1
    buffer_load_dwordx2 v[150:151], v133, s[40:43], s94 offen offset:2048 sc1
    s_add_u32 s94, s94, 4096
    buffer_load_dwordx2 v[152:153], v133, s[40:43], s94 offen offset:0 sc1
    buffer_load_dwordx2 v[154:155], v133, s[40:43], s94 offen offset:2048 sc1
    s_add_u32 s94, s94, 4096
    buffer_load_dwordx2 v[156:157], v133, s[40:43], s94 offen offset:0 sc1
    buffer_load_dwordx2 v[158:159], v133, s[40:43], s94 offen offset:2048 sc1
    s_add_u32 s94, s94, 4096
    buffer_load_dwordx2 v[160:161], v133, s[40:43], s94 offen offset:0 sc1
    buffer_load_dwordx2 v[162:163], v133, s[40:43], s94 offen offset:2048 sc1
    s_add_u32 s94, s94, 4096
    buffer_load_dwordx2 v[164:165], v133, s[40:43], s94 offen offset:0 sc1
    buffer_load_dwordx2 v[166:167], v133, s[40:43], s94 offen offset:2048 sc1
    s_add_u32 s94, s94, 4096
    buffer_load_dwordx2 v[168:169], v133, s[40:43], s94 offen offset:0 sc1
    buffer_load_dwordx2 v[170:171], v133, s[40:43], s94 offen offset:2048 sc1
    s_add_u32 s99, s99, 2
    s_waitcnt vmcnt(13)
    v_mfma_f32_4x4x4_16b_bf16 v[4:7], v[2:3], v[144:145], v[4:7]
    s_waitcnt vmcnt(12)
    v_mfma_f32_4x4x4_16b_bf16 v[8:11], v[2:3], v[146:147], v[8:11]
    s_waitcnt vmcnt(11)
    v_mfma_f32_4x4x4_16b_bf16 v[12:15], v[2:3], v[148:149], v[12:15]
    s_waitcnt vmcnt(10)
    v_mfma_f32_4x4x4_16b_bf16 v[16:19], v[2:3], v[150:151], v[16:19]
    s_waitcnt vmcnt(9)
    v_mfma_f32_4x4x4_16b_bf16 v[20:23], v[2:3], v[152:153], v[20:23]
    s_waitcnt vmcnt(8)
    v_mfma_f32_4x4x4_16b_bf16 v[24:27], v[2:3], v[154:155], v[24:27]
    s_waitcnt vmcnt(7)
    v_mfma_f32_4x4x4_16b_bf16 v[28:31], v[2:3], v[156:157], v[28:31]
    s_waitcnt vmcnt(6)
    v_mfma_f32_4x4x4_16b_bf16 v[4:7], v[2:3], v[158:159], v[4:7]
    s_waitcnt vmcnt(5)
    v_mfma_f32_4x4x4_16b_bf16 v[8:11], v[2:3], v[160:161], v[8:11]
    s_waitcnt vmcnt(4)
    v_mfma_f32_4x4x4_16b_bf16 v[12:15], v[2:3], v[162:163], v[12:15]
    s_waitcnt vmcnt(3)
    v_mfma_f32_4x4x4_16b_bf16 v[16:19], v[2:3], v[164:165], v[16:19]
    s_waitcnt vmcnt(2)
    v_mfma_f32_4x4x4_16b_bf16 v[20:23], v[2:3], v[166:167], v[20:23]
    s_waitcnt vmcnt(1)
    v_mfma_f32_4x4x4_16b_bf16 v[24:27], v[2:3], v[168:169], v[24:27]
    s_waitcnt vmcnt(0)
    v_mfma_f32_4x4x4_16b_bf16 v[28:31], v[2:3], v[170:171], v[28:31]
    buffer_load_dword v88, v135, s[40:43], s95 offen sc1
    s_nop 1
    v_cvt_pk_bf16_f32 v60, v4, v5
    v_cvt_pk_bf16_f32 v61, v6, v7
    ds_write_b64 v208, v[60:61] offset:0
    v_cvt_pk_bf16_f32 v62, v8, v9
    v_cvt_pk_bf16_f32 v63, v10, v11
    ds_write_b64 v208, v[62:63] offset:128
    v_cvt_pk_bf16_f32 v64, v12, v13
    v_cvt_pk_bf16_f32 v65, v14, v15
    ds_write_b64 v208, v[64:65] offset:256
    v_cvt_pk_bf16_f32 v66, v16, v17
    v_cvt_pk_bf16_f32 v67, v18, v19
    ds_write_b64 v208, v[66:67] offset:384
    v_cvt_pk_bf16_f32 v68, v20, v21
    v_cvt_pk_bf16_f32 v69, v22, v23
    ds_write_b64 v208, v[68:69] offset:512
    v_cvt_pk_bf16_f32 v70, v24, v25
    v_cvt_pk_bf16_f32 v71, v26, v27
    ds_write_b64 v208, v[70:71] offset:640
    v_cvt_pk_bf16_f32 v72, v28, v29
    v_cvt_pk_bf16_f32 v73, v30, v31
    ds_write_b64 v208, v[72:73] offset:768
    s_waitcnt vmcnt(0)
    v_subrev_u32 v88, s99, v88
    v_cmp_le_u32 vcc, 64, v88
    s_waitcnt lgkmcnt(0)
    ds_read_b128 v[176:179], v209 offset:0
    ds_read_b128 v[180:183], v209 offset:1024
    ds_read_b128 v[184:187], v209 offset:2048
    ds_read_b128 v[188:191], v209 offset:3072
    s_cbranch_vccz L_lk_180
    s_mov_b32 s71, 0
L_wp_183:
    buffer_load_dword v88, v135, s[40:43], s95 offen sc1
    s_waitcnt vmcnt(0)
    v_subrev_u32 v88, s99, v88
    v_cmp_le_u32 vcc, 64, v88
    s_add_u32 s71, s71, 1
    s_cmp_eq_u64 vcc, 0
    s_cbranch_scc1 L_wpd_184
    s_cmp_lt_u32 s71, 131072
    s_cbranch_scc1 L_wp_183
L_wpd_184:
L_lk_180:
    buffer_load_dwordx2 v[144:145], v133, s[40:43], s73 offen offset:0 sc1
    buffer_load_dwordx2 v[146:147], v133, s[40:43], s73 offen offset:2048 sc1
    s_add_u32 s73, s73, 4096
    buffer_load_dwordx2 v[148:149], v133, s[40:43], s73 offen offset:0 sc1
    buffer_load_dwordx2 v[150:151], v133, s[40:43], s73 offen offset:2048 sc1
    s_add_u32 s73, s73, 4096
    buffer_load_dwordx2 v[152:153], v133, s[40:43], s73 offen offset:0 sc1
    buffer_load_dwordx2 v[154:155], v133, s[40:43], s73 offen offset:2048 sc1
    s_add_u32 s73, s73, 4096
    buffer_load_dwordx2 v[156:157], v133, s[40:43], s73 offen offset:0 sc1
    buffer_load_dwordx2 v[158:159], v133, s[40:43], s73 offen offset:2048 sc1
    s_add_u32 s73, s73, 4096
    buffer_load_dwordx2 v[160:161], v133, s[40:43], s73 offen offset:0 sc1
    buffer_load_dwordx2 v[162:163], v133, s[40:43], s73 offen offset:2048 sc1
    s_add_u32 s73, s73, 4096
    buffer_load_dwordx2 v[164:165], v133, s[40:43], s73 offen offset:0 sc1
    buffer_load_dwordx2 v[166:167], v133, s[40:43], s73 offen offset:2048 sc1
    s_add_u32 s73, s73, 4096
    buffer_load_dwordx2 v[168:169], v133, s[40:43], s73 offen offset:0 sc1
    buffer_load_dwordx2 v[170:171], v133, s[40:43], s73 offen offset:2048 sc1
    s_waitcnt lgkmcnt(3)
    buffer_store_dwordx4 v[176:179], v210, s[60:63], s93 offen offset:0 nt
    s_waitcnt lgkmcnt(2)
    buffer_store_dwordx4 v[180:183], v210, s[60:63], s93 offen offset:1024 nt
    s_waitcnt lgkmcnt(1)
    buffer_store_dwordx4 v[184:187], v210, s[60:63], s93 offen offset:2048 nt
    s_waitcnt lgkmcnt(0)
    buffer_store_dwordx4 v[188:191], v211, s[60:63], s93 offen offset:3072 nt
    s_add_u32 s93, s93, 458752
    s_waitcnt vmcnt(17)
    v_mfma_f32_4x4x4_16b_bf16 v[32:35], v[2:3], v[144:145], v[32:35]
    s_waitcnt vmcnt(16)
    v_mfma_f32_4x4x4_16b_bf16 v[36:39], v[2:3], v[146:147], v[36:39]
    s_waitcnt vmcnt(15)
    v_mfma_f32_4x4x4_16b_bf16 v[40:43], v[2:3], v[148:149], v[40:43]
    s_waitcnt vmcnt(14)
    v_mfma_f32_4x4x4_16b_bf16 v[44:47], v[2:3], v[150:151], v[44:47]
    s_waitcnt vmcnt(13)
    v_mfma_f32_4x4x4_16b_bf16 v[48:51], v[2:3], v[152:153], v[48:51]
    s_waitcnt vmcnt(12)
    v_mfma_f32_4x4x4_16b_bf16 v[52:55], v[2:3], v[154:155], v[52:55]
    s_waitcnt vmcnt(11)
    v_mfma_f32_4x4x4_16b_bf16 v[56:59], v[2:3], v[156:157], v[56:59]
    s_waitcnt vmcnt(10)
    v_mfma_f32_4x4x4_16b_bf16 v[32:35], v[2:3], v[158:159], v[32:35]
    s_waitcnt vmcnt(9)
    v_mfma_f32_4x4x4_16b_bf16 v[36:39], v[2:3], v[160:161], v[36:39]
    s_waitcnt vmcnt(8)
    v_mfma_f32_4x4x4_16b_bf16 v[40:43], v[2:3], v[162:163], v[40:43]
    s_waitcnt vmcnt(7)
    v_mfma_f32_4x4x4_16b_bf16 v[44:47], v[2:3], v[164:165], v[44:47]
    s_waitcnt vmcnt(6)
    v_mfma_f32_4x4x4_16b_bf16 v[48:51], v[2:3], v[166:167], v[48:51]
    s_waitcnt vmcnt(5)
    v_mfma_f32_4x4x4_16b_bf16 v[52:55], v[2:3], v[168:169], v[52:55]
    s_waitcnt vmcnt(4)
    v_mfma_f32_4x4x4_16b_bf16 v[56:59], v[2:3], v[170:171], v[56:59]
    s_nop 2
    v_cvt_pk_bf16_f32 v60, v32, v33
    v_cvt_pk_bf16_f32 v61, v34, v35
    ds_write_b64 v208, v[60:61] offset:0
    v_cvt_pk_bf16_f32 v62, v36, v37
    v_cvt_pk_bf16_f32 v63, v38, v39
    ds_write_b64 v208, v[62:63] offset:128
    v_cvt_pk_bf16_f32 v64, v40, v41
    v_cvt_pk_bf16_f32 v65, v42, v43
    ds_write_b64 v208, v[64:65] offset:256
    v_cvt_pk_bf16_f32 v66, v44, v45
    v_cvt_pk_bf16_f32 v67, v46, v47
    ds_write_b64 v208, v[66:67] offset:384
    v_cvt_pk_bf16_f32 v68, v48, v49
    v_cvt_pk_bf16_f32 v69, v50, v51
    ds_write_b64 v208, v[68:69] offset:512
    v_cvt_pk_bf16_f32 v70, v52, v53
    v_cvt_pk_bf16_f32 v71, v54, v55
    ds_write_b64 v208, v[70:71] offset:640
    v_cvt_pk_bf16_f32 v72, v56, v57
    v_cvt_pk_bf16_f32 v73, v58, v59
    ds_write_b64 v208, v[72:73] offset:768
    s_waitcnt lgkmcnt(0)
    ds_read_b128 v[88:91], v209 offset:0
    ds_read_b128 v[92:95], v209 offset:1024
    ds_read_b128 v[96:99], v209 offset:2048
    ds_read_b128 v[100:103], v209 offset:3072
    s_waitcnt lgkmcnt(3)
    buffer_store_dwordx4 v[88:91], v210, s[60:63], s93 offen offset:0 nt
    s_waitcnt lgkmcnt(2)
    buffer_store_dwordx4 v[92:95], v210, s[60:63], s93 offen offset:1024 nt
    s_waitcnt lgkmcnt(1)
    buffer_store_dwordx4 v[96:99], v210, s[60:63], s93 offen offset:2048 nt
    s_waitcnt lgkmcnt(0)
    buffer_store_dwordx4 v[100:103], v211, s[60:63], s93 offen offset:3072 nt
    s_branch L_done
L_done:
L_end:
    s_endpgm
.section .rodata,"a"
.p2align 6
.amdhsa_kernel interleave_layers__ssm_conv_h3__glu_gated_bilinear__prompt_kernel
  .amdhsa_next_free_vgpr 512
  .amdhsa_next_free_sgpr 102
  .amdhsa_accum_offset 256
  .amdhsa_group_segment_fixed_size 0
  .amdhsa_kernarg_size 104
  .amdhsa_user_sgpr_count 2
  .amdhsa_user_sgpr_kernarg_segment_ptr 1
  .amdhsa_system_sgpr_workgroup_id_x 1
.end_amdhsa_kernel
```
